```python
import torch

def _softmax(x, axis=-1):
    return torch.softmax(x, dim=axis)

def _gelu(x):
    return torch.nn.functional.gelu(x, approximate='tanh')

def _silu(x):
    return torch.nn.functional.silu(x)

def _sigmoid(x):
    return torch.sigmoid(x)

def _layernorm(x, axis=-1, eps=1e-05):
    m = x.mean(dim=axis, keepdim=True)
    v = x.var(dim=axis, keepdim=True, unbiased=False)
    return (x - m) / torch.sqrt(v + eps)

def _scatter_add(tgt, idx, src, axis=0):
    return tgt.clone().index_add_(axis, idx, src)

def _segment_sum(src, seg, n):
    out = torch.zeros((n,) + src.shape[1:], dtype=src.dtype)
    return out.index_add_(0, seg, src)

def _pad(x, pw):
    flat = tuple((v for pair in reversed(pw) for v in pair))
    return torch.nn.functional.pad(x, flat)
kernel_name = 'concat_heads__memory_aug_recurrent_mem_tr__ssm_conv_s5__prompt'

def setup_inputs():

    _w = lambda a: (lambda t: t.to(torch.bfloat16) if t.is_floating_point() else t)(torch.as_tensor(a))

    def _A_setup():
        B, S, Dm = (1, 2048, 640)
        H, Dh = (32, 128)
        M, seg = (8, 32)
        seg = min(seg, S)
        S = S // seg * seg
        return {'x': _w((lambda *s: torch.randn(*s, dtype=torch.bfloat16) * 0.05)(B, S, Dm)), 'mem0': _w((lambda *s: torch.randn(*s, dtype=torch.bfloat16) * 0.8)(B, M, Dm)), 'Wq': _w((lambda *s: torch.randn(*s, dtype=torch.bfloat16) * 1.6)(Dm, H, Dh) * Dm ** (-0.5)), 'Wk': _w((lambda *s: torch.randn(*s, dtype=torch.bfloat16) * 1.6)(Dm, H, Dh) * Dm ** (-0.5)), 'Wv': _w((lambda *s: torch.randn(*s, dtype=torch.bfloat16) * 0.8)(Dm, H, Dh) * Dm ** (-0.5)), 'Wo': _w((lambda *s: torch.randn(*s, dtype=torch.bfloat16) * 0.8)(H, Dh, Dm) * (H * Dh) ** (-0.5)), 'seg_len': seg}
    _A_in = _A_setup()

    def _B_setup():
        B, S, D = (1, 2048, 640)
        P = D
        Lambda_re = -0.5 * (lambda _x: torch.exp(torch.as_tensor(_x)))((lambda *s: torch.randn(*s, dtype=torch.bfloat16) * 0.8)(P))
        Lambda_im = (lambda *s: torch.randn(*s, dtype=torch.bfloat16) * 0.8)(P) * 1.0
        B_re = (lambda *s: torch.randn(*s, dtype=torch.bfloat16) * 0.8)(P, D) * D ** (-0.5)
        B_im = (lambda *s: torch.randn(*s, dtype=torch.bfloat16) * 0.8)(P, D) * D ** (-0.5)
        C_re = (lambda *s: torch.randn(*s, dtype=torch.bfloat16) * 0.8)(D, P) * P ** (-0.5)
        C_im = (lambda *s: torch.randn(*s, dtype=torch.bfloat16) * 0.8)(D, P) * P ** (-0.5)
        log_dt = (lambda *s: torch.randn(*s, dtype=torch.bfloat16) * 0.8)(P) * 0.3 - 2.0
        Dskip = (lambda *s: torch.randn(*s, dtype=torch.bfloat16) * 0.8)(D)
        return {'x': _w((lambda *s: torch.randn(*s, dtype=torch.bfloat16) * 0.05)(B, S, D)), 'Lambda_re': _w(Lambda_re), 'Lambda_im': _w(Lambda_im), 'B_re': _w(B_re), 'B_im': _w(B_im), 'C_re': _w(C_re), 'C_im': _w(C_im), 'log_dt': _w(log_dt), 'Dskip': _w(Dskip)}
    _B_in = _B_setup()
    return {'A_x': _A_in['x'], 'A_mem0': _A_in['mem0'], 'A_Wq': _A_in['Wq'], 'A_Wk': _A_in['Wk'], 'A_Wv': _A_in['Wv'], 'A_Wo': _A_in['Wo'], 'A_seg_len': _A_in['seg_len'], 'B_x': _B_in['x'], 'B_Lambda_re': _B_in['Lambda_re'], 'B_Lambda_im': _B_in['Lambda_im'], 'B_B_re': _B_in['B_re'], 'B_B_im': _B_in['B_im'], 'B_C_re': _B_in['C_re'], 'B_C_im': _B_in['C_im'], 'B_log_dt': _B_in['log_dt'], 'B_Dskip': _B_in['Dskip']}

def reference(A_x, A_mem0, A_Wq, A_Wk, A_Wv, A_Wo, A_seg_len, B_x, B_Lambda_re, B_Lambda_im, B_B_re, B_B_im, B_C_re, B_C_im, B_log_dt, B_Dskip):

    def _A_ref(x, mem0, Wq, Wk, Wv, Wo, seg_len):
        B, S, Dm = x.shape
        H, Dh = (Wq.shape[1], Wq.shape[2])
        M = mem0.shape[1]
        scale = Dh ** (-0.5)
        n_seg = S // seg_len
        L = M + seg_len
        idx = torch.arange(L)
        mask = (idx[:, None] < M) | (idx[:, None] >= idx[None, :])
        mem = mem0
        outs = []
        for s in range(n_seg):
            xs = x[:, s * seg_len:(s + 1) * seg_len, :].clone()
            h = torch.concatenate([mem, xs], axis=1)
            q = torch.einsum('btd,dhe->bhte', h, Wq)
            k = torch.einsum('btd,dhe->bhte', h, Wk)
            v = torch.einsum('btd,dhe->bhte', h, Wv)
            scores = torch.einsum('bhqe,bhke->bhqk', q, k) * scale
            scores = torch.where(mask[None, None], scores, -1000000000.0)
            p = _softmax(scores, axis=-1)
            o = torch.einsum('bhqk,bhke->bhqe', p, v)
            o = torch.einsum('bhte,hed->btd', o, Wo)
            mem = o[:, :M, :].clone()
            outs.append(o[:, M:, :])
        return torch.concatenate(outs, axis=1)

    def _B_ref(x, Lambda_re, Lambda_im, B_re, B_im, C_re, C_im, log_dt, Dskip):
        Bsz, L, H = x.shape
        Lam = Lambda_re + 1j * Lambda_im
        Bmat = B_re + 1j * B_im
        Cmat = C_re + 1j * C_im
        dt = torch.exp(log_dt)
        Lam_bar = torch.exp(dt * Lam)
        B_bar = ((Lam_bar - 1.0) / Lam)[:, None] * Bmat
        Bu = torch.einsum('bld,pd->blp', x + 0j, B_bar)
        h = torch.zeros_like(Bu[:, 0, :])
        hs = []
        for t in range(L):
            h = Lam_bar[None, :] * h + Bu[:, t, :]
            hs.append(h)
        hseq = torch.stack(hs, 1)
        y = 2.0 * torch.einsum('blp,dp->bld', hseq, Cmat).real + x * Dskip[None, None, :]
        return y
    a = _A_ref(A_x, A_mem0, A_Wq, A_Wk, A_Wv, A_Wo, A_seg_len)
    b = _B_ref(B_x, B_Lambda_re, B_Lambda_im, B_B_re, B_B_im, B_C_re, B_C_im, B_log_dt, B_Dskip)
    return torch.concatenate([a, b], axis=-1)
```

```asm
; @launch grid=(256,1,1) block=(256,1,1) lds=122880
.amdgcn_target "amdgcn-amd-amdhsa--gfx950"
.text
.globl concat_heads__memory_aug_recurrent_mem_tr__ssm_conv_s5__prompt_kernel
.p2align 8
.type concat_heads__memory_aug_recurrent_mem_tr__ssm_conv_s5__prompt_kernel,@function
concat_heads__memory_aug_recurrent_mem_tr__ssm_conv_s5__prompt_kernel:
    s_cmp_ge_u32 s2, 256
    s_cbranch_scc1 L_end
    s_load_dwordx2 s[6:7], s[0:1], 136
    s_load_dwordx2 s[8:9], s[0:1], 144
    s_getreg_b32 s3, hwreg(HW_REG_XCC_ID)
    s_and_b32 s3, s3, 7
    v_lshrrev_b32 v1, 6, v0
    v_and_b32 v0, 63, v0
    v_readfirstlane_b32 s5, v1
    s_waitcnt lgkmcnt(0)
    s_add_u32 s8, s8, 0x3fffff
    s_addc_u32 s9, s9, 0
    s_and_b32 s8, s8, 0xffc00000
    s_cmp_eq_u32 s5, 0
    s_cbranch_scc0 L_noticket
    s_lshl_b32 s10, s3, 5
    v_mov_b32 v2, s10
    v_mov_b32 v3, 1
    v_mov_b32 v5, 0
    s_mov_b64 exec, 1
    global_atomic_add v4, v2, v3, s[6:7] sc0
    s_waitcnt vmcnt(0)
    ds_write_b32 v5, v4
    s_mov_b64 exec, -1
L_noticket:
    v_mov_b32 v5, 0
    s_waitcnt lgkmcnt(0)
    s_barrier
    ds_read_b32 v4, v5
    s_waitcnt lgkmcnt(0)
    v_readfirstlane_b32 s4, v4
    s_barrier
    s_cmp_lt_u32 s3, 2
    s_cbranch_scc1 L_rec
    s_cmp_eq_u32 s3, 2
    s_cbranch_scc1 L_kp
    s_cmp_eq_u32 s3, 3
    s_cbranch_scc1 L_vp
    s_cmp_eq_u32 s3, 4
    s_cbranch_scc1 L_s1
    s_cmp_eq_u32 s3, 5
    s_cbranch_scc1 L_qp
    s_sub_u32 s38, s3, 6
    s_mov_b32 s39, s4
    s_cmp_lt_u32 s4, 20
    s_cbranch_scc1 L_s2
    s_mul_i32 s10, s38, 12
    s_add_u32 s10, s10, s4
    s_sub_u32 s38, s10, 20
    s_cmp_lt_u32 s38, 20
    s_cbranch_scc1 L_b1
    s_waitcnt vmcnt(0)
    s_barrier
    s_cmp_eq_u32 s5, 0
    s_cbranch_scc0 L_si_1
    s_lshl_b32 s10, s3, 5
    s_add_u32 s10, s10, 4
    v_mov_b32 v5, s10
    v_mov_b32 v6, 1
    s_mov_b64 exec, 1
    global_atomic_add v5, v6, s[6:7]
    s_mov_b64 exec, -1
L_si_1:
    s_branch L_end
L_rec:
    s_mov_b32 s49, s3
    s_mov_b32 s50, 0
    v_lshlrev_b32 v1, 4, v0
    s_lshl_b32 s10, s5, 10
    v_add_u32 v2, s10, v1
    s_lshl_b32 s10, s5, 12
    v_add_u32 v16, s10, v1
    s_mul_i32 s10, s5, 20480
    s_add_u32 s10, s10, 40960
    v_add_u32 v18, s10, v1
    v_and_b32 v20, 15, v0
    v_bfe_u32 v21, v0, 4, 1
    v_lshrrev_b32 v22, 5, v0
    v_lshrrev_b32 v23, 2, v20
    v_and_b32 v24, 3, v20
    v_lshlrev_b32 v19, 4, v21
    s_lshl_b32 s10, s5, 3
    v_add_u32 v25, s10, v23
    v_lshl_add_u32 v25, v25, 1, v21
    v_lshlrev_b32 v25, 12, v25
    v_lshl_add_u32 v26, v22, 2, v24
    v_lshl_add_u32 v25, v26, 4, v25
    s_lshl_b32 s11, s4, 7
    v_add_u32 v3, s11, v25
    s_lshr_b32 s10, s5, 1
    s_add_u32 s10, s10, 8
    s_lshl_b32 s10, s10, 2
    v_add_u32 v25, s10, v23
    v_lshl_add_u32 v25, v25, 1, v21
    v_lshlrev_b32 v25, 12, v25
    s_and_b32 s10, s5, 1
    s_lshl_b32 s10, s10, 2
    v_add_u32 v26, s10, v24
    v_lshl_add_u32 v25, v26, 4, v25
    v_add_u32 v4, s11, v25
    s_lshl_b32 s10, s4, 1
    s_add_u32 s10, s10, s5
    s_add_u32 s11, s4, 64
    s_cmp_lt_u32 s5, 2
    s_cselect_b32 s10, s10, s11
    s_cselect_b32 s48, 1, 0
    s_cmp_eq_u32 s5, 2
    s_cselect_b32 s11, 1, 0
    s_cmp_lt_u32 s4, 16
    s_cselect_b32 s11, s11, 0
    s_or_b32 s48, s48, s11
    s_cmp_eq_u32 s48, 0
    s_cselect_b32 s10, 0, s10
    s_lshl_b32 s11, s10, 12
    v_add_u32 v5, s11, v1
    s_lshr_b32 s11, s10, 1
    s_and_b32 s10, s10, 1
    s_lshr_b32 s56, s11, 3
    s_lshl_b32 s56, s56, 10
    s_lshr_b32 s57, s11, 1
    s_and_b32 s57, s57, 3
    s_lshl_b32 s57, s57, 8
    s_add_u32 s56, s56, s57
    s_and_b32 s57, s11, 1
    s_lshl_b32 s57, s57, 7
    s_add_u32 s56, s56, s57
    s_lshl_b32 s57, s10, 6
    s_add_u32 s56, s56, s57
    v_lshrrev_b32 v25, 4, v0
    v_and_b32 v26, 1, v25
    v_lshrrev_b32 v27, 1, v25
    v_lshl_add_u32 v26, v26, 1, v27
    v_lshlrev_b32 v26, 4, v26
    v_and_b32 v27, 3, v0
    v_lshl_add_u32 v26, v27, 2, v26
    v_add_u32 v6, s56, v26
    v_lshrrev_b32 v25, 4, v0
    v_lshlrev_b32 v25, 2, v25
    v_bfe_u32 v26, v0, 3, 1
    v_add_u32 v25, v25, v26
    v_bfe_u32 v26, v0, 2, 1
    v_mul_u32_u24 v26, 34, v26
    v_add_u32 v25, v25, v26
    v_and_b32 v26, 1, v0
    v_lshl_add_u32 v25, v26, 4, v25
    v_bfe_u32 v26, v0, 1, 1
    v_mul_u32_u24 v26, 72, v26
    v_add_u32 v25, v25, v26
    v_lshlrev_b32 v25, 3, v25
    v_add_u32 v7, 32768, v25
    v_lshl_add_u32 v25, v21, 4, v20
    v_mul_u32_u24 v26, 34, v22
    v_add_u32 v25, v25, v26
    v_lshlrev_b32 v25, 3, v25
    s_mul_i32 s10, s5, 1152
    s_add_u32 s10, s10, 32768
    v_add_u32 v8, s10, v25
    s_lshr_b32 s10, s5, 1
    s_lshl_b32 s10, s10, 10
    s_and_b32 s11, s5, 1
    s_lshl_b32 s11, s11, 7
    s_add_u32 s10, s10, s11
    s_add_u32 s10, s10, 37376
    v_add_u32 v25, s10, v1
    v_add_u32 v26, 39424, v1
    v_cmp_gt_u32 vcc, 8, v20
    s_nop 1
    v_cndmask_b32 v9, v26, v25, vcc
    s_lshl_b32 s10, s49, 11
    s_lshl_b32 s11, s5, 9
    s_add_u32 s10, s10, s11
    v_lshlrev_b32 v25, 3, v0
    v_add_u32 v10, s10, v25
    v_mov_b32 v25, 0x44444444
    v_mov_b32 v26, 0xeeeeeeee
    v_cndmask_b32 v11, v26, v25, vcc
    v_add_u32 v13, 0, v1
    s_lshl_b32 s10, s5, 11
    s_add_u32 s10, s10, 8192
    v_add_u32 v12, s10, v1
    v_and_b32 v25, 1, v0
    v_lshlrev_b32 v25, 12, v25
    s_lshl_b32 s10, s4, 7
    v_add_u32 v17, s10, v25
    s_mov_b32 s42, 0
    s_mov_b32 s43, -1
    s_mov_b32 s44, 0x00ff00ff
    s_mov_b32 s45, 0x00ff00ff
    s_mov_b32 s46, 0x000f000f
    s_mov_b32 s47, 0x000f000f
    s_mov_b32 s74, -1
    s_mov_b32 s75, 0
    s_mov_b32 s52, 1040356334
    s_mov_b32 s53, 1040356334
    s_mul_i32 s10, s49, 524288
    s_add_u32 s10, s10, 4194304
    s_add_u32 s22, s8, s10
    s_addc_u32 s23, s9, 0
    s_add_u32 s24, s22, 32768
    s_addc_u32 s25, s23, 0
    s_mul_i32 s10, s49, 32768
    s_add_u32 s10, s10, 5242880
    s_add_u32 s68, s8, s10
    s_addc_u32 s69, s9, 0
    s_add_u32 s36, s8, 5767168
    s_addc_u32 s37, s9, 0
    s_add_u32 s66, s8, 0
    s_addc_u32 s67, s9, 0
    s_lshl_b32 s10, s4, 8
    s_lshl_b32 s11, s49, 7
    s_add_u32 s10, s10, s11
    s_add_u32 s17, s10, 8192
    s_lshl_b32 s10, s50, 13
    s_add_u32 s10, s10, 1048576
    s_mul_i32 s11, s49, 49152
    s_add_u32 s11, s11, s10
    s_add_u32 s92, s66, s11
    s_addc_u32 s93, s67, 0
    s_xor_b32 s11, s49, 1
    s_mul_i32 s11, s11, 49152
    s_add_u32 s11, s11, s10
    s_add_u32 s94, s66, s11
    s_addc_u32 s95, s67, 0
    v_mov_b32 v20, -1
    v_mov_b32 v21, -1
    v_mov_b32 v22, -1
    v_mov_b32 v23, -1
    s_lshl_b32 s56, s4, 14
    s_lshl_b32 s57, s49, 12
    s_add_u32 s56, s56, s57
    s_add_u32 s56, s56, 0
    s_add_u32 s58, s66, s56
    s_addc_u32 s59, s67, 0
    global_store_dwordx4 v2, v[20:23], s[58:59] sc1
    s_lshl_b32 s56, s4, 14
    s_lshl_b32 s57, s49, 12
    s_add_u32 s56, s56, s57
    s_add_u32 s56, s56, 8192
    s_add_u32 s58, s66, s56
    s_addc_u32 s59, s67, 0
    global_store_dwordx4 v2, v[20:23], s[58:59] sc1
    s_lshl_b32 s56, s4, 14
    s_lshl_b32 s57, s49, 12
    s_add_u32 s56, s56, s57
    s_add_u32 s56, s56, 524288
    s_add_u32 s58, s66, s56
    s_addc_u32 s59, s67, 0
    global_store_dwordx4 v2, v[20:23], s[58:59] sc1
    s_lshl_b32 s56, s4, 14
    s_lshl_b32 s57, s49, 12
    s_add_u32 s56, s56, s57
    s_add_u32 s56, s56, 532480
    s_add_u32 s58, s66, s56
    s_addc_u32 s59, s67, 0
    global_store_dwordx4 v2, v[20:23], s[58:59] sc1
    global_store_dwordx4 v3, v[20:23], s[22:23]
    global_store_dwordx4 v3, v[20:23], s[24:25]
    s_mov_b64 exec, s[74:75]
    global_store_dwordx4 v4, v[20:23], s[22:23]
    s_mov_b64 exec, -1
    s_cmp_eq_u32 s48, 0
    s_cbranch_scc1 L_nr_2
    s_mov_b64 exec, s[46:47]
    s_add_u32 s58, s68, 0
    s_addc_u32 s59, s69, 0
    global_store_dword v6, v20, s[58:59]
    s_mul_i32 s56, s49, 49152
    s_add_u32 s56, s56, 1048576
    s_add_u32 s58, s66, s56
    s_addc_u32 s59, s67, 0
    global_store_dword v6, v20, s[58:59] sc1
    s_mul_i32 s56, s49, 49152
    s_add_u32 s56, s56, 1056768
    s_add_u32 s58, s66, s56
    s_addc_u32 s59, s67, 0
    global_store_dword v6, v20, s[58:59] sc1
    s_add_u32 s58, s68, 8192
    s_addc_u32 s59, s69, 0
    global_store_dword v6, v20, s[58:59]
    s_mul_i32 s56, s49, 49152
    s_add_u32 s56, s56, 1064960
    s_add_u32 s58, s66, s56
    s_addc_u32 s59, s67, 0
    global_store_dword v6, v20, s[58:59] sc1
    s_mul_i32 s56, s49, 49152
    s_add_u32 s56, s56, 1073152
    s_add_u32 s58, s66, s56
    s_addc_u32 s59, s67, 0
    global_store_dword v6, v20, s[58:59] sc1
    s_add_u32 s58, s68, 16384
    s_addc_u32 s59, s69, 0
    global_store_dword v6, v20, s[58:59]
    s_mul_i32 s56, s49, 49152
    s_add_u32 s56, s56, 1081344
    s_add_u32 s58, s66, s56
    s_addc_u32 s59, s67, 0
    global_store_dword v6, v20, s[58:59] sc1
    s_mul_i32 s56, s49, 49152
    s_add_u32 s56, s56, 1089536
    s_add_u32 s58, s66, s56
    s_addc_u32 s59, s67, 0
    global_store_dword v6, v20, s[58:59] sc1
    s_mov_b64 exec, -1
L_nr_2:
    s_cmp_eq_u32 s5, 0
    s_cbranch_scc0 L_kz_3
    v_mov_b32 v24, s17
    v_mov_b32 v25, 0
    s_mov_b64 exec, 1
    global_store_dword v24, v25, s[36:37] sc1
    s_mov_b64 exec, -1
L_kz_3:
    s_waitcnt vmcnt(0)
    s_barrier
    s_cmp_eq_u32 s5, 0
    s_cbranch_scc0 L_si_4
    s_lshl_b32 s10, s3, 5
    s_add_u32 s10, s10, 4
    v_mov_b32 v24, s10
    v_mov_b32 v25, 1
    s_mov_b64 exec, 1
    global_atomic_add v24, v25, s[6:7]
    s_mov_b64 exec, -1
L_si_4:
    v_and_b32 v68, 15, v0
    v_lshrrev_b32 v69, 4, v0
    v_lshrrev_b32 v70, 1, v69
    v_and_b32 v71, 1, v69
    v_lshlrev_b32 v72, 4, v70
    v_lshl_add_u32 v72, v71, 2, v72
    v_lshlrev_b32 v64, 13, v72
    v_lshl_add_u32 v64, v68, 2, v64
    s_lshl_b32 s10, s4, 8
    s_lshl_b32 s11, s5, 6
    s_add_u32 s10, s10, s11
    v_add_u32 v64, s10, v64
    s_xor_b32 s11, s49, 1
    s_mul_i32 s11, s11, 2621440
    v_add_u32 v67, s11, v64
    s_mul_i32 s11, s49, 2621440
    v_add_u32 v64, s11, v64
    v_lshlrev_b32 v72, 3, v70
    v_lshl_add_u32 v72, v71, 2, v72
    v_mul_u32_u24 v65, 1280, v72
    v_lshl_add_u32 v65, v68, 2, v65
    s_mul_i32 s10, s4, 163840
    s_mul_i32 s11, s49, 640
    s_add_u32 s10, s10, s11
    v_add_u32 v65, s10, v65
    s_lshr_b32 s11, s5, 1
    s_lshl_b32 s11, s11, 6
    s_add_u32 s11, s11, 512
    v_add_u32 v66, s11, v65
    s_lshl_b32 s11, s5, 7
    v_add_u32 v65, s11, v65
    s_mov_b32 s70, 0x05040100
    s_mov_b32 s71, 0x07060302
    s_and_b32 s10, s5, 1
    s_cmp_eq_u32 s10, 0
    s_cselect_b32 s72, s70, s71
    s_load_dwordx2 s[10:11], s[0:1], 16
    s_waitcnt lgkmcnt(0)
    s_mov_b32 s76, s10
    s_and_b32 s77, s11, 0xffff
    s_mov_b32 s78, 5242880
    s_mov_b32 s79, 0x20000
    s_load_dwordx2 s[10:11], s[0:1], 24
    s_waitcnt lgkmcnt(0)
    s_mov_b32 s80, s10
    s_and_b32 s81, s11, 0xffff
    s_mov_b32 s82, 5242880
    s_mov_b32 s83, 0x20000
    s_load_dwordx2 s[10:11], s[0:1], 32
    s_waitcnt lgkmcnt(0)
    s_mov_b32 s84, s10
    s_and_b32 s85, s11, 0xffff
    s_mov_b32 s86, 5242880
    s_mov_b32 s87, 0x20000
    s_load_dwordx2 s[10:11], s[0:1], 40
    s_waitcnt lgkmcnt(0)
    s_mov_b32 s88, s10
    s_and_b32 s89, s11, 0xffff
    s_mov_b32 s90, 5242880
    s_mov_b32 s91, 0x20000
    s_mov_b32 s10, 0
    buffer_load_dword v20, v64, s[76:79], s10 offen
    s_mov_b32 s11, 8192
    buffer_load_dword v21, v64, s[76:79], s11 offen
    s_mov_b32 s10, 65536
    buffer_load_dword v22, v64, s[76:79], s10 offen
    s_mov_b32 s11, 73728
    buffer_load_dword v23, v64, s[76:79], s11 offen
    s_mov_b32 s10, 16384
    buffer_load_dword v24, v64, s[76:79], s10 offen
    s_mov_b32 s11, 24576
    buffer_load_dword v25, v64, s[76:79], s11 offen
    s_mov_b32 s10, 81920
    buffer_load_dword v26, v64, s[76:79], s10 offen
    s_mov_b32 s11, 90112
    buffer_load_dword v27, v64, s[76:79], s11 offen
    s_mov_b32 s10, 262144
    buffer_load_dword v28, v64, s[76:79], s10 offen
    s_mov_b32 s11, 270336
    buffer_load_dword v29, v64, s[76:79], s11 offen
    s_mov_b32 s10, 327680
    buffer_load_dword v30, v64, s[76:79], s10 offen
    s_mov_b32 s11, 335872
    buffer_load_dword v31, v64, s[76:79], s11 offen
    s_mov_b32 s10, 278528
    buffer_load_dword v32, v64, s[76:79], s10 offen
    s_mov_b32 s11, 286720
    buffer_load_dword v33, v64, s[76:79], s11 offen
    s_mov_b32 s10, 344064
    buffer_load_dword v34, v64, s[76:79], s10 offen
    s_mov_b32 s11, 352256
    buffer_load_dword v35, v64, s[76:79], s11 offen
    s_mov_b32 s10, 524288
    buffer_load_dword v36, v64, s[76:79], s10 offen
    s_mov_b32 s11, 532480
    buffer_load_dword v37, v64, s[76:79], s11 offen
    s_mov_b32 s10, 589824
    buffer_load_dword v38, v64, s[76:79], s10 offen
    s_mov_b32 s11, 598016
    buffer_load_dword v39, v64, s[76:79], s11 offen
    s_mov_b32 s10, 540672
    buffer_load_dword v40, v64, s[76:79], s10 offen
    s_mov_b32 s11, 548864
    buffer_load_dword v41, v64, s[76:79], s11 offen
    s_mov_b32 s10, 606208
    buffer_load_dword v42, v64, s[76:79], s10 offen
    s_mov_b32 s11, 614400
    buffer_load_dword v43, v64, s[76:79], s11 offen
    s_mov_b32 s10, 786432
    buffer_load_dword v44, v64, s[76:79], s10 offen
    s_mov_b32 s11, 794624
    buffer_load_dword v45, v64, s[76:79], s11 offen
    s_mov_b32 s10, 851968
    buffer_load_dword v46, v64, s[76:79], s10 offen
    s_mov_b32 s11, 860160
    buffer_load_dword v47, v64, s[76:79], s11 offen
    s_mov_b32 s10, 802816
    buffer_load_dword v48, v64, s[76:79], s10 offen
    s_mov_b32 s11, 811008
    buffer_load_dword v49, v64, s[76:79], s11 offen
    s_mov_b32 s10, 868352
    buffer_load_dword v50, v64, s[76:79], s10 offen
    s_mov_b32 s11, 876544
    buffer_load_dword v51, v64, s[76:79], s11 offen
    s_mov_b32 s10, 1048576
    buffer_load_dword v84, v64, s[76:79], s10 offen
    s_mov_b32 s11, 1056768
    buffer_load_dword v85, v64, s[76:79], s11 offen
    s_mov_b32 s10, 1114112
    buffer_load_dword v86, v64, s[76:79], s10 offen
    s_mov_b32 s11, 1122304
    buffer_load_dword v87, v64, s[76:79], s11 offen
    s_mov_b32 s10, 1064960
    buffer_load_dword v88, v64, s[76:79], s10 offen
    s_mov_b32 s11, 1073152
    buffer_load_dword v89, v64, s[76:79], s11 offen
    s_mov_b32 s10, 1130496
    buffer_load_dword v90, v64, s[76:79], s10 offen
    s_mov_b32 s11, 1138688
    buffer_load_dword v91, v64, s[76:79], s11 offen
    s_mov_b32 s10, 1310720
    buffer_load_dword v92, v64, s[76:79], s10 offen
    s_mov_b32 s11, 1318912
    buffer_load_dword v93, v64, s[76:79], s11 offen
    s_mov_b32 s10, 1376256
    buffer_load_dword v94, v64, s[76:79], s10 offen
    s_mov_b32 s11, 1384448
    buffer_load_dword v95, v64, s[76:79], s11 offen
    s_mov_b32 s10, 1327104
    buffer_load_dword v96, v64, s[76:79], s10 offen
    s_mov_b32 s11, 1335296
    buffer_load_dword v97, v64, s[76:79], s11 offen
    s_mov_b32 s10, 1392640
    buffer_load_dword v98, v64, s[76:79], s10 offen
    s_mov_b32 s11, 1400832
    buffer_load_dword v99, v64, s[76:79], s11 offen
    s_waitcnt vmcnt(32)
    v_perm_b32 v52, v21, v20, s70
    v_accvgpr_write_b32 a0, v52
    v_perm_b32 v53, v21, v20, s71
    v_accvgpr_write_b32 a8, v53
    v_perm_b32 v54, v23, v22, s70
    v_accvgpr_write_b32 a1, v54
    v_perm_b32 v55, v23, v22, s71
    v_accvgpr_write_b32 a9, v55
    v_perm_b32 v56, v25, v24, s70
    v_accvgpr_write_b32 a2, v56
    v_perm_b32 v57, v25, v24, s71
    v_accvgpr_write_b32 a10, v57
    v_perm_b32 v58, v27, v26, s70
    v_accvgpr_write_b32 a3, v58
    v_perm_b32 v59, v27, v26, s71
    v_accvgpr_write_b32 a11, v59
    v_perm_b32 v52, v29, v28, s70
    v_accvgpr_write_b32 a4, v52
    v_perm_b32 v53, v29, v28, s71
    v_accvgpr_write_b32 a12, v53
    v_perm_b32 v54, v31, v30, s70
    v_accvgpr_write_b32 a5, v54
    v_perm_b32 v55, v31, v30, s71
    v_accvgpr_write_b32 a13, v55
    v_perm_b32 v56, v33, v32, s70
    v_accvgpr_write_b32 a6, v56
    v_perm_b32 v57, v33, v32, s71
    v_accvgpr_write_b32 a14, v57
    v_perm_b32 v58, v35, v34, s70
    v_accvgpr_write_b32 a7, v58
    v_perm_b32 v59, v35, v34, s71
    v_accvgpr_write_b32 a15, v59
    s_mov_b32 s10, 1572864
    buffer_load_dword v20, v64, s[76:79], s10 offen
    s_mov_b32 s11, 1581056
    buffer_load_dword v21, v64, s[76:79], s11 offen
    s_mov_b32 s10, 1638400
    buffer_load_dword v22, v64, s[76:79], s10 offen
    s_mov_b32 s11, 1646592
    buffer_load_dword v23, v64, s[76:79], s11 offen
    s_mov_b32 s10, 1589248
    buffer_load_dword v24, v64, s[76:79], s10 offen
    s_mov_b32 s11, 1597440
    buffer_load_dword v25, v64, s[76:79], s11 offen
    s_mov_b32 s10, 1654784
    buffer_load_dword v26, v64, s[76:79], s10 offen
    s_mov_b32 s11, 1662976
    buffer_load_dword v27, v64, s[76:79], s11 offen
    s_mov_b32 s10, 1835008
    buffer_load_dword v28, v64, s[76:79], s10 offen
    s_mov_b32 s11, 1843200
    buffer_load_dword v29, v64, s[76:79], s11 offen
    s_mov_b32 s10, 1900544
    buffer_load_dword v30, v64, s[76:79], s10 offen
    s_mov_b32 s11, 1908736
    buffer_load_dword v31, v64, s[76:79], s11 offen
    s_mov_b32 s10, 1851392
    buffer_load_dword v32, v64, s[76:79], s10 offen
    s_mov_b32 s11, 1859584
    buffer_load_dword v33, v64, s[76:79], s11 offen
    s_mov_b32 s10, 1916928
    buffer_load_dword v34, v64, s[76:79], s10 offen
    s_mov_b32 s11, 1925120
    buffer_load_dword v35, v64, s[76:79], s11 offen
    s_waitcnt vmcnt(32)
    v_perm_b32 v52, v37, v36, s70
    v_accvgpr_write_b32 a16, v52
    v_perm_b32 v53, v37, v36, s71
    v_accvgpr_write_b32 a24, v53
    v_perm_b32 v54, v39, v38, s70
    v_accvgpr_write_b32 a17, v54
    v_perm_b32 v55, v39, v38, s71
    v_accvgpr_write_b32 a25, v55
    v_perm_b32 v56, v41, v40, s70
    v_accvgpr_write_b32 a18, v56
    v_perm_b32 v57, v41, v40, s71
    v_accvgpr_write_b32 a26, v57
    v_perm_b32 v58, v43, v42, s70
    v_accvgpr_write_b32 a19, v58
    v_perm_b32 v59, v43, v42, s71
    v_accvgpr_write_b32 a27, v59
    v_perm_b32 v52, v45, v44, s70
    v_accvgpr_write_b32 a20, v52
    v_perm_b32 v53, v45, v44, s71
    v_accvgpr_write_b32 a28, v53
    v_perm_b32 v54, v47, v46, s70
    v_accvgpr_write_b32 a21, v54
    v_perm_b32 v55, v47, v46, s71
    v_accvgpr_write_b32 a29, v55
    v_perm_b32 v56, v49, v48, s70
    v_accvgpr_write_b32 a22, v56
    v_perm_b32 v57, v49, v48, s71
    v_accvgpr_write_b32 a30, v57
    v_perm_b32 v58, v51, v50, s70
    v_accvgpr_write_b32 a23, v58
    v_perm_b32 v59, v51, v50, s71
    v_accvgpr_write_b32 a31, v59
    s_mov_b32 s10, 2097152
    buffer_load_dword v36, v64, s[76:79], s10 offen
    s_mov_b32 s11, 2105344
    buffer_load_dword v37, v64, s[76:79], s11 offen
    s_mov_b32 s10, 2162688
    buffer_load_dword v38, v64, s[76:79], s10 offen
    s_mov_b32 s11, 2170880
    buffer_load_dword v39, v64, s[76:79], s11 offen
    s_mov_b32 s10, 2113536
    buffer_load_dword v40, v64, s[76:79], s10 offen
    s_mov_b32 s11, 2121728
    buffer_load_dword v41, v64, s[76:79], s11 offen
    s_mov_b32 s10, 2179072
    buffer_load_dword v42, v64, s[76:79], s10 offen
    s_mov_b32 s11, 2187264
    buffer_load_dword v43, v64, s[76:79], s11 offen
    s_mov_b32 s10, 2359296
    buffer_load_dword v44, v64, s[76:79], s10 offen
    s_mov_b32 s11, 2367488
    buffer_load_dword v45, v64, s[76:79], s11 offen
    s_mov_b32 s10, 2424832
    buffer_load_dword v46, v64, s[76:79], s10 offen
    s_mov_b32 s11, 2433024
    buffer_load_dword v47, v64, s[76:79], s11 offen
    s_mov_b32 s10, 2375680
    buffer_load_dword v48, v64, s[76:79], s10 offen
    s_mov_b32 s11, 2383872
    buffer_load_dword v49, v64, s[76:79], s11 offen
    s_mov_b32 s10, 2441216
    buffer_load_dword v50, v64, s[76:79], s10 offen
    s_mov_b32 s11, 2449408
    buffer_load_dword v51, v64, s[76:79], s11 offen
    s_waitcnt vmcnt(32)
    v_perm_b32 v52, v85, v84, s70
    v_accvgpr_write_b32 a32, v52
    v_perm_b32 v53, v85, v84, s71
    v_accvgpr_write_b32 a40, v53
    v_perm_b32 v54, v87, v86, s70
    v_accvgpr_write_b32 a33, v54
    v_perm_b32 v55, v87, v86, s71
    v_accvgpr_write_b32 a41, v55
    v_perm_b32 v56, v89, v88, s70
    v_accvgpr_write_b32 a34, v56
    v_perm_b32 v57, v89, v88, s71
    v_accvgpr_write_b32 a42, v57
    v_perm_b32 v58, v91, v90, s70
    v_accvgpr_write_b32 a35, v58
    v_perm_b32 v59, v91, v90, s71
    v_accvgpr_write_b32 a43, v59
    v_perm_b32 v52, v93, v92, s70
    v_accvgpr_write_b32 a36, v52
    v_perm_b32 v53, v93, v92, s71
    v_accvgpr_write_b32 a44, v53
    v_perm_b32 v54, v95, v94, s70
    v_accvgpr_write_b32 a37, v54
    v_perm_b32 v55, v95, v94, s71
    v_accvgpr_write_b32 a45, v55
    v_perm_b32 v56, v97, v96, s70
    v_accvgpr_write_b32 a38, v56
    v_perm_b32 v57, v97, v96, s71
    v_accvgpr_write_b32 a46, v57
    v_perm_b32 v58, v99, v98, s70
    v_accvgpr_write_b32 a39, v58
    v_perm_b32 v59, v99, v98, s71
    v_accvgpr_write_b32 a47, v59
    s_mov_b32 s10, 0
    buffer_load_dword v84, v67, s[76:79], s10 offen
    s_mov_b32 s11, 8192
    buffer_load_dword v85, v67, s[76:79], s11 offen
    s_mov_b32 s10, 65536
    buffer_load_dword v86, v67, s[76:79], s10 offen
    s_mov_b32 s11, 73728
    buffer_load_dword v87, v67, s[76:79], s11 offen
    s_mov_b32 s10, 16384
    buffer_load_dword v88, v67, s[76:79], s10 offen
    s_mov_b32 s11, 24576
    buffer_load_dword v89, v67, s[76:79], s11 offen
    s_mov_b32 s10, 81920
    buffer_load_dword v90, v67, s[76:79], s10 offen
    s_mov_b32 s11, 90112
    buffer_load_dword v91, v67, s[76:79], s11 offen
    s_mov_b32 s10, 262144
    buffer_load_dword v92, v67, s[76:79], s10 offen
    s_mov_b32 s11, 270336
    buffer_load_dword v93, v67, s[76:79], s11 offen
    s_mov_b32 s10, 327680
    buffer_load_dword v94, v67, s[76:79], s10 offen
    s_mov_b32 s11, 335872
    buffer_load_dword v95, v67, s[76:79], s11 offen
    s_mov_b32 s10, 278528
    buffer_load_dword v96, v67, s[76:79], s10 offen
    s_mov_b32 s11, 286720
    buffer_load_dword v97, v67, s[76:79], s11 offen
    s_mov_b32 s10, 344064
    buffer_load_dword v98, v67, s[76:79], s10 offen
    s_mov_b32 s11, 352256
    buffer_load_dword v99, v67, s[76:79], s11 offen
    s_waitcnt vmcnt(32)
    v_perm_b32 v52, v21, v20, s70
    v_accvgpr_write_b32 a48, v52
    v_perm_b32 v53, v21, v20, s71
    v_accvgpr_write_b32 a56, v53
    v_perm_b32 v54, v23, v22, s70
    v_accvgpr_write_b32 a49, v54
    v_perm_b32 v55, v23, v22, s71
    v_accvgpr_write_b32 a57, v55
    v_perm_b32 v56, v25, v24, s70
    v_accvgpr_write_b32 a50, v56
    v_perm_b32 v57, v25, v24, s71
    v_accvgpr_write_b32 a58, v57
    v_perm_b32 v58, v27, v26, s70
    v_accvgpr_write_b32 a51, v58
    v_perm_b32 v59, v27, v26, s71
    v_accvgpr_write_b32 a59, v59
    v_perm_b32 v52, v29, v28, s70
    v_accvgpr_write_b32 a52, v52
    v_perm_b32 v53, v29, v28, s71
    v_accvgpr_write_b32 a60, v53
    v_perm_b32 v54, v31, v30, s70
    v_accvgpr_write_b32 a53, v54
    v_perm_b32 v55, v31, v30, s71
    v_accvgpr_write_b32 a61, v55
    v_perm_b32 v56, v33, v32, s70
    v_accvgpr_write_b32 a54, v56
    v_perm_b32 v57, v33, v32, s71
    v_accvgpr_write_b32 a62, v57
    v_perm_b32 v58, v35, v34, s70
    v_accvgpr_write_b32 a55, v58
    v_perm_b32 v59, v35, v34, s71
    v_accvgpr_write_b32 a63, v59
    s_mov_b32 s10, 524288
    buffer_load_dword v20, v67, s[76:79], s10 offen
    s_mov_b32 s11, 532480
    buffer_load_dword v21, v67, s[76:79], s11 offen
    s_mov_b32 s10, 589824
    buffer_load_dword v22, v67, s[76:79], s10 offen
    s_mov_b32 s11, 598016
    buffer_load_dword v23, v67, s[76:79], s11 offen
    s_mov_b32 s10, 540672
    buffer_load_dword v24, v67, s[76:79], s10 offen
    s_mov_b32 s11, 548864
    buffer_load_dword v25, v67, s[76:79], s11 offen
    s_mov_b32 s10, 606208
    buffer_load_dword v26, v67, s[76:79], s10 offen
    s_mov_b32 s11, 614400
    buffer_load_dword v27, v67, s[76:79], s11 offen
    s_mov_b32 s10, 786432
    buffer_load_dword v28, v67, s[76:79], s10 offen
    s_mov_b32 s11, 794624
    buffer_load_dword v29, v67, s[76:79], s11 offen
    s_mov_b32 s10, 851968
    buffer_load_dword v30, v67, s[76:79], s10 offen
    s_mov_b32 s11, 860160
    buffer_load_dword v31, v67, s[76:79], s11 offen
    s_mov_b32 s10, 802816
    buffer_load_dword v32, v67, s[76:79], s10 offen
    s_mov_b32 s11, 811008
    buffer_load_dword v33, v67, s[76:79], s11 offen
    s_mov_b32 s10, 868352
    buffer_load_dword v34, v67, s[76:79], s10 offen
    s_mov_b32 s11, 876544
    buffer_load_dword v35, v67, s[76:79], s11 offen
    s_waitcnt vmcnt(32)
    v_perm_b32 v52, v37, v36, s70
    v_accvgpr_write_b32 a64, v52
    v_perm_b32 v53, v37, v36, s71
    v_accvgpr_write_b32 a72, v53
    v_perm_b32 v54, v39, v38, s70
    v_accvgpr_write_b32 a65, v54
    v_perm_b32 v55, v39, v38, s71
    v_accvgpr_write_b32 a73, v55
    v_perm_b32 v56, v41, v40, s70
    v_accvgpr_write_b32 a66, v56
    v_perm_b32 v57, v41, v40, s71
    v_accvgpr_write_b32 a74, v57
    v_perm_b32 v58, v43, v42, s70
    v_accvgpr_write_b32 a67, v58
    v_perm_b32 v59, v43, v42, s71
    v_accvgpr_write_b32 a75, v59
    v_perm_b32 v52, v45, v44, s70
    v_accvgpr_write_b32 a68, v52
    v_perm_b32 v53, v45, v44, s71
    v_accvgpr_write_b32 a76, v53
    v_perm_b32 v54, v47, v46, s70
    v_accvgpr_write_b32 a69, v54
    v_perm_b32 v55, v47, v46, s71
    v_accvgpr_write_b32 a77, v55
    v_perm_b32 v56, v49, v48, s70
    v_accvgpr_write_b32 a70, v56
    v_perm_b32 v57, v49, v48, s71
    v_accvgpr_write_b32 a78, v57
    v_perm_b32 v58, v51, v50, s70
    v_accvgpr_write_b32 a71, v58
    v_perm_b32 v59, v51, v50, s71
    v_accvgpr_write_b32 a79, v59
    s_mov_b32 s10, 1048576
    buffer_load_dword v36, v67, s[76:79], s10 offen
    s_mov_b32 s11, 1056768
    buffer_load_dword v37, v67, s[76:79], s11 offen
    s_mov_b32 s10, 1114112
    buffer_load_dword v38, v67, s[76:79], s10 offen
    s_mov_b32 s11, 1122304
    buffer_load_dword v39, v67, s[76:79], s11 offen
    s_mov_b32 s10, 1064960
    buffer_load_dword v40, v67, s[76:79], s10 offen
    s_mov_b32 s11, 1073152
    buffer_load_dword v41, v67, s[76:79], s11 offen
    s_mov_b32 s10, 1130496
    buffer_load_dword v42, v67, s[76:79], s10 offen
    s_mov_b32 s11, 1138688
    buffer_load_dword v43, v67, s[76:79], s11 offen
    s_mov_b32 s10, 1310720
    buffer_load_dword v44, v67, s[76:79], s10 offen
    s_mov_b32 s11, 1318912
    buffer_load_dword v45, v67, s[76:79], s11 offen
    s_mov_b32 s10, 1376256
    buffer_load_dword v46, v67, s[76:79], s10 offen
    s_mov_b32 s11, 1384448
    buffer_load_dword v47, v67, s[76:79], s11 offen
    s_mov_b32 s10, 1327104
    buffer_load_dword v48, v67, s[76:79], s10 offen
    s_mov_b32 s11, 1335296
    buffer_load_dword v49, v67, s[76:79], s11 offen
    s_mov_b32 s10, 1392640
    buffer_load_dword v50, v67, s[76:79], s10 offen
    s_mov_b32 s11, 1400832
    buffer_load_dword v51, v67, s[76:79], s11 offen
    s_waitcnt vmcnt(32)
    v_perm_b32 v52, v85, v84, s70
    v_accvgpr_write_b32 a80, v52
    v_perm_b32 v53, v85, v84, s71
    v_accvgpr_write_b32 a88, v53
    v_perm_b32 v54, v87, v86, s70
    v_accvgpr_write_b32 a81, v54
    v_perm_b32 v55, v87, v86, s71
    v_accvgpr_write_b32 a89, v55
    v_perm_b32 v56, v89, v88, s70
    v_accvgpr_write_b32 a82, v56
    v_perm_b32 v57, v89, v88, s71
    v_accvgpr_write_b32 a90, v57
    v_perm_b32 v58, v91, v90, s70
    v_accvgpr_write_b32 a83, v58
    v_perm_b32 v59, v91, v90, s71
    v_accvgpr_write_b32 a91, v59
    v_perm_b32 v52, v93, v92, s70
    v_accvgpr_write_b32 a84, v52
    v_perm_b32 v53, v93, v92, s71
    v_accvgpr_write_b32 a92, v53
    v_perm_b32 v54, v95, v94, s70
    v_accvgpr_write_b32 a85, v54
    v_perm_b32 v55, v95, v94, s71
    v_accvgpr_write_b32 a93, v55
    v_perm_b32 v56, v97, v96, s70
    v_accvgpr_write_b32 a86, v56
    v_perm_b32 v57, v97, v96, s71
    v_accvgpr_write_b32 a94, v57
    v_perm_b32 v58, v99, v98, s70
    v_accvgpr_write_b32 a87, v58
    v_perm_b32 v59, v99, v98, s71
    v_accvgpr_write_b32 a95, v59
    s_mov_b32 s10, 1572864
    buffer_load_dword v84, v67, s[76:79], s10 offen
    s_mov_b32 s11, 1581056
    buffer_load_dword v85, v67, s[76:79], s11 offen
    s_mov_b32 s10, 1638400
    buffer_load_dword v86, v67, s[76:79], s10 offen
    s_mov_b32 s11, 1646592
    buffer_load_dword v87, v67, s[76:79], s11 offen
    s_mov_b32 s10, 1589248
    buffer_load_dword v88, v67, s[76:79], s10 offen
    s_mov_b32 s11, 1597440
    buffer_load_dword v89, v67, s[76:79], s11 offen
    s_mov_b32 s10, 1654784
    buffer_load_dword v90, v67, s[76:79], s10 offen
    s_mov_b32 s11, 1662976
    buffer_load_dword v91, v67, s[76:79], s11 offen
    s_mov_b32 s10, 1835008
    buffer_load_dword v92, v67, s[76:79], s10 offen
    s_mov_b32 s11, 1843200
    buffer_load_dword v93, v67, s[76:79], s11 offen
    s_mov_b32 s10, 1900544
    buffer_load_dword v94, v67, s[76:79], s10 offen
    s_mov_b32 s11, 1908736
    buffer_load_dword v95, v67, s[76:79], s11 offen
    s_mov_b32 s10, 1851392
    buffer_load_dword v96, v67, s[76:79], s10 offen
    s_mov_b32 s11, 1859584
    buffer_load_dword v97, v67, s[76:79], s11 offen
    s_mov_b32 s10, 1916928
    buffer_load_dword v98, v67, s[76:79], s10 offen
    s_mov_b32 s11, 1925120
    buffer_load_dword v99, v67, s[76:79], s11 offen
    s_waitcnt vmcnt(32)
    v_perm_b32 v52, v21, v20, s70
    v_accvgpr_write_b32 a96, v52
    v_perm_b32 v53, v21, v20, s71
    v_accvgpr_write_b32 a104, v53
    v_perm_b32 v54, v23, v22, s70
    v_accvgpr_write_b32 a97, v54
    v_perm_b32 v55, v23, v22, s71
    v_accvgpr_write_b32 a105, v55
    v_perm_b32 v56, v25, v24, s70
    v_accvgpr_write_b32 a98, v56
    v_perm_b32 v57, v25, v24, s71
    v_accvgpr_write_b32 a106, v57
    v_perm_b32 v58, v27, v26, s70
    v_accvgpr_write_b32 a99, v58
    v_perm_b32 v59, v27, v26, s71
    v_accvgpr_write_b32 a107, v59
    v_perm_b32 v52, v29, v28, s70
    v_accvgpr_write_b32 a100, v52
    v_perm_b32 v53, v29, v28, s71
    v_accvgpr_write_b32 a108, v53
    v_perm_b32 v54, v31, v30, s70
    v_accvgpr_write_b32 a101, v54
    v_perm_b32 v55, v31, v30, s71
    v_accvgpr_write_b32 a109, v55
    v_perm_b32 v56, v33, v32, s70
    v_accvgpr_write_b32 a102, v56
    v_perm_b32 v57, v33, v32, s71
    v_accvgpr_write_b32 a110, v57
    v_perm_b32 v58, v35, v34, s70
    v_accvgpr_write_b32 a103, v58
    v_perm_b32 v59, v35, v34, s71
    v_accvgpr_write_b32 a111, v59
    s_mov_b32 s10, 2097152
    buffer_load_dword v20, v67, s[76:79], s10 offen
    s_mov_b32 s11, 2105344
    buffer_load_dword v21, v67, s[76:79], s11 offen
    s_mov_b32 s10, 2162688
    buffer_load_dword v22, v67, s[76:79], s10 offen
    s_mov_b32 s11, 2170880
    buffer_load_dword v23, v67, s[76:79], s11 offen
    s_mov_b32 s10, 2113536
    buffer_load_dword v24, v67, s[76:79], s10 offen
    s_mov_b32 s11, 2121728
    buffer_load_dword v25, v67, s[76:79], s11 offen
    s_mov_b32 s10, 2179072
    buffer_load_dword v26, v67, s[76:79], s10 offen
    s_mov_b32 s11, 2187264
    buffer_load_dword v27, v67, s[76:79], s11 offen
    s_mov_b32 s10, 2359296
    buffer_load_dword v28, v67, s[76:79], s10 offen
    s_mov_b32 s11, 2367488
    buffer_load_dword v29, v67, s[76:79], s11 offen
    s_mov_b32 s10, 2424832
    buffer_load_dword v30, v67, s[76:79], s10 offen
    s_mov_b32 s11, 2433024
    buffer_load_dword v31, v67, s[76:79], s11 offen
    s_mov_b32 s10, 2375680
    buffer_load_dword v32, v67, s[76:79], s10 offen
    s_mov_b32 s11, 2383872
    buffer_load_dword v33, v67, s[76:79], s11 offen
    s_mov_b32 s10, 2441216
    buffer_load_dword v34, v67, s[76:79], s10 offen
    s_mov_b32 s11, 2449408
    buffer_load_dword v35, v67, s[76:79], s11 offen
    s_waitcnt vmcnt(32)
    v_perm_b32 v52, v37, v36, s70
    v_accvgpr_write_b32 a112, v52
    v_perm_b32 v53, v37, v36, s71
    v_accvgpr_write_b32 a120, v53
    v_perm_b32 v54, v39, v38, s70
    v_accvgpr_write_b32 a113, v54
    v_perm_b32 v55, v39, v38, s71
    v_accvgpr_write_b32 a121, v55
    v_perm_b32 v56, v41, v40, s70
    v_accvgpr_write_b32 a114, v56
    v_perm_b32 v57, v41, v40, s71
    v_accvgpr_write_b32 a122, v57
    v_perm_b32 v58, v43, v42, s70
    v_accvgpr_write_b32 a115, v58
    v_perm_b32 v59, v43, v42, s71
    v_accvgpr_write_b32 a123, v59
    v_perm_b32 v52, v45, v44, s70
    v_accvgpr_write_b32 a116, v52
    v_perm_b32 v53, v45, v44, s71
    v_accvgpr_write_b32 a124, v53
    v_perm_b32 v54, v47, v46, s70
    v_accvgpr_write_b32 a117, v54
    v_perm_b32 v55, v47, v46, s71
    v_accvgpr_write_b32 a125, v55
    v_perm_b32 v56, v49, v48, s70
    v_accvgpr_write_b32 a118, v56
    v_perm_b32 v57, v49, v48, s71
    v_accvgpr_write_b32 a126, v57
    v_perm_b32 v58, v51, v50, s70
    v_accvgpr_write_b32 a119, v58
    v_perm_b32 v59, v51, v50, s71
    v_accvgpr_write_b32 a127, v59
    s_mov_b32 s10, 0
    buffer_load_dword v36, v64, s[80:83], s10 offen
    s_mov_b32 s11, 8192
    buffer_load_dword v37, v64, s[80:83], s11 offen
    s_mov_b32 s10, 65536
    buffer_load_dword v38, v64, s[80:83], s10 offen
    s_mov_b32 s11, 73728
    buffer_load_dword v39, v64, s[80:83], s11 offen
    s_mov_b32 s10, 16384
    buffer_load_dword v40, v64, s[80:83], s10 offen
    s_mov_b32 s11, 24576
    buffer_load_dword v41, v64, s[80:83], s11 offen
    s_mov_b32 s10, 81920
    buffer_load_dword v42, v64, s[80:83], s10 offen
    s_mov_b32 s11, 90112
    buffer_load_dword v43, v64, s[80:83], s11 offen
    s_mov_b32 s10, 262144
    buffer_load_dword v44, v64, s[80:83], s10 offen
    s_mov_b32 s11, 270336
    buffer_load_dword v45, v64, s[80:83], s11 offen
    s_mov_b32 s10, 327680
    buffer_load_dword v46, v64, s[80:83], s10 offen
    s_mov_b32 s11, 335872
    buffer_load_dword v47, v64, s[80:83], s11 offen
    s_mov_b32 s10, 278528
    buffer_load_dword v48, v64, s[80:83], s10 offen
    s_mov_b32 s11, 286720
    buffer_load_dword v49, v64, s[80:83], s11 offen
    s_mov_b32 s10, 344064
    buffer_load_dword v50, v64, s[80:83], s10 offen
    s_mov_b32 s11, 352256
    buffer_load_dword v51, v64, s[80:83], s11 offen
    s_waitcnt vmcnt(32)
    v_perm_b32 v52, v85, v84, s70
    v_accvgpr_write_b32 a128, v52
    v_perm_b32 v53, v85, v84, s71
    v_accvgpr_write_b32 a136, v53
    v_perm_b32 v54, v87, v86, s70
    v_accvgpr_write_b32 a129, v54
    v_perm_b32 v55, v87, v86, s71
    v_accvgpr_write_b32 a137, v55
    v_perm_b32 v56, v89, v88, s70
    v_accvgpr_write_b32 a130, v56
    v_perm_b32 v57, v89, v88, s71
    v_accvgpr_write_b32 a138, v57
    v_perm_b32 v58, v91, v90, s70
    v_accvgpr_write_b32 a131, v58
    v_perm_b32 v59, v91, v90, s71
    v_accvgpr_write_b32 a139, v59
    v_perm_b32 v52, v93, v92, s70
    v_accvgpr_write_b32 a132, v52
    v_perm_b32 v53, v93, v92, s71
    v_accvgpr_write_b32 a140, v53
    v_perm_b32 v54, v95, v94, s70
    v_accvgpr_write_b32 a133, v54
    v_perm_b32 v55, v95, v94, s71
    v_accvgpr_write_b32 a141, v55
    v_perm_b32 v56, v97, v96, s70
    v_accvgpr_write_b32 a134, v56
    v_perm_b32 v57, v97, v96, s71
    v_accvgpr_write_b32 a142, v57
    v_perm_b32 v58, v99, v98, s70
    v_accvgpr_write_b32 a135, v58
    v_perm_b32 v59, v99, v98, s71
    v_accvgpr_write_b32 a143, v59
    s_mov_b32 s10, 524288
    buffer_load_dword v84, v64, s[80:83], s10 offen
    s_mov_b32 s11, 532480
    buffer_load_dword v85, v64, s[80:83], s11 offen
    s_mov_b32 s10, 589824
    buffer_load_dword v86, v64, s[80:83], s10 offen
    s_mov_b32 s11, 598016
    buffer_load_dword v87, v64, s[80:83], s11 offen
    s_mov_b32 s10, 540672
    buffer_load_dword v88, v64, s[80:83], s10 offen
    s_mov_b32 s11, 548864
    buffer_load_dword v89, v64, s[80:83], s11 offen
    s_mov_b32 s10, 606208
    buffer_load_dword v90, v64, s[80:83], s10 offen
    s_mov_b32 s11, 614400
    buffer_load_dword v91, v64, s[80:83], s11 offen
    s_mov_b32 s10, 786432
    buffer_load_dword v92, v64, s[80:83], s10 offen
    s_mov_b32 s11, 794624
    buffer_load_dword v93, v64, s[80:83], s11 offen
    s_mov_b32 s10, 851968
    buffer_load_dword v94, v64, s[80:83], s10 offen
    s_mov_b32 s11, 860160
    buffer_load_dword v95, v64, s[80:83], s11 offen
    s_mov_b32 s10, 802816
    buffer_load_dword v96, v64, s[80:83], s10 offen
    s_mov_b32 s11, 811008
    buffer_load_dword v97, v64, s[80:83], s11 offen
    s_mov_b32 s10, 868352
    buffer_load_dword v98, v64, s[80:83], s10 offen
    s_mov_b32 s11, 876544
    buffer_load_dword v99, v64, s[80:83], s11 offen
    s_waitcnt vmcnt(32)
    v_perm_b32 v52, v21, v20, s70
    v_accvgpr_write_b32 a144, v52
    v_perm_b32 v53, v21, v20, s71
    v_accvgpr_write_b32 a152, v53
    v_perm_b32 v54, v23, v22, s70
    v_accvgpr_write_b32 a145, v54
    v_perm_b32 v55, v23, v22, s71
    v_accvgpr_write_b32 a153, v55
    v_perm_b32 v56, v25, v24, s70
    v_accvgpr_write_b32 a146, v56
    v_perm_b32 v57, v25, v24, s71
    v_accvgpr_write_b32 a154, v57
    v_perm_b32 v58, v27, v26, s70
    v_accvgpr_write_b32 a147, v58
    v_perm_b32 v59, v27, v26, s71
    v_accvgpr_write_b32 a155, v59
    v_perm_b32 v52, v29, v28, s70
    v_accvgpr_write_b32 a148, v52
    v_perm_b32 v53, v29, v28, s71
    v_accvgpr_write_b32 a156, v53
    v_perm_b32 v54, v31, v30, s70
    v_accvgpr_write_b32 a149, v54
    v_perm_b32 v55, v31, v30, s71
    v_accvgpr_write_b32 a157, v55
    v_perm_b32 v56, v33, v32, s70
    v_accvgpr_write_b32 a150, v56
    v_perm_b32 v57, v33, v32, s71
    v_accvgpr_write_b32 a158, v57
    v_perm_b32 v58, v35, v34, s70
    v_accvgpr_write_b32 a151, v58
    v_perm_b32 v59, v35, v34, s71
    v_accvgpr_write_b32 a159, v59
    s_mov_b32 s10, 1048576
    buffer_load_dword v20, v64, s[80:83], s10 offen
    s_mov_b32 s11, 1056768
    buffer_load_dword v21, v64, s[80:83], s11 offen
    s_mov_b32 s10, 1114112
    buffer_load_dword v22, v64, s[80:83], s10 offen
    s_mov_b32 s11, 1122304
    buffer_load_dword v23, v64, s[80:83], s11 offen
    s_mov_b32 s10, 1064960
    buffer_load_dword v24, v64, s[80:83], s10 offen
    s_mov_b32 s11, 1073152
    buffer_load_dword v25, v64, s[80:83], s11 offen
    s_mov_b32 s10, 1130496
    buffer_load_dword v26, v64, s[80:83], s10 offen
    s_mov_b32 s11, 1138688
    buffer_load_dword v27, v64, s[80:83], s11 offen
    s_mov_b32 s10, 1310720
    buffer_load_dword v28, v64, s[80:83], s10 offen
    s_mov_b32 s11, 1318912
    buffer_load_dword v29, v64, s[80:83], s11 offen
    s_mov_b32 s10, 1376256
    buffer_load_dword v30, v64, s[80:83], s10 offen
    s_mov_b32 s11, 1384448
    buffer_load_dword v31, v64, s[80:83], s11 offen
    s_mov_b32 s10, 1327104
    buffer_load_dword v32, v64, s[80:83], s10 offen
    s_mov_b32 s11, 1335296
    buffer_load_dword v33, v64, s[80:83], s11 offen
    s_mov_b32 s10, 1392640
    buffer_load_dword v34, v64, s[80:83], s10 offen
    s_mov_b32 s11, 1400832
    buffer_load_dword v35, v64, s[80:83], s11 offen
    s_waitcnt vmcnt(32)
    v_perm_b32 v52, v37, v36, s70
    v_accvgpr_write_b32 a160, v52
    v_perm_b32 v53, v37, v36, s71
    v_accvgpr_write_b32 a168, v53
    v_perm_b32 v54, v39, v38, s70
    v_accvgpr_write_b32 a161, v54
    v_perm_b32 v55, v39, v38, s71
    v_accvgpr_write_b32 a169, v55
    v_perm_b32 v56, v41, v40, s70
    v_accvgpr_write_b32 a162, v56
    v_perm_b32 v57, v41, v40, s71
    v_accvgpr_write_b32 a170, v57
    v_perm_b32 v58, v43, v42, s70
    v_accvgpr_write_b32 a163, v58
    v_perm_b32 v59, v43, v42, s71
    v_accvgpr_write_b32 a171, v59
    v_perm_b32 v52, v45, v44, s70
    v_accvgpr_write_b32 a164, v52
    v_perm_b32 v53, v45, v44, s71
    v_accvgpr_write_b32 a172, v53
    v_perm_b32 v54, v47, v46, s70
    v_accvgpr_write_b32 a165, v54
    v_perm_b32 v55, v47, v46, s71
    v_accvgpr_write_b32 a173, v55
    v_perm_b32 v56, v49, v48, s70
    v_accvgpr_write_b32 a166, v56
    v_perm_b32 v57, v49, v48, s71
    v_accvgpr_write_b32 a174, v57
    v_perm_b32 v58, v51, v50, s70
    v_accvgpr_write_b32 a167, v58
    v_perm_b32 v59, v51, v50, s71
    v_accvgpr_write_b32 a175, v59
    s_mov_b32 s10, 1572864
    buffer_load_dword v36, v64, s[80:83], s10 offen
    s_mov_b32 s11, 1581056
    buffer_load_dword v37, v64, s[80:83], s11 offen
    s_mov_b32 s10, 1638400
    buffer_load_dword v38, v64, s[80:83], s10 offen
    s_mov_b32 s11, 1646592
    buffer_load_dword v39, v64, s[80:83], s11 offen
    s_mov_b32 s10, 1589248
    buffer_load_dword v40, v64, s[80:83], s10 offen
    s_mov_b32 s11, 1597440
    buffer_load_dword v41, v64, s[80:83], s11 offen
    s_mov_b32 s10, 1654784
    buffer_load_dword v42, v64, s[80:83], s10 offen
    s_mov_b32 s11, 1662976
    buffer_load_dword v43, v64, s[80:83], s11 offen
    s_mov_b32 s10, 1835008
    buffer_load_dword v44, v64, s[80:83], s10 offen
    s_mov_b32 s11, 1843200
    buffer_load_dword v45, v64, s[80:83], s11 offen
    s_mov_b32 s10, 1900544
    buffer_load_dword v46, v64, s[80:83], s10 offen
    s_mov_b32 s11, 1908736
    buffer_load_dword v47, v64, s[80:83], s11 offen
    s_mov_b32 s10, 1851392
    buffer_load_dword v48, v64, s[80:83], s10 offen
    s_mov_b32 s11, 1859584
    buffer_load_dword v49, v64, s[80:83], s11 offen
    s_mov_b32 s10, 1916928
    buffer_load_dword v50, v64, s[80:83], s10 offen
    s_mov_b32 s11, 1925120
    buffer_load_dword v51, v64, s[80:83], s11 offen
    s_waitcnt vmcnt(32)
    v_perm_b32 v52, v85, v84, s70
    v_accvgpr_write_b32 a176, v52
    v_perm_b32 v53, v85, v84, s71
    v_accvgpr_write_b32 a184, v53
    v_perm_b32 v54, v87, v86, s70
    v_accvgpr_write_b32 a177, v54
    v_perm_b32 v55, v87, v86, s71
    v_accvgpr_write_b32 a185, v55
    v_perm_b32 v56, v89, v88, s70
    v_accvgpr_write_b32 a178, v56
    v_perm_b32 v57, v89, v88, s71
    v_accvgpr_write_b32 a186, v57
    v_perm_b32 v58, v91, v90, s70
    v_accvgpr_write_b32 a179, v58
    v_perm_b32 v59, v91, v90, s71
    v_accvgpr_write_b32 a187, v59
    v_perm_b32 v52, v93, v92, s70
    v_accvgpr_write_b32 a180, v52
    v_perm_b32 v53, v93, v92, s71
    v_accvgpr_write_b32 a188, v53
    v_perm_b32 v54, v95, v94, s70
    v_accvgpr_write_b32 a181, v54
    v_perm_b32 v55, v95, v94, s71
    v_accvgpr_write_b32 a189, v55
    v_perm_b32 v56, v97, v96, s70
    v_accvgpr_write_b32 a182, v56
    v_perm_b32 v57, v97, v96, s71
    v_accvgpr_write_b32 a190, v57
    v_perm_b32 v58, v99, v98, s70
    v_accvgpr_write_b32 a183, v58
    v_perm_b32 v59, v99, v98, s71
    v_accvgpr_write_b32 a191, v59
    s_mov_b32 s10, 2097152
    buffer_load_dword v84, v64, s[80:83], s10 offen
    s_mov_b32 s11, 2105344
    buffer_load_dword v85, v64, s[80:83], s11 offen
    s_mov_b32 s10, 2162688
    buffer_load_dword v86, v64, s[80:83], s10 offen
    s_mov_b32 s11, 2170880
    buffer_load_dword v87, v64, s[80:83], s11 offen
    s_mov_b32 s10, 2113536
    buffer_load_dword v88, v64, s[80:83], s10 offen
    s_mov_b32 s11, 2121728
    buffer_load_dword v89, v64, s[80:83], s11 offen
    s_mov_b32 s10, 2179072
    buffer_load_dword v90, v64, s[80:83], s10 offen
    s_mov_b32 s11, 2187264
    buffer_load_dword v91, v64, s[80:83], s11 offen
    s_mov_b32 s10, 2359296
    buffer_load_dword v92, v64, s[80:83], s10 offen
    s_mov_b32 s11, 2367488
    buffer_load_dword v93, v64, s[80:83], s11 offen
    s_mov_b32 s10, 2424832
    buffer_load_dword v94, v64, s[80:83], s10 offen
    s_mov_b32 s11, 2433024
    buffer_load_dword v95, v64, s[80:83], s11 offen
    s_mov_b32 s10, 2375680
    buffer_load_dword v96, v64, s[80:83], s10 offen
    s_mov_b32 s11, 2383872
    buffer_load_dword v97, v64, s[80:83], s11 offen
    s_mov_b32 s10, 2441216
    buffer_load_dword v98, v64, s[80:83], s10 offen
    s_mov_b32 s11, 2449408
    buffer_load_dword v99, v64, s[80:83], s11 offen
    s_waitcnt vmcnt(32)
    v_perm_b32 v52, v21, v20, s70
    v_accvgpr_write_b32 a192, v52
    v_perm_b32 v53, v21, v20, s71
    v_accvgpr_write_b32 a200, v53
    v_perm_b32 v54, v23, v22, s70
    v_accvgpr_write_b32 a193, v54
    v_perm_b32 v55, v23, v22, s71
    v_accvgpr_write_b32 a201, v55
    v_perm_b32 v56, v25, v24, s70
    v_accvgpr_write_b32 a194, v56
    v_perm_b32 v57, v25, v24, s71
    v_accvgpr_write_b32 a202, v57
    v_perm_b32 v58, v27, v26, s70
    v_accvgpr_write_b32 a195, v58
    v_perm_b32 v59, v27, v26, s71
    v_accvgpr_write_b32 a203, v59
    v_perm_b32 v52, v29, v28, s70
    v_accvgpr_write_b32 a196, v52
    v_perm_b32 v53, v29, v28, s71
    v_accvgpr_write_b32 a204, v53
    v_perm_b32 v54, v31, v30, s70
    v_accvgpr_write_b32 a197, v54
    v_perm_b32 v55, v31, v30, s71
    v_accvgpr_write_b32 a205, v55
    v_perm_b32 v56, v33, v32, s70
    v_accvgpr_write_b32 a198, v56
    v_perm_b32 v57, v33, v32, s71
    v_accvgpr_write_b32 a206, v57
    v_perm_b32 v58, v35, v34, s70
    v_accvgpr_write_b32 a199, v58
    v_perm_b32 v59, v35, v34, s71
    v_accvgpr_write_b32 a207, v59
    s_mov_b32 s10, 0
    buffer_load_dword v20, v67, s[80:83], s10 offen
    s_mov_b32 s11, 8192
    buffer_load_dword v21, v67, s[80:83], s11 offen
    s_mov_b32 s10, 65536
    buffer_load_dword v22, v67, s[80:83], s10 offen
    s_mov_b32 s11, 73728
    buffer_load_dword v23, v67, s[80:83], s11 offen
    s_mov_b32 s10, 16384
    buffer_load_dword v24, v67, s[80:83], s10 offen
    s_mov_b32 s11, 24576
    buffer_load_dword v25, v67, s[80:83], s11 offen
    s_mov_b32 s10, 81920
    buffer_load_dword v26, v67, s[80:83], s10 offen
    s_mov_b32 s11, 90112
    buffer_load_dword v27, v67, s[80:83], s11 offen
    s_mov_b32 s10, 262144
    buffer_load_dword v28, v67, s[80:83], s10 offen
    s_mov_b32 s11, 270336
    buffer_load_dword v29, v67, s[80:83], s11 offen
    s_mov_b32 s10, 327680
    buffer_load_dword v30, v67, s[80:83], s10 offen
    s_mov_b32 s11, 335872
    buffer_load_dword v31, v67, s[80:83], s11 offen
    s_mov_b32 s10, 278528
    buffer_load_dword v32, v67, s[80:83], s10 offen
    s_mov_b32 s11, 286720
    buffer_load_dword v33, v67, s[80:83], s11 offen
    s_mov_b32 s10, 344064
    buffer_load_dword v34, v67, s[80:83], s10 offen
    s_mov_b32 s11, 352256
    buffer_load_dword v35, v67, s[80:83], s11 offen
    s_waitcnt vmcnt(32)
    v_perm_b32 v52, v37, v36, s70
    v_accvgpr_write_b32 a208, v52
    v_perm_b32 v53, v37, v36, s71
    v_accvgpr_write_b32 a216, v53
    v_perm_b32 v54, v39, v38, s70
    v_accvgpr_write_b32 a209, v54
    v_perm_b32 v55, v39, v38, s71
    v_accvgpr_write_b32 a217, v55
    v_perm_b32 v56, v41, v40, s70
    v_accvgpr_write_b32 a210, v56
    v_perm_b32 v57, v41, v40, s71
    v_accvgpr_write_b32 a218, v57
    v_perm_b32 v58, v43, v42, s70
    v_accvgpr_write_b32 a211, v58
    v_perm_b32 v59, v43, v42, s71
    v_accvgpr_write_b32 a219, v59
    v_perm_b32 v52, v45, v44, s70
    v_accvgpr_write_b32 a212, v52
    v_perm_b32 v53, v45, v44, s71
    v_accvgpr_write_b32 a220, v53
    v_perm_b32 v54, v47, v46, s70
    v_accvgpr_write_b32 a213, v54
    v_perm_b32 v55, v47, v46, s71
    v_accvgpr_write_b32 a221, v55
    v_perm_b32 v56, v49, v48, s70
    v_accvgpr_write_b32 a214, v56
    v_perm_b32 v57, v49, v48, s71
    v_accvgpr_write_b32 a222, v57
    v_perm_b32 v58, v51, v50, s70
    v_accvgpr_write_b32 a215, v58
    v_perm_b32 v59, v51, v50, s71
    v_accvgpr_write_b32 a223, v59
    s_mov_b32 s10, 524288
    buffer_load_dword v36, v67, s[80:83], s10 offen
    s_mov_b32 s11, 532480
    buffer_load_dword v37, v67, s[80:83], s11 offen
    s_mov_b32 s10, 589824
    buffer_load_dword v38, v67, s[80:83], s10 offen
    s_mov_b32 s11, 598016
    buffer_load_dword v39, v67, s[80:83], s11 offen
    s_mov_b32 s10, 540672
    buffer_load_dword v40, v67, s[80:83], s10 offen
    s_mov_b32 s11, 548864
    buffer_load_dword v41, v67, s[80:83], s11 offen
    s_mov_b32 s10, 606208
    buffer_load_dword v42, v67, s[80:83], s10 offen
    s_mov_b32 s11, 614400
    buffer_load_dword v43, v67, s[80:83], s11 offen
    s_mov_b32 s10, 786432
    buffer_load_dword v44, v67, s[80:83], s10 offen
    s_mov_b32 s11, 794624
    buffer_load_dword v45, v67, s[80:83], s11 offen
    s_mov_b32 s10, 851968
    buffer_load_dword v46, v67, s[80:83], s10 offen
    s_mov_b32 s11, 860160
    buffer_load_dword v47, v67, s[80:83], s11 offen
    s_mov_b32 s10, 802816
    buffer_load_dword v48, v67, s[80:83], s10 offen
    s_mov_b32 s11, 811008
    buffer_load_dword v49, v67, s[80:83], s11 offen
    s_mov_b32 s10, 868352
    buffer_load_dword v50, v67, s[80:83], s10 offen
    s_mov_b32 s11, 876544
    buffer_load_dword v51, v67, s[80:83], s11 offen
    s_waitcnt vmcnt(32)
    v_perm_b32 v52, v85, v84, s70
    v_accvgpr_write_b32 a224, v52
    v_perm_b32 v53, v85, v84, s71
    v_accvgpr_write_b32 a232, v53
    v_perm_b32 v54, v87, v86, s70
    v_accvgpr_write_b32 a225, v54
    v_perm_b32 v55, v87, v86, s71
    v_accvgpr_write_b32 a233, v55
    v_perm_b32 v56, v89, v88, s70
    v_accvgpr_write_b32 a226, v56
    v_perm_b32 v57, v89, v88, s71
    v_accvgpr_write_b32 a234, v57
    v_perm_b32 v58, v91, v90, s70
    v_accvgpr_write_b32 a227, v58
    v_perm_b32 v59, v91, v90, s71
    v_accvgpr_write_b32 a235, v59
    v_perm_b32 v52, v93, v92, s70
    v_accvgpr_write_b32 a228, v52
    v_perm_b32 v53, v93, v92, s71
    v_accvgpr_write_b32 a236, v53
    v_perm_b32 v54, v95, v94, s70
    v_accvgpr_write_b32 a229, v54
    v_perm_b32 v55, v95, v94, s71
    v_accvgpr_write_b32 a237, v55
    v_perm_b32 v56, v97, v96, s70
    v_accvgpr_write_b32 a230, v56
    v_perm_b32 v57, v97, v96, s71
    v_accvgpr_write_b32 a238, v57
    v_perm_b32 v58, v99, v98, s70
    v_accvgpr_write_b32 a231, v58
    v_perm_b32 v59, v99, v98, s71
    v_accvgpr_write_b32 a239, v59
    s_mov_b32 s10, 1048576
    buffer_load_dword v84, v67, s[80:83], s10 offen
    s_mov_b32 s11, 1056768
    buffer_load_dword v85, v67, s[80:83], s11 offen
    s_mov_b32 s10, 1114112
    buffer_load_dword v86, v67, s[80:83], s10 offen
    s_mov_b32 s11, 1122304
    buffer_load_dword v87, v67, s[80:83], s11 offen
    s_mov_b32 s10, 1064960
    buffer_load_dword v88, v67, s[80:83], s10 offen
    s_mov_b32 s11, 1073152
    buffer_load_dword v89, v67, s[80:83], s11 offen
    s_mov_b32 s10, 1130496
    buffer_load_dword v90, v67, s[80:83], s10 offen
    s_mov_b32 s11, 1138688
    buffer_load_dword v91, v67, s[80:83], s11 offen
    s_mov_b32 s10, 1310720
    buffer_load_dword v92, v67, s[80:83], s10 offen
    s_mov_b32 s11, 1318912
    buffer_load_dword v93, v67, s[80:83], s11 offen
    s_mov_b32 s10, 1376256
    buffer_load_dword v94, v67, s[80:83], s10 offen
    s_mov_b32 s11, 1384448
    buffer_load_dword v95, v67, s[80:83], s11 offen
    s_mov_b32 s10, 1327104
    buffer_load_dword v96, v67, s[80:83], s10 offen
    s_mov_b32 s11, 1335296
    buffer_load_dword v97, v67, s[80:83], s11 offen
    s_mov_b32 s10, 1392640
    buffer_load_dword v98, v67, s[80:83], s10 offen
    s_mov_b32 s11, 1400832
    buffer_load_dword v99, v67, s[80:83], s11 offen
    s_waitcnt vmcnt(32)
    v_perm_b32 v52, v21, v20, s70
    v_accvgpr_write_b32 a240, v52
    v_perm_b32 v53, v21, v20, s71
    v_accvgpr_write_b32 a248, v53
    v_perm_b32 v54, v23, v22, s70
    v_accvgpr_write_b32 a241, v54
    v_perm_b32 v55, v23, v22, s71
    v_accvgpr_write_b32 a249, v55
    v_perm_b32 v56, v25, v24, s70
    v_accvgpr_write_b32 a242, v56
    v_perm_b32 v57, v25, v24, s71
    v_accvgpr_write_b32 a250, v57
    v_perm_b32 v58, v27, v26, s70
    v_accvgpr_write_b32 a243, v58
    v_perm_b32 v59, v27, v26, s71
    v_accvgpr_write_b32 a251, v59
    v_perm_b32 v52, v29, v28, s70
    v_accvgpr_write_b32 a244, v52
    v_perm_b32 v53, v29, v28, s71
    v_accvgpr_write_b32 a252, v53
    v_perm_b32 v54, v31, v30, s70
    v_accvgpr_write_b32 a245, v54
    v_perm_b32 v55, v31, v30, s71
    v_accvgpr_write_b32 a253, v55
    v_perm_b32 v56, v33, v32, s70
    v_accvgpr_write_b32 a246, v56
    v_perm_b32 v57, v33, v32, s71
    v_accvgpr_write_b32 a254, v57
    v_perm_b32 v58, v35, v34, s70
    v_accvgpr_write_b32 a247, v58
    v_perm_b32 v59, v35, v34, s71
    v_accvgpr_write_b32 a255, v59
    s_mov_b32 s10, 1572864
    buffer_load_dword v20, v67, s[80:83], s10 offen
    s_mov_b32 s11, 1581056
    buffer_load_dword v21, v67, s[80:83], s11 offen
    s_mov_b32 s10, 1638400
    buffer_load_dword v22, v67, s[80:83], s10 offen
    s_mov_b32 s11, 1646592
    buffer_load_dword v23, v67, s[80:83], s11 offen
    s_mov_b32 s10, 1589248
    buffer_load_dword v24, v67, s[80:83], s10 offen
    s_mov_b32 s11, 1597440
    buffer_load_dword v25, v67, s[80:83], s11 offen
    s_mov_b32 s10, 1654784
    buffer_load_dword v26, v67, s[80:83], s10 offen
    s_mov_b32 s11, 1662976
    buffer_load_dword v27, v67, s[80:83], s11 offen
    s_mov_b32 s10, 1835008
    buffer_load_dword v28, v67, s[80:83], s10 offen
    s_mov_b32 s11, 1843200
    buffer_load_dword v29, v67, s[80:83], s11 offen
    s_mov_b32 s10, 1900544
    buffer_load_dword v30, v67, s[80:83], s10 offen
    s_mov_b32 s11, 1908736
    buffer_load_dword v31, v67, s[80:83], s11 offen
    s_mov_b32 s10, 1851392
    buffer_load_dword v32, v67, s[80:83], s10 offen
    s_mov_b32 s11, 1859584
    buffer_load_dword v33, v67, s[80:83], s11 offen
    s_mov_b32 s10, 1916928
    buffer_load_dword v34, v67, s[80:83], s10 offen
    s_mov_b32 s11, 1925120
    buffer_load_dword v35, v67, s[80:83], s11 offen
    s_waitcnt vmcnt(32)
    v_perm_b32 v112, v37, v36, s70
    v_perm_b32 v120, v37, v36, s71
    v_perm_b32 v113, v39, v38, s70
    v_perm_b32 v121, v39, v38, s71
    v_perm_b32 v114, v41, v40, s70
    v_perm_b32 v122, v41, v40, s71
    v_perm_b32 v115, v43, v42, s70
    v_perm_b32 v123, v43, v42, s71
    v_perm_b32 v116, v45, v44, s70
    v_perm_b32 v124, v45, v44, s71
    v_perm_b32 v117, v47, v46, s70
    v_perm_b32 v125, v47, v46, s71
    v_perm_b32 v118, v49, v48, s70
    v_perm_b32 v126, v49, v48, s71
    v_perm_b32 v119, v51, v50, s70
    v_perm_b32 v127, v51, v50, s71
    s_mov_b32 s10, 2097152
    buffer_load_dword v36, v67, s[80:83], s10 offen
    s_mov_b32 s11, 2105344
    buffer_load_dword v37, v67, s[80:83], s11 offen
    s_mov_b32 s10, 2162688
    buffer_load_dword v38, v67, s[80:83], s10 offen
    s_mov_b32 s11, 2170880
    buffer_load_dword v39, v67, s[80:83], s11 offen
    s_mov_b32 s10, 2113536
    buffer_load_dword v40, v67, s[80:83], s10 offen
    s_mov_b32 s11, 2121728
    buffer_load_dword v41, v67, s[80:83], s11 offen
    s_mov_b32 s10, 2179072
    buffer_load_dword v42, v67, s[80:83], s10 offen
    s_mov_b32 s11, 2187264
    buffer_load_dword v43, v67, s[80:83], s11 offen
    s_mov_b32 s10, 2359296
    buffer_load_dword v44, v67, s[80:83], s10 offen
    s_mov_b32 s11, 2367488
    buffer_load_dword v45, v67, s[80:83], s11 offen
    s_mov_b32 s10, 2424832
    buffer_load_dword v46, v67, s[80:83], s10 offen
    s_mov_b32 s11, 2433024
    buffer_load_dword v47, v67, s[80:83], s11 offen
    s_mov_b32 s10, 2375680
    buffer_load_dword v48, v67, s[80:83], s10 offen
    s_mov_b32 s11, 2383872
    buffer_load_dword v49, v67, s[80:83], s11 offen
    s_mov_b32 s10, 2441216
    buffer_load_dword v50, v67, s[80:83], s10 offen
    s_mov_b32 s11, 2449408
    buffer_load_dword v51, v67, s[80:83], s11 offen
    s_waitcnt vmcnt(32)
    v_perm_b32 v128, v85, v84, s70
    v_perm_b32 v136, v85, v84, s71
    v_perm_b32 v129, v87, v86, s70
    v_perm_b32 v137, v87, v86, s71
    v_perm_b32 v130, v89, v88, s70
    v_perm_b32 v138, v89, v88, s71
    v_perm_b32 v131, v91, v90, s70
    v_perm_b32 v139, v91, v90, s71
    v_perm_b32 v132, v93, v92, s70
    v_perm_b32 v140, v93, v92, s71
    v_perm_b32 v133, v95, v94, s70
    v_perm_b32 v141, v95, v94, s71
    v_perm_b32 v134, v97, v96, s70
    v_perm_b32 v142, v97, v96, s71
    v_perm_b32 v135, v99, v98, s70
    v_perm_b32 v143, v99, v98, s71
    s_mov_b32 s10, 0
    buffer_load_dword v84, v64, s[84:87], s10 offen
    s_mov_b32 s11, 8192
    buffer_load_dword v85, v64, s[84:87], s11 offen
    s_mov_b32 s10, 65536
    buffer_load_dword v86, v64, s[84:87], s10 offen
    s_mov_b32 s11, 73728
    buffer_load_dword v87, v64, s[84:87], s11 offen
    s_mov_b32 s10, 16384
    buffer_load_dword v88, v64, s[84:87], s10 offen
    s_mov_b32 s11, 24576
    buffer_load_dword v89, v64, s[84:87], s11 offen
    s_mov_b32 s10, 81920
    buffer_load_dword v90, v64, s[84:87], s10 offen
    s_mov_b32 s11, 90112
    buffer_load_dword v91, v64, s[84:87], s11 offen
    s_mov_b32 s10, 262144
    buffer_load_dword v92, v64, s[84:87], s10 offen
    s_mov_b32 s11, 270336
    buffer_load_dword v93, v64, s[84:87], s11 offen
    s_mov_b32 s10, 327680
    buffer_load_dword v94, v64, s[84:87], s10 offen
    s_mov_b32 s11, 335872
    buffer_load_dword v95, v64, s[84:87], s11 offen
    s_mov_b32 s10, 278528
    buffer_load_dword v96, v64, s[84:87], s10 offen
    s_mov_b32 s11, 286720
    buffer_load_dword v97, v64, s[84:87], s11 offen
    s_mov_b32 s10, 344064
    buffer_load_dword v98, v64, s[84:87], s10 offen
    s_mov_b32 s11, 352256
    buffer_load_dword v99, v64, s[84:87], s11 offen
    s_waitcnt vmcnt(32)
    v_perm_b32 v144, v21, v20, s70
    v_perm_b32 v152, v21, v20, s71
    v_perm_b32 v145, v23, v22, s70
    v_perm_b32 v153, v23, v22, s71
    v_perm_b32 v146, v25, v24, s70
    v_perm_b32 v154, v25, v24, s71
    v_perm_b32 v147, v27, v26, s70
    v_perm_b32 v155, v27, v26, s71
    v_perm_b32 v148, v29, v28, s70
    v_perm_b32 v156, v29, v28, s71
    v_perm_b32 v149, v31, v30, s70
    v_perm_b32 v157, v31, v30, s71
    v_perm_b32 v150, v33, v32, s70
    v_perm_b32 v158, v33, v32, s71
    v_perm_b32 v151, v35, v34, s70
    v_perm_b32 v159, v35, v34, s71
    s_mov_b32 s10, 524288
    buffer_load_dword v20, v64, s[84:87], s10 offen
    s_mov_b32 s11, 532480
    buffer_load_dword v21, v64, s[84:87], s11 offen
    s_mov_b32 s10, 589824
    buffer_load_dword v22, v64, s[84:87], s10 offen
    s_mov_b32 s11, 598016
    buffer_load_dword v23, v64, s[84:87], s11 offen
    s_mov_b32 s10, 540672
    buffer_load_dword v24, v64, s[84:87], s10 offen
    s_mov_b32 s11, 548864
    buffer_load_dword v25, v64, s[84:87], s11 offen
    s_mov_b32 s10, 606208
    buffer_load_dword v26, v64, s[84:87], s10 offen
    s_mov_b32 s11, 614400
    buffer_load_dword v27, v64, s[84:87], s11 offen
    s_mov_b32 s10, 786432
    buffer_load_dword v28, v64, s[84:87], s10 offen
    s_mov_b32 s11, 794624
    buffer_load_dword v29, v64, s[84:87], s11 offen
    s_mov_b32 s10, 851968
    buffer_load_dword v30, v64, s[84:87], s10 offen
    s_mov_b32 s11, 860160
    buffer_load_dword v31, v64, s[84:87], s11 offen
    s_mov_b32 s10, 802816
    buffer_load_dword v32, v64, s[84:87], s10 offen
    s_mov_b32 s11, 811008
    buffer_load_dword v33, v64, s[84:87], s11 offen
    s_mov_b32 s10, 868352
    buffer_load_dword v34, v64, s[84:87], s10 offen
    s_mov_b32 s11, 876544
    buffer_load_dword v35, v64, s[84:87], s11 offen
    s_waitcnt vmcnt(32)
    v_perm_b32 v160, v37, v36, s70
    v_perm_b32 v168, v37, v36, s71
    v_perm_b32 v161, v39, v38, s70
    v_perm_b32 v169, v39, v38, s71
    v_perm_b32 v162, v41, v40, s70
    v_perm_b32 v170, v41, v40, s71
    v_perm_b32 v163, v43, v42, s70
    v_perm_b32 v171, v43, v42, s71
    v_perm_b32 v164, v45, v44, s70
    v_perm_b32 v172, v45, v44, s71
    v_perm_b32 v165, v47, v46, s70
    v_perm_b32 v173, v47, v46, s71
    v_perm_b32 v166, v49, v48, s70
    v_perm_b32 v174, v49, v48, s71
    v_perm_b32 v167, v51, v50, s70
    v_perm_b32 v175, v51, v50, s71
    s_mov_b32 s10, 1048576
    buffer_load_dword v36, v64, s[84:87], s10 offen
    s_mov_b32 s11, 1056768
    buffer_load_dword v37, v64, s[84:87], s11 offen
    s_mov_b32 s10, 1114112
    buffer_load_dword v38, v64, s[84:87], s10 offen
    s_mov_b32 s11, 1122304
    buffer_load_dword v39, v64, s[84:87], s11 offen
    s_mov_b32 s10, 1064960
    buffer_load_dword v40, v64, s[84:87], s10 offen
    s_mov_b32 s11, 1073152
    buffer_load_dword v41, v64, s[84:87], s11 offen
    s_mov_b32 s10, 1130496
    buffer_load_dword v42, v64, s[84:87], s10 offen
    s_mov_b32 s11, 1138688
    buffer_load_dword v43, v64, s[84:87], s11 offen
    s_mov_b32 s10, 1310720
    buffer_load_dword v44, v64, s[84:87], s10 offen
    s_mov_b32 s11, 1318912
    buffer_load_dword v45, v64, s[84:87], s11 offen
    s_mov_b32 s10, 1376256
    buffer_load_dword v46, v64, s[84:87], s10 offen
    s_mov_b32 s11, 1384448
    buffer_load_dword v47, v64, s[84:87], s11 offen
    s_mov_b32 s10, 1327104
    buffer_load_dword v48, v64, s[84:87], s10 offen
    s_mov_b32 s11, 1335296
    buffer_load_dword v49, v64, s[84:87], s11 offen
    s_mov_b32 s10, 1392640
    buffer_load_dword v50, v64, s[84:87], s10 offen
    s_mov_b32 s11, 1400832
    buffer_load_dword v51, v64, s[84:87], s11 offen
    s_waitcnt vmcnt(32)
    v_perm_b32 v68, v85, v84, s70
    v_perm_b32 v76, v85, v84, s71
    v_perm_b32 v69, v87, v86, s70
    v_perm_b32 v77, v87, v86, s71
    v_perm_b32 v70, v89, v88, s70
    v_perm_b32 v78, v89, v88, s71
    v_perm_b32 v71, v91, v90, s70
    v_perm_b32 v79, v91, v90, s71
    v_perm_b32 v72, v93, v92, s70
    v_perm_b32 v80, v93, v92, s71
    v_perm_b32 v73, v95, v94, s70
    v_perm_b32 v81, v95, v94, s71
    v_perm_b32 v74, v97, v96, s70
    v_perm_b32 v82, v97, v96, s71
    v_perm_b32 v75, v99, v98, s70
    v_perm_b32 v83, v99, v98, s71
    ds_write_b128 v18, v[68:71] offset:0
    ds_write_b128 v18, v[72:75] offset:1024
    ds_write_b128 v18, v[76:79] offset:2048
    ds_write_b128 v18, v[80:83] offset:3072
    s_mov_b32 s10, 1572864
    buffer_load_dword v84, v64, s[84:87], s10 offen
    s_mov_b32 s11, 1581056
    buffer_load_dword v85, v64, s[84:87], s11 offen
    s_mov_b32 s10, 1638400
    buffer_load_dword v86, v64, s[84:87], s10 offen
    s_mov_b32 s11, 1646592
    buffer_load_dword v87, v64, s[84:87], s11 offen
    s_mov_b32 s10, 1589248
    buffer_load_dword v88, v64, s[84:87], s10 offen
    s_mov_b32 s11, 1597440
    buffer_load_dword v89, v64, s[84:87], s11 offen
    s_mov_b32 s10, 1654784
    buffer_load_dword v90, v64, s[84:87], s10 offen
    s_mov_b32 s11, 1662976
    buffer_load_dword v91, v64, s[84:87], s11 offen
    s_mov_b32 s10, 1835008
    buffer_load_dword v92, v64, s[84:87], s10 offen
    s_mov_b32 s11, 1843200
    buffer_load_dword v93, v64, s[84:87], s11 offen
    s_mov_b32 s10, 1900544
    buffer_load_dword v94, v64, s[84:87], s10 offen
    s_mov_b32 s11, 1908736
    buffer_load_dword v95, v64, s[84:87], s11 offen
    s_mov_b32 s10, 1851392
    buffer_load_dword v96, v64, s[84:87], s10 offen
    s_mov_b32 s11, 1859584
    buffer_load_dword v97, v64, s[84:87], s11 offen
    s_mov_b32 s10, 1916928
    buffer_load_dword v98, v64, s[84:87], s10 offen
    s_mov_b32 s11, 1925120
    buffer_load_dword v99, v64, s[84:87], s11 offen
    s_waitcnt vmcnt(32)
    v_perm_b32 v68, v21, v20, s70
    v_perm_b32 v76, v21, v20, s71
    v_perm_b32 v69, v23, v22, s70
    v_perm_b32 v77, v23, v22, s71
    v_perm_b32 v70, v25, v24, s70
    v_perm_b32 v78, v25, v24, s71
    v_perm_b32 v71, v27, v26, s70
    v_perm_b32 v79, v27, v26, s71
    v_perm_b32 v72, v29, v28, s70
    v_perm_b32 v80, v29, v28, s71
    v_perm_b32 v73, v31, v30, s70
    v_perm_b32 v81, v31, v30, s71
    v_perm_b32 v74, v33, v32, s70
    v_perm_b32 v82, v33, v32, s71
    v_perm_b32 v75, v35, v34, s70
    v_perm_b32 v83, v35, v34, s71
    ds_write_b128 v18, v[68:71] offset:4096
    ds_write_b128 v18, v[72:75] offset:5120
    ds_write_b128 v18, v[76:79] offset:6144
    ds_write_b128 v18, v[80:83] offset:7168
    s_mov_b32 s10, 2097152
    buffer_load_dword v20, v64, s[84:87], s10 offen
    s_mov_b32 s11, 2105344
    buffer_load_dword v21, v64, s[84:87], s11 offen
    s_mov_b32 s10, 2162688
    buffer_load_dword v22, v64, s[84:87], s10 offen
    s_mov_b32 s11, 2170880
    buffer_load_dword v23, v64, s[84:87], s11 offen
    s_mov_b32 s10, 2113536
    buffer_load_dword v24, v64, s[84:87], s10 offen
    s_mov_b32 s11, 2121728
    buffer_load_dword v25, v64, s[84:87], s11 offen
    s_mov_b32 s10, 2179072
    buffer_load_dword v26, v64, s[84:87], s10 offen
    s_mov_b32 s11, 2187264
    buffer_load_dword v27, v64, s[84:87], s11 offen
    s_mov_b32 s10, 2359296
    buffer_load_dword v28, v64, s[84:87], s10 offen
    s_mov_b32 s11, 2367488
    buffer_load_dword v29, v64, s[84:87], s11 offen
    s_mov_b32 s10, 2424832
    buffer_load_dword v30, v64, s[84:87], s10 offen
    s_mov_b32 s11, 2433024
    buffer_load_dword v31, v64, s[84:87], s11 offen
    s_mov_b32 s10, 2375680
    buffer_load_dword v32, v64, s[84:87], s10 offen
    s_mov_b32 s11, 2383872
    buffer_load_dword v33, v64, s[84:87], s11 offen
    s_mov_b32 s10, 2441216
    buffer_load_dword v34, v64, s[84:87], s10 offen
    s_mov_b32 s11, 2449408
    buffer_load_dword v35, v64, s[84:87], s11 offen
    s_waitcnt vmcnt(32)
    v_perm_b32 v68, v37, v36, s70
    v_perm_b32 v76, v37, v36, s71
    v_perm_b32 v69, v39, v38, s70
    v_perm_b32 v77, v39, v38, s71
    v_perm_b32 v70, v41, v40, s70
    v_perm_b32 v78, v41, v40, s71
    v_perm_b32 v71, v43, v42, s70
    v_perm_b32 v79, v43, v42, s71
    v_perm_b32 v72, v45, v44, s70
    v_perm_b32 v80, v45, v44, s71
    v_perm_b32 v73, v47, v46, s70
    v_perm_b32 v81, v47, v46, s71
    v_perm_b32 v74, v49, v48, s70
    v_perm_b32 v82, v49, v48, s71
    v_perm_b32 v75, v51, v50, s70
    v_perm_b32 v83, v51, v50, s71
    ds_write_b128 v18, v[68:71] offset:8192
    ds_write_b128 v18, v[72:75] offset:9216
    ds_write_b128 v18, v[76:79] offset:10240
    ds_write_b128 v18, v[80:83] offset:11264
    s_mov_b32 s10, 0
    buffer_load_dword v36, v65, s[88:91], s10 offen
    s_mov_b32 s11, 1280
    buffer_load_dword v37, v65, s[88:91], s11 offen
    s_mov_b32 s10, 40960
    buffer_load_dword v38, v65, s[88:91], s10 offen
    s_mov_b32 s11, 42240
    buffer_load_dword v39, v65, s[88:91], s11 offen
    s_mov_b32 s10, 2560
    buffer_load_dword v40, v65, s[88:91], s10 offen
    s_mov_b32 s11, 3840
    buffer_load_dword v41, v65, s[88:91], s11 offen
    s_mov_b32 s10, 43520
    buffer_load_dword v42, v65, s[88:91], s10 offen
    s_mov_b32 s11, 44800
    buffer_load_dword v43, v65, s[88:91], s11 offen
    s_mov_b32 s10, 20480
    buffer_load_dword v44, v65, s[88:91], s10 offen
    s_mov_b32 s11, 21760
    buffer_load_dword v45, v65, s[88:91], s11 offen
    s_mov_b32 s10, 61440
    buffer_load_dword v46, v65, s[88:91], s10 offen
    s_mov_b32 s11, 62720
    buffer_load_dword v47, v65, s[88:91], s11 offen
    s_mov_b32 s10, 23040
    buffer_load_dword v48, v65, s[88:91], s10 offen
    s_mov_b32 s11, 24320
    buffer_load_dword v49, v65, s[88:91], s11 offen
    s_mov_b32 s10, 64000
    buffer_load_dword v50, v65, s[88:91], s10 offen
    s_mov_b32 s11, 65280
    buffer_load_dword v51, v65, s[88:91], s11 offen
    s_waitcnt vmcnt(32)
    v_perm_b32 v68, v85, v84, s70
    v_perm_b32 v76, v85, v84, s71
    v_perm_b32 v69, v87, v86, s70
    v_perm_b32 v77, v87, v86, s71
    v_perm_b32 v70, v89, v88, s70
    v_perm_b32 v78, v89, v88, s71
    v_perm_b32 v71, v91, v90, s70
    v_perm_b32 v79, v91, v90, s71
    v_perm_b32 v72, v93, v92, s70
    v_perm_b32 v80, v93, v92, s71
    v_perm_b32 v73, v95, v94, s70
    v_perm_b32 v81, v95, v94, s71
    v_perm_b32 v74, v97, v96, s70
    v_perm_b32 v82, v97, v96, s71
    v_perm_b32 v75, v99, v98, s70
    v_perm_b32 v83, v99, v98, s71
    ds_write_b128 v18, v[68:71] offset:12288
    ds_write_b128 v18, v[72:75] offset:13312
    ds_write_b128 v18, v[76:79] offset:14336
    ds_write_b128 v18, v[80:83] offset:15360
    s_mov_b32 s10, 64
    buffer_load_dword v84, v65, s[88:91], s10 offen
    s_mov_b32 s11, 1344
    buffer_load_dword v85, v65, s[88:91], s11 offen
    s_mov_b32 s10, 41024
    buffer_load_dword v86, v65, s[88:91], s10 offen
    s_mov_b32 s11, 42304
    buffer_load_dword v87, v65, s[88:91], s11 offen
    s_mov_b32 s10, 2624
    buffer_load_dword v88, v65, s[88:91], s10 offen
    s_mov_b32 s11, 3904
    buffer_load_dword v89, v65, s[88:91], s11 offen
    s_mov_b32 s10, 43584
    buffer_load_dword v90, v65, s[88:91], s10 offen
    s_mov_b32 s11, 44864
    buffer_load_dword v91, v65, s[88:91], s11 offen
    s_mov_b32 s10, 20544
    buffer_load_dword v92, v65, s[88:91], s10 offen
    s_mov_b32 s11, 21824
    buffer_load_dword v93, v65, s[88:91], s11 offen
    s_mov_b32 s10, 61504
    buffer_load_dword v94, v65, s[88:91], s10 offen
    s_mov_b32 s11, 62784
    buffer_load_dword v95, v65, s[88:91], s11 offen
    s_mov_b32 s10, 23104
    buffer_load_dword v96, v65, s[88:91], s10 offen
    s_mov_b32 s11, 24384
    buffer_load_dword v97, v65, s[88:91], s11 offen
    s_mov_b32 s10, 64064
    buffer_load_dword v98, v65, s[88:91], s10 offen
    s_mov_b32 s11, 65344
    buffer_load_dword v99, v65, s[88:91], s11 offen
    s_waitcnt vmcnt(32)
    v_perm_b32 v68, v21, v20, s70
    v_perm_b32 v76, v21, v20, s71
    v_perm_b32 v69, v23, v22, s70
    v_perm_b32 v77, v23, v22, s71
    v_perm_b32 v70, v25, v24, s70
    v_perm_b32 v78, v25, v24, s71
    v_perm_b32 v71, v27, v26, s70
    v_perm_b32 v79, v27, v26, s71
    v_perm_b32 v72, v29, v28, s70
    v_perm_b32 v80, v29, v28, s71
    v_perm_b32 v73, v31, v30, s70
    v_perm_b32 v81, v31, v30, s71
    v_perm_b32 v74, v33, v32, s70
    v_perm_b32 v82, v33, v32, s71
    v_perm_b32 v75, v35, v34, s70
    v_perm_b32 v83, v35, v34, s71
    ds_write_b128 v18, v[68:71] offset:16384
    ds_write_b128 v18, v[72:75] offset:17408
    ds_write_b128 v18, v[76:79] offset:18432
    ds_write_b128 v18, v[80:83] offset:19456
    s_mov_b32 s10, 0
    buffer_load_dword v20, v66, s[88:91], s10 offen
    s_mov_b32 s11, 1280
    buffer_load_dword v21, v66, s[88:91], s11 offen
    s_mov_b32 s10, 40960
    buffer_load_dword v22, v66, s[88:91], s10 offen
    s_mov_b32 s11, 42240
    buffer_load_dword v23, v66, s[88:91], s11 offen
    s_mov_b32 s10, 2560
    buffer_load_dword v24, v66, s[88:91], s10 offen
    s_mov_b32 s11, 3840
    buffer_load_dword v25, v66, s[88:91], s11 offen
    s_mov_b32 s10, 43520
    buffer_load_dword v26, v66, s[88:91], s10 offen
    s_mov_b32 s11, 44800
    buffer_load_dword v27, v66, s[88:91], s11 offen
    s_mov_b32 s10, 20480
    buffer_load_dword v28, v66, s[88:91], s10 offen
    s_mov_b32 s11, 21760
    buffer_load_dword v29, v66, s[88:91], s11 offen
    s_mov_b32 s10, 61440
    buffer_load_dword v30, v66, s[88:91], s10 offen
    s_mov_b32 s11, 62720
    buffer_load_dword v31, v66, s[88:91], s11 offen
    s_mov_b32 s10, 23040
    buffer_load_dword v32, v66, s[88:91], s10 offen
    s_mov_b32 s11, 24320
    buffer_load_dword v33, v66, s[88:91], s11 offen
    s_mov_b32 s10, 64000
    buffer_load_dword v34, v66, s[88:91], s10 offen
    s_mov_b32 s11, 65280
    buffer_load_dword v35, v66, s[88:91], s11 offen
    s_waitcnt vmcnt(32)
    v_perm_b32 v176, v37, v36, s70
    v_perm_b32 v184, v37, v36, s71
    v_perm_b32 v177, v39, v38, s70
    v_perm_b32 v185, v39, v38, s71
    v_perm_b32 v178, v41, v40, s70
    v_perm_b32 v186, v41, v40, s71
    v_perm_b32 v179, v43, v42, s70
    v_perm_b32 v187, v43, v42, s71
    v_perm_b32 v180, v45, v44, s70
    v_perm_b32 v188, v45, v44, s71
    v_perm_b32 v181, v47, v46, s70
    v_perm_b32 v189, v47, v46, s71
    v_perm_b32 v182, v49, v48, s70
    v_perm_b32 v190, v49, v48, s71
    v_perm_b32 v183, v51, v50, s70
    v_perm_b32 v191, v51, v50, s71
    s_mov_b32 s10, 81920
    buffer_load_dword v36, v65, s[88:91], s10 offen
    s_mov_b32 s11, 83200
    buffer_load_dword v37, v65, s[88:91], s11 offen
    s_mov_b32 s10, 122880
    buffer_load_dword v38, v65, s[88:91], s10 offen
    s_mov_b32 s11, 124160
    buffer_load_dword v39, v65, s[88:91], s11 offen
    s_mov_b32 s10, 84480
    buffer_load_dword v40, v65, s[88:91], s10 offen
    s_mov_b32 s11, 85760
    buffer_load_dword v41, v65, s[88:91], s11 offen
    s_mov_b32 s10, 125440
    buffer_load_dword v42, v65, s[88:91], s10 offen
    s_mov_b32 s11, 126720
    buffer_load_dword v43, v65, s[88:91], s11 offen
    s_mov_b32 s10, 102400
    buffer_load_dword v44, v65, s[88:91], s10 offen
    s_mov_b32 s11, 103680
    buffer_load_dword v45, v65, s[88:91], s11 offen
    s_mov_b32 s10, 143360
    buffer_load_dword v46, v65, s[88:91], s10 offen
    s_mov_b32 s11, 144640
    buffer_load_dword v47, v65, s[88:91], s11 offen
    s_mov_b32 s10, 104960
    buffer_load_dword v48, v65, s[88:91], s10 offen
    s_mov_b32 s11, 106240
    buffer_load_dword v49, v65, s[88:91], s11 offen
    s_mov_b32 s10, 145920
    buffer_load_dword v50, v65, s[88:91], s10 offen
    s_mov_b32 s11, 147200
    buffer_load_dword v51, v65, s[88:91], s11 offen
    s_waitcnt vmcnt(32)
    v_perm_b32 v192, v85, v84, s70
    v_perm_b32 v200, v85, v84, s71
    v_perm_b32 v193, v87, v86, s70
    v_perm_b32 v201, v87, v86, s71
    v_perm_b32 v194, v89, v88, s70
    v_perm_b32 v202, v89, v88, s71
    v_perm_b32 v195, v91, v90, s70
    v_perm_b32 v203, v91, v90, s71
    v_perm_b32 v196, v93, v92, s70
    v_perm_b32 v204, v93, v92, s71
    v_perm_b32 v197, v95, v94, s70
    v_perm_b32 v205, v95, v94, s71
    v_perm_b32 v198, v97, v96, s70
    v_perm_b32 v206, v97, v96, s71
    v_perm_b32 v199, v99, v98, s70
    v_perm_b32 v207, v99, v98, s71
    s_mov_b32 s10, 81984
    buffer_load_dword v84, v65, s[88:91], s10 offen
    s_mov_b32 s11, 83264
    buffer_load_dword v85, v65, s[88:91], s11 offen
    s_mov_b32 s10, 122944
    buffer_load_dword v86, v65, s[88:91], s10 offen
    s_mov_b32 s11, 124224
    buffer_load_dword v87, v65, s[88:91], s11 offen
    s_mov_b32 s10, 84544
    buffer_load_dword v88, v65, s[88:91], s10 offen
    s_mov_b32 s11, 85824
    buffer_load_dword v89, v65, s[88:91], s11 offen
    s_mov_b32 s10, 125504
    buffer_load_dword v90, v65, s[88:91], s10 offen
    s_mov_b32 s11, 126784
    buffer_load_dword v91, v65, s[88:91], s11 offen
    s_mov_b32 s10, 102464
    buffer_load_dword v92, v65, s[88:91], s10 offen
    s_mov_b32 s11, 103744
    buffer_load_dword v93, v65, s[88:91], s11 offen
    s_mov_b32 s10, 143424
    buffer_load_dword v94, v65, s[88:91], s10 offen
    s_mov_b32 s11, 144704
    buffer_load_dword v95, v65, s[88:91], s11 offen
    s_mov_b32 s10, 105024
    buffer_load_dword v96, v65, s[88:91], s10 offen
    s_mov_b32 s11, 106304
    buffer_load_dword v97, v65, s[88:91], s11 offen
    s_mov_b32 s10, 145984
    buffer_load_dword v98, v65, s[88:91], s10 offen
    s_mov_b32 s11, 147264
    buffer_load_dword v99, v65, s[88:91], s11 offen
    s_waitcnt vmcnt(32)
    v_perm_b32 v208, v21, v20, s72
    v_perm_b32 v209, v23, v22, s72
    v_perm_b32 v210, v25, v24, s72
    v_perm_b32 v211, v27, v26, s72
    v_perm_b32 v212, v29, v28, s72
    v_perm_b32 v213, v31, v30, s72
    v_perm_b32 v214, v33, v32, s72
    v_perm_b32 v215, v35, v34, s72
    s_mov_b32 s10, 81920
    buffer_load_dword v20, v66, s[88:91], s10 offen
    s_mov_b32 s11, 83200
    buffer_load_dword v21, v66, s[88:91], s11 offen
    s_mov_b32 s10, 122880
    buffer_load_dword v22, v66, s[88:91], s10 offen
    s_mov_b32 s11, 124160
    buffer_load_dword v23, v66, s[88:91], s11 offen
    s_mov_b32 s10, 84480
    buffer_load_dword v24, v66, s[88:91], s10 offen
    s_mov_b32 s11, 85760
    buffer_load_dword v25, v66, s[88:91], s11 offen
    s_mov_b32 s10, 125440
    buffer_load_dword v26, v66, s[88:91], s10 offen
    s_mov_b32 s11, 126720
    buffer_load_dword v27, v66, s[88:91], s11 offen
    s_mov_b32 s10, 102400
    buffer_load_dword v28, v66, s[88:91], s10 offen
    s_mov_b32 s11, 103680
    buffer_load_dword v29, v66, s[88:91], s11 offen
    s_mov_b32 s10, 143360
    buffer_load_dword v30, v66, s[88:91], s10 offen
    s_mov_b32 s11, 144640
    buffer_load_dword v31, v66, s[88:91], s11 offen
    s_mov_b32 s10, 104960
    buffer_load_dword v32, v66, s[88:91], s10 offen
    s_mov_b32 s11, 106240
    buffer_load_dword v33, v66, s[88:91], s11 offen
    s_mov_b32 s10, 145920
    buffer_load_dword v34, v66, s[88:91], s10 offen
    s_mov_b32 s11, 147200
    buffer_load_dword v35, v66, s[88:91], s11 offen
    s_waitcnt vmcnt(32)
    v_perm_b32 v216, v37, v36, s70
    v_perm_b32 v224, v37, v36, s71
    v_perm_b32 v217, v39, v38, s70
    v_perm_b32 v225, v39, v38, s71
    v_perm_b32 v218, v41, v40, s70
    v_perm_b32 v226, v41, v40, s71
    v_perm_b32 v219, v43, v42, s70
    v_perm_b32 v227, v43, v42, s71
    v_perm_b32 v220, v45, v44, s70
    v_perm_b32 v228, v45, v44, s71
    v_perm_b32 v221, v47, v46, s70
    v_perm_b32 v229, v47, v46, s71
    v_perm_b32 v222, v49, v48, s70
    v_perm_b32 v230, v49, v48, s71
    v_perm_b32 v223, v51, v50, s70
    v_perm_b32 v231, v51, v50, s71
    s_waitcnt vmcnt(16)
    v_perm_b32 v232, v85, v84, s70
    v_perm_b32 v240, v85, v84, s71
    v_perm_b32 v233, v87, v86, s70
    v_perm_b32 v241, v87, v86, s71
    v_perm_b32 v234, v89, v88, s70
    v_perm_b32 v242, v89, v88, s71
    v_perm_b32 v235, v91, v90, s70
    v_perm_b32 v243, v91, v90, s71
    v_perm_b32 v236, v93, v92, s70
    v_perm_b32 v244, v93, v92, s71
    v_perm_b32 v237, v95, v94, s70
    v_perm_b32 v245, v95, v94, s71
    v_perm_b32 v238, v97, v96, s70
    v_perm_b32 v246, v97, v96, s71
    v_perm_b32 v239, v99, v98, s70
    v_perm_b32 v247, v99, v98, s71
    s_waitcnt vmcnt(0)
    v_perm_b32 v248, v21, v20, s72
    v_perm_b32 v249, v23, v22, s72
    v_perm_b32 v250, v25, v24, s72
    v_perm_b32 v251, v27, v26, s72
    v_perm_b32 v252, v29, v28, s72
    v_perm_b32 v253, v31, v30, s72
    v_perm_b32 v254, v33, v32, s72
    v_perm_b32 v255, v35, v34, s72
    s_load_dwordx2 s[10:11], s[0:1], 8
    v_and_b32 v60, 7, v0
    v_mul_u32_u24 v60, 1280, v60
    v_lshrrev_b32 v61, 4, v0
    v_lshlrev_b32 v61, 5, v61
    v_bfe_u32 v62, v0, 3, 1
    v_lshl_add_u32 v61, v62, 4, v61
    v_add_u32 v60, v60, v61
    s_xor_b32 s57, s49, 1
    s_mul_i32 s57, s57, 640
    v_add_u32 v61, s57, v60
    s_mul_i32 s56, s49, 640
    v_add_u32 v60, s56, v60
    s_waitcnt lgkmcnt(0)
    global_load_dwordx4 v[20:23], v60, s[10:11] offset:0
    global_load_dwordx4 v[40:43], v61, s[10:11] offset:0
    global_load_dwordx4 v[24:27], v60, s[10:11] offset:128
    global_load_dwordx4 v[44:47], v61, s[10:11] offset:128
    global_load_dwordx4 v[28:31], v60, s[10:11] offset:256
    global_load_dwordx4 v[48:51], v61, s[10:11] offset:256
    global_load_dwordx4 v[32:35], v60, s[10:11] offset:384
    global_load_dwordx4 v[52:55], v61, s[10:11] offset:384
    global_load_dwordx4 v[36:39], v60, s[10:11] offset:512
    global_load_dwordx4 v[56:59], v61, s[10:11] offset:512
    v_lshlrev_b32 v62, 5, v0
    v_add_u32 v62, 4, v62
    s_mov_b32 s41, 0
L_wi_5:
    s_mov_b64 exec, 0xff
    global_load_dword v63, v62, s[6:7] sc1
    s_waitcnt vmcnt(0)
    s_mov_b64 exec, -1
    v_readlane_b32 s10, v63, 0
    v_readlane_b32 s11, v63, 1
    s_add_u32 s10, s10, s11
    v_readlane_b32 s11, v63, 2
    s_add_u32 s10, s10, s11
    v_readlane_b32 s11, v63, 3
    s_add_u32 s10, s10, s11
    v_readlane_b32 s11, v63, 4
    s_add_u32 s10, s10, s11
    v_readlane_b32 s11, v63, 5
    s_add_u32 s10, s10, s11
    v_readlane_b32 s11, v63, 6
    s_add_u32 s10, s10, s11
    v_readlane_b32 s11, v63, 7
    s_add_u32 s10, s10, s11
    s_cmp_ge_u32 s10, 256
    s_cbranch_scc1 L_wiok_6
    s_sleep 4
    s_add_u32 s41, s41, 1
    s_cmp_lt_u32 s41, 262144
    s_cbranch_scc1 L_wi_5
    s_branch L_timeout
L_wiok_6:
    s_mov_b32 s41, 0
L_f0_7:
    global_load_dword v14, v17, s[36:37] sc1
    s_waitcnt vmcnt(0)
    v_cmp_gt_u32 vcc, 2, v14
    s_cbranch_vccz L_f0ok_8
    s_add_u32 s41, s41, 1
    s_cmp_lt_u32 s41, 262144
    s_cbranch_scc1 L_f0_7
    s_branch L_timeout
L_f0ok_8:
    s_lshl_b32 s10, s4, 14
    s_add_u32 s10, s10, 16777216
    s_add_u32 s32, s8, s10
    s_addc_u32 s33, s9, 0
    s_lshl_b32 s10, s5, 12
    s_add_u32 s64, s10, 0
    s_mov_b32 m0, s64
    s_nop 0
    global_load_lds_dwordx4 v16, s[32:33] offset:0 sc1
    global_load_lds_dwordx4 v16, s[32:33] offset:1024 sc1
    global_load_lds_dwordx4 v16, s[32:33] offset:2048 sc1
    global_load_lds_dwordx4 v16, s[32:33] offset:3072 sc1
    s_add_u32 s32, s32, 524288
    s_addc_u32 s33, s33, 0
    s_lshl_b32 s10, s4, 12
    s_add_u32 s10, s10, 8388608
    s_add_u32 s34, s8, s10
    s_addc_u32 s35, s9, 0
    s_mov_b32 s16, 0
    s_mov_b32 s40, 1
    v_mov_b64 v[60:61], 0
    v_mov_b64 v[62:63], 0
    v_mov_b64 v[64:65], 0
    v_mov_b64 v[66:67], 0
    v_mov_b64 v[68:69], 0
    v_mov_b64 v[70:71], 0
    v_mov_b64 v[72:73], 0
    v_mov_b64 v[74:75], 0
    v_mov_b64 v[76:77], 0
    v_mov_b64 v[78:79], 0
    v_mov_b64 v[80:81], 0
    v_mov_b64 v[82:83], 0
    s_waitcnt vmcnt(0) lgkmcnt(0)
    s_barrier
    s_and_b32 s10, s16, 1
    s_lshl_b32 s10, s10, 19
    s_lshl_b32 s11, s50, 13
    s_add_u32 s10, s10, s11
    s_lshl_b32 s11, s4, 14
    s_add_u32 s10, s10, s11
    s_lshl_b32 s11, s49, 12
    s_add_u32 s56, s10, s11
    s_xor_b32 s11, s11, 4096
    s_add_u32 s57, s10, s11
    s_add_u32 s18, s66, s56
    s_addc_u32 s19, s67, 0
    s_add_u32 s20, s66, s57
    s_addc_u32 s21, s67, 0
    s_lshr_b32 s38, s16, 1
    s_and_b32 s38, s38, 1
    s_and_b32 s39, s16, 1
    ds_read_b128 v[84:87], v18 offset:0
    ds_read_b128 v[88:91], v18 offset:1024
    ds_read_b128 v[92:95], v18 offset:2048
    ds_read_b128 v[96:99], v18 offset:3072
    s_branch L_have_m
L_step:
    ds_read_b128 v[84:87], v18 offset:0
    ds_read_b128 v[88:91], v18 offset:1024
    ds_read_b128 v[92:95], v18 offset:2048
    ds_read_b128 v[96:99], v18 offset:3072
    s_mov_b32 s41, 0
L_ap_9:
    global_load_dwordx4 v[20:23], v1, s[26:27] offset:-2048 sc1
    global_load_dwordx4 v[24:27], v1, s[26:27] offset:-1024 sc1
    global_load_dwordx4 v[28:31], v1, s[26:27] offset:0 sc1
    global_load_dwordx4 v[32:35], v1, s[26:27] offset:1024 sc1
    global_load_dwordx4 v[36:39], v1, s[26:27] offset:2048 sc1
    s_waitcnt vmcnt(0)
    v_max3_u32 v14, v20, v24, v28
    v_max3_u32 v14, v14, v32, v36
    v_cmp_eq_u32 vcc, -1, v14
    s_cbranch_vccz L_aok_10
    s_add_u32 s41, s41, 1
    s_cmp_lt_u32 s41, 262144
    s_cbranch_scc1 L_ap_9
    s_branch L_timeout
L_aok_10:
L_have_m:
    s_mov_b32 s65, 0
    s_cmp_eq_u32 s16, 0
    s_cbranch_scc1 L_norem_11
    global_load_dwordx4 v[40:43], v1, s[54:55] offset:-2048 sc1
    global_load_dwordx4 v[44:47], v1, s[54:55] offset:-1024 sc1
    global_load_dwordx4 v[48:51], v1, s[54:55] offset:0 sc1
    global_load_dwordx4 v[52:55], v1, s[54:55] offset:1024 sc1
    global_load_dwordx4 v[56:59], v1, s[54:55] offset:2048 sc1
L_norem_11:
    s_waitcnt lgkmcnt(2)
    v_smfmac_f32_16x16x64_bf16 v[76:79], v[20:23], v[84:91], v11
    ds_read_b128 v[84:87], v18 offset:4096
    ds_read_b128 v[88:91], v18 offset:5120
    v_smfmac_f32_16x16x64_bf16 v[60:63], v[20:23], a[0:7], v11
    s_waitcnt lgkmcnt(2)
    v_smfmac_f32_16x16x64_bf16 v[80:83], v[20:23], v[92:99], v11
    ds_read_b128 v[92:95], v18 offset:6144
    ds_read_b128 v[96:99], v18 offset:7168
    v_smfmac_f32_16x16x64_bf16 v[64:67], v[20:23], a[8:15], v11
    s_waitcnt lgkmcnt(2)
    v_smfmac_f32_16x16x64_bf16 v[76:79], v[24:27], v[84:91], v11
    ds_read_b128 v[84:87], v18 offset:8192
    ds_read_b128 v[88:91], v18 offset:9216
    v_smfmac_f32_16x16x64_bf16 v[60:63], v[24:27], a[16:23], v11
    s_waitcnt lgkmcnt(2)
    v_smfmac_f32_16x16x64_bf16 v[80:83], v[24:27], v[92:99], v11
    ds_read_b128 v[92:95], v18 offset:10240
    ds_read_b128 v[96:99], v18 offset:11264
    v_smfmac_f32_16x16x64_bf16 v[64:67], v[24:27], a[24:31], v11
    s_waitcnt lgkmcnt(2)
    v_smfmac_f32_16x16x64_bf16 v[76:79], v[28:31], v[84:91], v11
    ds_read_b128 v[84:87], v18 offset:12288
    ds_read_b128 v[88:91], v18 offset:13312
    v_smfmac_f32_16x16x64_bf16 v[60:63], v[28:31], a[32:39], v11
    s_waitcnt lgkmcnt(2)
    v_smfmac_f32_16x16x64_bf16 v[80:83], v[28:31], v[92:99], v11
    ds_read_b128 v[92:95], v18 offset:14336
    ds_read_b128 v[96:99], v18 offset:15360
    v_smfmac_f32_16x16x64_bf16 v[64:67], v[28:31], a[40:47], v11
    s_waitcnt lgkmcnt(2)
    v_smfmac_f32_16x16x64_bf16 v[76:79], v[32:35], v[84:91], v11
    ds_read_b128 v[84:87], v18 offset:16384
    ds_read_b128 v[88:91], v18 offset:17408
    v_smfmac_f32_16x16x64_bf16 v[60:63], v[32:35], a[48:55], v11
    s_waitcnt lgkmcnt(2)
    v_smfmac_f32_16x16x64_bf16 v[80:83], v[32:35], v[92:99], v11
    ds_read_b128 v[92:95], v18 offset:18432
    ds_read_b128 v[96:99], v18 offset:19456
    v_smfmac_f32_16x16x64_bf16 v[64:67], v[32:35], a[56:63], v11
    s_waitcnt lgkmcnt(2)
    v_smfmac_f32_16x16x64_bf16 v[76:79], v[36:39], v[84:91], v11
    v_smfmac_f32_16x16x64_bf16 v[60:63], v[36:39], a[64:71], v11
    s_waitcnt lgkmcnt(0)
    v_smfmac_f32_16x16x64_bf16 v[80:83], v[36:39], v[92:99], v11
    v_smfmac_f32_16x16x64_bf16 v[64:67], v[36:39], a[72:79], v11
    v_smfmac_f32_16x16x64_bf16 v[68:71], v[20:23], a[160:167], v11
    v_smfmac_f32_16x16x64_bf16 v[72:75], v[20:23], a[168:175], v11
    v_permlane32_swap_b32 v76, v80
    v_permlane32_swap_b32 v77, v81
    v_smfmac_f32_16x16x64_bf16 v[68:71], v[24:27], a[176:183], v11
    v_permlane32_swap_b32 v78, v82
    v_permlane32_swap_b32 v79, v83
    v_smfmac_f32_16x16x64_bf16 v[72:75], v[24:27], a[184:191], v11
    v_pk_add_f32 v[76:77], v[76:77], v[80:81]
    v_pk_add_f32 v[78:79], v[78:79], v[82:83]
    v_smfmac_f32_16x16x64_bf16 v[68:71], v[28:31], a[192:199], v11
    v_and_or_b32 v76, v76, -2, s38
    global_store_dwordx4 v2, v[76:79], s[18:19] sc1
    v_smfmac_f32_16x16x64_bf16 v[72:75], v[28:31], a[200:207], v11
    v_smfmac_f32_16x16x64_bf16 v[68:71], v[32:35], a[208:215], v11
    v_smfmac_f32_16x16x64_bf16 v[72:75], v[32:35], a[216:223], v11
    v_smfmac_f32_16x16x64_bf16 v[68:71], v[36:39], a[224:231], v11
    v_smfmac_f32_16x16x64_bf16 v[72:75], v[36:39], a[232:239], v11
    s_mov_b32 s41, 0
    s_cmp_eq_u32 s16, 0
    s_cbranch_scc1 L_bok_13
    s_waitcnt vmcnt(1)
    s_mov_b32 s41, 0
L_bp_12:
    v_max3_u32 v14, v40, v44, v48
    v_max3_u32 v14, v14, v52, v56
    v_cmp_eq_u32 vcc, -1, v14
    s_cbranch_vccz L_bok_13
    global_load_dwordx4 v[40:43], v1, s[54:55] offset:-2048 sc1
    global_load_dwordx4 v[44:47], v1, s[54:55] offset:-1024 sc1
    global_load_dwordx4 v[48:51], v1, s[54:55] offset:0 sc1
    global_load_dwordx4 v[52:55], v1, s[54:55] offset:1024 sc1
    global_load_dwordx4 v[56:59], v1, s[54:55] offset:2048 sc1
    s_waitcnt vmcnt(0)
    s_add_u32 s41, s41, 1
    s_cmp_lt_u32 s41, 262144
    s_cbranch_scc1 L_bp_12
    s_branch L_timeout
L_bok_13:
    v_smfmac_f32_16x16x64_bf16 v[60:63], v[40:43], a[80:87], v11
    v_smfmac_f32_16x16x64_bf16 v[64:67], v[40:43], a[88:95], v11
    ds_read_b128 v[84:87], v13 offset:0
    v_smfmac_f32_16x16x64_bf16 v[60:63], v[44:47], a[96:103], v11
    ds_read_b128 v[36:39], v13 offset:4096
    v_smfmac_f32_16x16x64_bf16 v[64:67], v[44:47], a[104:111], v11
    ds_read_b128 v[88:91], v13 offset:1024
    v_smfmac_f32_16x16x64_bf16 v[60:63], v[48:51], a[112:119], v11
    ds_read_b128 v[80:83], v13 offset:5120
    v_smfmac_f32_16x16x64_bf16 v[64:67], v[48:51], a[120:127], v11
    ds_read_b128 v[92:95], v13 offset:2048
    v_smfmac_f32_16x16x64_bf16 v[60:63], v[52:55], a[128:135], v11
    ds_read_b128 v[104:107], v13 offset:6144
    v_smfmac_f32_16x16x64_bf16 v[64:67], v[52:55], a[136:143], v11
    ds_read_b128 v[96:99], v13 offset:3072
    v_smfmac_f32_16x16x64_bf16 v[60:63], v[56:59], a[144:151], v11
    ds_read_b128 v[108:111], v13 offset:7168
    v_smfmac_f32_16x16x64_bf16 v[64:67], v[56:59], a[152:159], v11
    v_smfmac_f32_16x16x64_bf16 v[68:71], v[40:43], a[240:247], v11
    v_smfmac_f32_16x16x64_bf16 v[72:75], v[40:43], a[248:255], v11
    v_smfmac_f32_16x16x64_bf16 v[68:71], v[44:47], v[112:119], v11
    v_permlane32_swap_b32 v60, v64
    v_permlane32_swap_b32 v61, v65
    v_smfmac_f32_16x16x64_bf16 v[72:75], v[44:47], v[120:127], v11
    v_permlane32_swap_b32 v62, v66
    v_permlane32_swap_b32 v63, v67
    v_smfmac_f32_16x16x64_bf16 v[68:71], v[48:51], v[128:135], v11
    v_pk_add_f32 v[60:61], v[60:61], v[64:65]
    v_pk_add_f32 v[62:63], v[62:63], v[66:67]
    v_smfmac_f32_16x16x64_bf16 v[72:75], v[48:51], v[136:143], v11
    v_pk_mul_f32 v[60:61], v[60:61], s[52:53]
    v_pk_mul_f32 v[62:63], v[62:63], s[52:53]
    v_smfmac_f32_16x16x64_bf16 v[68:71], v[52:55], v[144:151], v11
    v_cvt_pk_bf16_f32 v64, v60, v61
    v_cvt_pk_bf16_f32 v65, v62, v63
    v_smfmac_f32_16x16x64_bf16 v[72:75], v[52:55], v[152:159], v11
    ds_write_b64 v8, v[64:65]
    v_smfmac_f32_16x16x64_bf16 v[68:71], v[56:59], v[160:167], v11
    v_smfmac_f32_16x16x64_bf16 v[72:75], v[56:59], v[168:175], v11
    s_nop 7
    v_permlane32_swap_b32 v68, v72
    v_permlane32_swap_b32 v69, v73
    v_permlane32_swap_b32 v70, v74
    v_permlane32_swap_b32 v71, v75
    v_pk_add_f32 v[68:69], v[68:69], v[72:73]
    v_pk_add_f32 v[70:71], v[70:71], v[74:75]
    v_cvt_pk_bf16_f32 v72, v68, v69
    v_cvt_pk_bf16_f32 v73, v70, v71
    ds_write_b64 v8, v[72:73] offset:576
    s_cmp_ge_u32 s16, 63
    s_cbranch_scc1 L_last
    global_load_dwordx4 v[100:103], v2, s[20:21] sc1
    s_cmp_eq_u32 s5, 3
    s_cbranch_scc0 L_w3l_14
    global_load_dword v15, v17, s[36:37] sc1
L_w3l_14:
    s_waitcnt lgkmcnt(0)
    s_barrier
    ds_read_b64_tr_b16 v[20:21], v7 offset:0
    ds_read_b64_tr_b16 v[22:23], v7 offset:16
    ds_read_b64_tr_b16 v[24:25], v7 offset:1152
    ds_read_b64_tr_b16 v[26:27], v7 offset:1168
    ds_read_b64_tr_b16 v[28:29], v7 offset:2304
    ds_read_b64_tr_b16 v[30:31], v7 offset:2320
    ds_read_b64_tr_b16 v[32:33], v7 offset:3456
    ds_read_b64_tr_b16 v[34:35], v7 offset:3472
    v_mov_b64 v[70:71], 0
    v_xor_b32 v13, 16384, v13
    s_waitcnt lgkmcnt(6)
    v_mfma_f32_16x16x32_bf16 v[44:47], v[84:87], v[20:23], 0
    v_mfma_f32_16x16x32_bf16 v[48:51], v[36:39], v[20:23], 0
    v_mfma_f32_16x16x32_bf16 v[40:43], v[20:23], v[20:23], 0
    s_waitcnt lgkmcnt(4)
    v_mfma_f32_16x16x32_bf16 v[44:47], v[88:91], v[24:27], v[44:47]
    v_mfma_f32_16x16x32_bf16 v[48:51], v[80:83], v[24:27], v[48:51]
    v_mfma_f32_16x16x32_bf16 v[40:43], v[24:27], v[24:27], v[40:43]
    s_waitcnt lgkmcnt(2)
    v_mfma_f32_16x16x32_bf16 v[44:47], v[92:95], v[28:31], v[44:47]
    v_mfma_f32_16x16x32_bf16 v[48:51], v[104:107], v[28:31], v[48:51]
    v_mfma_f32_16x16x32_bf16 v[40:43], v[28:31], v[28:31], v[40:43]
    s_waitcnt lgkmcnt(0)
    v_mfma_f32_16x16x32_bf16 v[44:47], v[96:99], v[32:35], v[44:47]
    v_mfma_f32_16x16x32_bf16 v[48:51], v[108:111], v[32:35], v[48:51]
    v_mfma_f32_16x16x32_bf16 v[40:43], v[32:35], v[32:35], v[40:43]
    s_mov_b32 s41, 0
    s_waitcnt vmcnt(0)
L_vp_15:
    v_xor_b32 v14, s38, v100
    v_and_b32 v14, 1, v14
    v_cmp_ne_u32 vcc, 0, v14
    s_cbranch_vccz L_vok_16
    global_load_dwordx4 v[100:103], v2, s[20:21] sc1
    s_waitcnt vmcnt(0)
    s_add_u32 s41, s41, 1
    s_cmp_lt_u32 s41, 262144
    s_cbranch_scc1 L_vp_15
    s_branch L_timeout
L_vok_16:
    s_cmp_eq_u32 s5, 3
    s_cbranch_scc0 L_w3ok_18
    s_add_u32 s10, s16, 3
    s_min_u32 s10, s10, 64
    s_mov_b32 s41, 0
L_w3_17:
    v_cmp_gt_u32 vcc, s10, v15
    s_cbranch_vccz L_w3ok_18
    global_load_dword v15, v17, s[36:37] sc1
    s_waitcnt vmcnt(0)
    s_add_u32 s41, s41, 1
    s_cmp_lt_u32 s41, 262144
    s_cbranch_scc1 L_w3_17
    s_branch L_timeout
L_w3ok_18:
    v_pk_add_f32 v[76:77], v[76:77], v[100:101]
    v_pk_add_f32 v[78:79], v[78:79], v[102:103]
    v_cvt_pk_bf16_f32 v68, v76, v77
    v_cvt_pk_bf16_f32 v69, v78, v79
    v_mov_b32 v102, v68
    v_mov_b32 v103, v69
    s_cmp_eq_u32 s49, 0
    s_cbranch_scc0 L_pk_19
    v_mov_b32 v102, v72
    v_mov_b32 v103, v73
L_pk_19:
    s_cmp_ge_u32 s16, 63
    s_cbranch_scc1 L_nodma_20
    s_xor_b32 s64, s64, 16384
    s_mov_b32 m0, s64
    s_nop 0
    global_load_lds_dwordx4 v16, s[32:33] offset:0 sc1
    global_load_lds_dwordx4 v16, s[32:33] offset:1024 sc1
    global_load_lds_dwordx4 v16, s[32:33] offset:2048 sc1
    global_load_lds_dwordx4 v16, s[32:33] offset:3072 sc1
    s_add_u32 s32, s32, 524288
    s_addc_u32 s33, s33, 0
L_nodma_20:
    ds_read_b128 v[20:23], v12
    ds_read_b128 v[24:27], v12 offset:1024
    v_permlane32_swap_b32 v70, v68
    v_permlane32_swap_b32 v71, v69
L_exp:
    v_exp_f32 v52, v44
    v_exp_f32 v53, v45
    v_exp_f32 v54, v46
    v_exp_f32 v55, v47
    v_exp_f32 v56, v48
    v_exp_f32 v57, v49
    v_exp_f32 v58, v50
    v_exp_f32 v59, v51
    v_exp_f32 v60, v40
    v_exp_f32 v61, v41
    v_exp_f32 v62, v42
    v_exp_f32 v63, v43
    v_cvt_pk_bf16_f32 v64, v52, v53
    v_cvt_pk_bf16_f32 v65, v54, v55
    v_cvt_pk_bf16_f32 v66, v56, v57
    v_cvt_pk_bf16_f32 v67, v58, v59
    v_cvt_pk_bf16_f32 v72, v60, v61
    v_cvt_pk_bf16_f32 v73, v62, v63
    s_waitcnt lgkmcnt(0)
    v_mfma_f32_16x16x32_bf16 v[28:31], v[20:23], v[64:67], 0
    v_cndmask_b32 v72, 0, v72, s[42:43]
    v_cndmask_b32 v73, 0, v73, s[42:43]
    v_mfma_f32_16x16x32_bf16 v[32:35], v[24:27], v[64:67], 0
    v_add_f32 v14, v60, v61
    v_add_f32 v15, v62, v63
    v_mfma_f32_16x16x16_bf16 v[28:31], v[70:71], v[72:73], v[28:31]
    v_add_f32 v14, v14, v15
    v_pk_add_f32 v[96:97], v[52:53], v[54:55]
    v_mfma_f32_16x16x16_bf16 v[32:35], v[68:69], v[72:73], v[32:35]
    v_cndmask_b32 v14, 0, v14, s[42:43]
    v_pk_add_f32 v[98:99], v[56:57], v[58:59]
    v_pk_add_f32 v[96:97], v[96:97], v[98:99]
    v_add_f32 v14, v14, v96
    v_add_f32 v14, v14, v97
    s_nop 2
    v_cvt_pk_bf16_f32 v96, v28, v32
    v_cvt_pk_bf16_f32 v97, v29, v33
    v_cvt_pk_bf16_f32 v98, v30, v34
    v_cvt_pk_bf16_f32 v99, v31, v35
    ds_write_b128 v9, v[96:99]
    v_mov_b32 v15, v14
    s_nop 1
    v_permlane32_swap_b32 v14, v15
    v_add_f32 v14, v14, v15
    v_mov_b32 v15, v14
    s_nop 1
    v_permlane16_swap_b32 v14, v15
    v_add_f32 v14, v14, v15
    v_subrev_u32 v15, 729808896, v14
    v_rcp_f32 v14, v14
    v_cmp_lt_u32 vcc, 671088640, v15
    s_and_b64 vcc, vcc, s[44:45]
    s_cbranch_vccnz L_slow
L_norm:
    global_store_dwordx2 v10, v[102:103], s[34:35] sc1
    s_cmp_eq_u32 s48, 0
    s_cbranch_scc1 L_norr_21
    s_add_u32 s10, s40, 1
    s_cmp_eq_u32 s10, 3
    s_cselect_b32 s10, 0, s10
    s_lshl_b32 s11, s10, 14
    s_add_u32 s60, s92, s11
    s_addc_u32 s61, s93, 0
    s_lshl_b32 s11, s10, 13
    s_add_u32 s30, s68, s11
    s_addc_u32 s31, s69, 0
    v_mov_b32 v15, -1
    s_mov_b64 exec, s[46:47]
    global_store_dword v6, v15, s[60:61] sc1
    global_store_dword v6, v15, s[30:31]
    s_mov_b64 exec, -1
L_norr_21:
    s_waitcnt lgkmcnt(0)
    s_barrier
    ds_read_b128 v[84:87], v1 offset:37376
    ds_read_b128 v[88:91], v1 offset:38400
    ds_bpermute_b32 v92, v19, v14 offset:0
    ds_bpermute_b32 v93, v19, v14 offset:4
    ds_bpermute_b32 v94, v19, v14 offset:8
    ds_bpermute_b32 v95, v19, v14 offset:12
    v_mov_b64 v[36:37], 0
    v_mov_b64 v[38:39], 0
    v_mov_b64 v[40:41], 0
    v_mov_b64 v[42:43], 0
    v_mov_b64 v[44:45], 0
    v_mov_b64 v[46:47], 0
    v_mov_b64 v[48:49], 0
    v_mov_b64 v[50:51], 0
    v_mov_b64 v[52:53], 0
    v_mov_b64 v[54:55], 0
    v_mov_b64 v[56:57], 0
    v_mov_b64 v[58:59], 0
    v_xor_b32 v12, 16384, v12
    s_cmp_eq_u32 s16, 0
    s_cbranch_scc1 L_nokf_22
    s_cmp_eq_u32 s5, 0
    s_cbranch_scc0 L_nokf_22
    v_mov_b32 v96, s17
    v_mov_b32 v97, s16
    s_mov_b64 exec, 1
    global_store_dword v96, v97, s[36:37] sc1
    s_mov_b64 exec, -1
L_nokf_22:
    s_waitcnt lgkmcnt(5)
    v_smfmac_f32_16x16x64_bf16 v[36:39], v[84:87], v[176:183], v11
    v_smfmac_f32_16x16x64_bf16 v[40:43], v[84:87], v[184:191], v11
    v_smfmac_f32_16x16x64_bf16 v[44:47], v[84:87], v[192:199], v11
    v_smfmac_f32_16x16x64_bf16 v[48:51], v[84:87], v[200:207], v11
    v_smfmac_f32_16x16x64_bf16 v[52:55], v[84:87], v[208:215], v11
    s_waitcnt lgkmcnt(4)
    v_smfmac_f32_16x16x64_bf16 v[36:39], v[88:91], v[216:223], v11
    v_smfmac_f32_16x16x64_bf16 v[40:43], v[88:91], v[224:231], v11
    v_smfmac_f32_16x16x64_bf16 v[44:47], v[88:91], v[232:239], v11
    v_smfmac_f32_16x16x64_bf16 v[48:51], v[88:91], v[240:247], v11
    v_smfmac_f32_16x16x64_bf16 v[52:55], v[88:91], v[248:255], v11
    s_waitcnt lgkmcnt(0)
    v_permlane32_swap_b32 v36, v40
    v_permlane32_swap_b32 v37, v41
    v_permlane32_swap_b32 v38, v42
    v_permlane32_swap_b32 v39, v43
    v_pk_add_f32 v[36:37], v[36:37], v[40:41]
    v_pk_add_f32 v[38:39], v[38:39], v[42:43]
    v_pk_mul_f32 v[36:37], v[36:37], v[92:93]
    v_pk_mul_f32 v[38:39], v[38:39], v[94:95]
    v_and_or_b32 v36, v36, -2, s39
    global_store_dwordx4 v3, v[36:39], s[22:23]
    v_permlane32_swap_b32 v44, v48
    v_permlane32_swap_b32 v45, v49
    v_permlane32_swap_b32 v46, v50
    v_permlane32_swap_b32 v47, v51
    v_pk_add_f32 v[44:45], v[44:45], v[48:49]
    v_pk_add_f32 v[46:47], v[46:47], v[50:51]
    v_pk_mul_f32 v[44:45], v[44:45], v[92:93]
    v_pk_mul_f32 v[46:47], v[46:47], v[94:95]
    v_and_or_b32 v44, v44, -2, s39
    global_store_dwordx4 v3, v[44:47], s[24:25]
    v_permlane32_swap_b32 v52, v56
    v_permlane32_swap_b32 v53, v57
    v_permlane32_swap_b32 v54, v58
    v_permlane32_swap_b32 v55, v59
    v_pk_add_f32 v[52:53], v[52:53], v[56:57]
    v_pk_add_f32 v[54:55], v[54:55], v[58:59]
    v_pk_mul_f32 v[52:53], v[52:53], v[92:93]
    v_pk_mul_f32 v[54:55], v[54:55], v[94:95]
    v_and_or_b32 v52, v52, -2, s39
    s_mov_b64 exec, s[74:75]
    global_store_dwordx4 v4, v[52:55], s[22:23]
    s_mov_b64 exec, -1
    v_mov_b64 v[60:61], 0
    v_mov_b64 v[62:63], 0
    v_mov_b64 v[64:65], 0
    v_mov_b64 v[66:67], 0
    v_mov_b64 v[68:69], 0
    v_mov_b64 v[70:71], 0
    v_mov_b64 v[72:73], 0
    v_mov_b64 v[74:75], 0
    v_mov_b64 v[76:77], 0
    v_mov_b64 v[78:79], 0
    v_mov_b64 v[80:81], 0
    v_mov_b64 v[82:83], 0
    s_lshl_b32 s10, s40, 13
    s_add_u32 s58, s68, s10
    s_addc_u32 s59, s69, 0
    s_add_u32 s26, s58, 2048
    s_addc_u32 s27, s59, 0
    s_lshl_b32 s10, s40, 14
    s_add_u32 s28, s92, s10
    s_addc_u32 s29, s93, 0
    s_add_u32 s54, s94, s10
    s_addc_u32 s55, s95, 0
    s_add_u32 s54, s54, 2048
    s_addc_u32 s55, s55, 0
    s_mov_b32 s51, s39
    s_add_u32 s16, s16, 1
    s_add_u32 s34, s34, 131072
    s_addc_u32 s35, s35, 0
    s_and_b32 s10, s16, 1
    s_lshl_b32 s10, s10, 19
    s_lshl_b32 s11, s50, 13
    s_add_u32 s10, s10, s11
    s_lshl_b32 s11, s4, 14
    s_add_u32 s10, s10, s11
    s_lshl_b32 s11, s49, 12
    s_add_u32 s56, s10, s11
    s_xor_b32 s11, s11, 4096
    s_add_u32 s57, s10, s11
    s_add_u32 s18, s66, s56
    s_addc_u32 s19, s67, 0
    s_add_u32 s20, s66, s57
    s_addc_u32 s21, s67, 0
    s_lshr_b32 s38, s16, 1
    s_and_b32 s38, s38, 1
    s_and_b32 s39, s16, 1
    s_add_u32 s40, s40, 1
    s_cmp_eq_u32 s40, 3
    s_cselect_b32 s40, 0, s40
    s_cmp_eq_u32 s48, 0
    s_cbranch_scc0 L_nr2_26
    s_waitcnt vmcnt(0)
    s_branch L_nored_23
L_nr2_26:
    s_nop 15
    s_nop 15
    s_nop 15
    s_nop 15
    s_mov_b32 s41, 0
L_rp_24:
    global_load_dwordx4 v[20:23], v5, s[22:23] offset:0 sc1
    global_load_dwordx4 v[24:27], v5, s[22:23] offset:1024 sc1
    global_load_dwordx4 v[28:31], v5, s[22:23] offset:2048 sc1
    global_load_dwordx4 v[32:35], v5, s[22:23] offset:3072 sc1
    s_waitcnt vmcnt(0)
    v_bitop3_b32 v14, v20, v24, s51 bitop3:0x7e
    v_bitop3_b32 v15, v28, v32, s51 bitop3:0x7e
    v_or_b32 v14, v14, v15
    v_and_b32 v14, 1, v14
    v_cmp_ne_u32 vcc, 0, v14
    s_cbranch_vccz L_rok_25
    s_add_u32 s41, s41, 1
    s_cmp_lt_u32 s41, 262144
    s_cbranch_scc1 L_rp_24
    s_branch L_timeout
L_rok_25:
    v_pk_add_f32 v[20:21], v[20:21], v[24:25]
    v_pk_add_f32 v[28:29], v[28:29], v[32:33]
    v_pk_add_f32 v[22:23], v[22:23], v[26:27]
    v_pk_add_f32 v[30:31], v[30:31], v[34:35]
    v_pk_add_f32 v[20:21], v[20:21], v[28:29]
    v_pk_add_f32 v[22:23], v[22:23], v[30:31]
    s_nop 0
    v_permlane32_swap_b32 v20, v21
    v_permlane32_swap_b32 v22, v23
    v_add_f32 v20, v20, v21
    v_add_f32 v22, v22, v23
    s_nop 1
    v_permlane16_swap_b32 v20, v22
    v_add_f32 v20, v20, v22
    s_nop 1
    v_add_f32_dpp v20, v20, v20 row_ror:8 row_mask:0xf bank_mask:0xf
    s_nop 1
    v_mov_b32_dpp v21, v20 row_shl:4 row_mask:0xf bank_mask:0xf
    v_cvt_pk_bf16_f32 v20, v20, v21
    s_mov_b64 exec, s[46:47]
    global_store_dword v6, v20, s[28:29] sc1
    global_store_dword v6, v20, s[58:59]
    s_mov_b64 exec, -1
L_nored_23:
    s_barrier
    s_branch L_step
L_slow:
    s_cmp_eq_u32 s65, 1
    s_cbranch_scc1 L_norm
    s_mov_b32 s65, 1
    v_max3_f32 v14, v40, v41, v42
    v_max_f32 v14, v14, v43
    v_mov_b32 v15, 0xff800000
    v_cndmask_b32 v14, v15, v14, s[42:43]
    v_max3_f32 v14, v14, v44, v45
    v_max3_f32 v14, v14, v46, v47
    v_max3_f32 v14, v14, v48, v49
    v_max3_f32 v14, v14, v50, v51
    v_mov_b32 v15, v14
    s_nop 1
    v_permlane32_swap_b32 v14, v15
    v_max_f32 v14, v14, v15
    v_mov_b32 v15, v14
    s_nop 1
    v_permlane16_swap_b32 v14, v15
    v_max_f32 v14, v14, v15
    v_sub_f32 v40, v40, v14
    v_sub_f32 v41, v41, v14
    v_sub_f32 v42, v42, v14
    v_sub_f32 v43, v43, v14
    v_sub_f32 v44, v44, v14
    v_sub_f32 v45, v45, v14
    v_sub_f32 v46, v46, v14
    v_sub_f32 v47, v47, v14
    v_sub_f32 v48, v48, v14
    v_sub_f32 v49, v49, v14
    v_sub_f32 v50, v50, v14
    v_sub_f32 v51, v51, v14
    s_branch L_exp
L_last:
    global_load_dwordx4 v[100:103], v2, s[20:21] sc1
    s_mov_b32 s41, 0
    s_waitcnt vmcnt(0)
L_lvp_27:
    v_xor_b32 v14, s38, v100
    v_and_b32 v14, 1, v14
    v_cmp_ne_u32 vcc, 0, v14
    s_cbranch_vccz L_lvok_28
    global_load_dwordx4 v[100:103], v2, s[20:21] sc1
    s_waitcnt vmcnt(0)
    s_add_u32 s41, s41, 1
    s_cmp_lt_u32 s41, 262144
    s_cbranch_scc1 L_lvp_27
    s_branch L_timeout
L_lvok_28:
    v_pk_add_f32 v[76:77], v[76:77], v[100:101]
    v_pk_add_f32 v[78:79], v[78:79], v[102:103]
    v_cvt_pk_bf16_f32 v68, v76, v77
    v_cvt_pk_bf16_f32 v69, v78, v79
    s_cmp_eq_u32 s49, 1
    s_cbranch_scc0 L_pubk2_30
    global_store_dwordx2 v10, v[68:69], s[34:35] sc1
    s_branch L_pubv2_29
L_pubk2_30:
    global_store_dwordx2 v10, v[72:73], s[34:35] sc1
L_pubv2_29:
    s_waitcnt vmcnt(0)
    s_barrier
    v_mov_b32 v14, s17
    v_mov_b32 v15, 64
    s_cmp_eq_u32 s5, 0
    s_cbranch_scc0 L_lastdone
    s_mov_b64 exec, 1
    global_store_dword v14, v15, s[36:37] sc1
    s_mov_b64 exec, -1
L_lastdone:
    s_waitcnt vmcnt(0)
    s_endpgm
L_kp:
    s_add_u32 s22, s8, 5767168
    s_addc_u32 s23, s9, 0
    s_lshl_b32 s29, s4, 7
    s_add_u32 s29, s29, 0
    s_mov_b32 s30, 0
    s_cmp_eq_u32 s5, 0
    s_cbranch_scc0 L_fl_31
    v_mov_b32 v5, s29
    v_mov_b32 v6, s30
    s_mov_b64 exec, 1
    global_store_dword v5, v6, s[22:23] sc1
    s_mov_b64 exec, -1
L_fl_31:
    s_waitcnt vmcnt(0)
    s_barrier
    s_cmp_eq_u32 s5, 0
    s_cbranch_scc0 L_si_32
    s_lshl_b32 s10, s3, 5
    s_add_u32 s10, s10, 4
    v_mov_b32 v5, s10
    v_mov_b32 v6, 1
    s_mov_b64 exec, 1
    global_atomic_add v5, v6, s[6:7]
    s_mov_b64 exec, -1
L_si_32:
    s_load_dwordx2 s[16:17], s[0:1], 0
    v_lshlrev_b32 v1, 4, v0
    v_lshrrev_b32 v5, 3, v0
    v_and_b32 v6, 7, v0
    v_xor_b32 v6, v6, v5
    s_lshl_b32 s10, s5, 3
    v_add_u32 v5, s10, v5
    v_mul_u32_u24 v2, 1280, v5
    v_lshl_add_u32 v2, v6, 4, v2
    v_and_b32 v5, 7, v0
    v_bfe_u32 v6, v0, 3, 1
    v_mul_u32_u24 v3, 10240, v6
    v_lshl_add_u32 v3, v5, 7, v3
    v_lshrrev_b32 v6, 4, v0
    v_xor_b32 v14, v6, v5
    v_xor_b32 v6, 4, v14
    v_lshl_add_u32 v15, v6, 4, v3
    v_lshl_add_u32 v14, v14, 4, v3
    s_waitcnt lgkmcnt(0)
    s_mov_b32 s31, 0
    s_mul_i32 s13, s5, 10240
    s_add_u32 s13, s13, s31
    s_add_u32 m0, s13, 0
    s_nop 0
    global_load_lds_dwordx4 v2, s[16:17] offset:0
    s_add_u32 m0, s13, 896
    s_nop 0
    global_load_lds_dwordx4 v2, s[16:17] offset:128
    s_add_u32 m0, s13, 1792
    s_nop 0
    global_load_lds_dwordx4 v2, s[16:17] offset:256
    s_add_u32 m0, s13, 2688
    s_nop 0
    global_load_lds_dwordx4 v2, s[16:17] offset:384
    s_add_u32 m0, s13, 3584
    s_nop 0
    global_load_lds_dwordx4 v2, s[16:17] offset:512
    s_add_u32 m0, s13, 4480
    s_nop 0
    global_load_lds_dwordx4 v2, s[16:17] offset:640
    s_add_u32 m0, s13, 5376
    s_nop 0
    global_load_lds_dwordx4 v2, s[16:17] offset:768
    s_add_u32 m0, s13, 6272
    s_nop 0
    global_load_lds_dwordx4 v2, s[16:17] offset:896
    s_add_u32 m0, s13, 7168
    s_nop 0
    global_load_lds_dwordx4 v2, s[16:17] offset:1024
    s_add_u32 m0, s13, 8064
    s_nop 0
    global_load_lds_dwordx4 v2, s[16:17] offset:1152
    s_lshl_b32 s30, s4, 8
    s_lshl_b32 s31, s5, 6
    s_add_u32 s30, s30, s31
    s_load_dwordx2 s[10:11], s[0:1], 24
    v_and_b32 v9, 15, v0
    v_lshrrev_b32 v10, 4, v0
    v_lshlrev_b32 v10, 3, v10
    s_mov_b32 s12, 8192
    v_mul_lo_u32 v8, v10, s12
    v_lshl_add_u32 v8, v9, 2, v8
    v_add_u32 v8, s30, v8
    s_mov_b32 s24, 0x05040100
    s_mov_b32 s25, 0x07060302
    s_waitcnt lgkmcnt(0)
    s_mov_b32 s76, s10
    s_and_b32 s77, s11, 0xffff
    s_mov_b32 s78, 5242880
    s_mov_b32 s79, 0x20000
    s_mov_b32 s10, 0
    buffer_load_dword v64, v8, s[76:79], s10 offen
    s_mov_b32 s11, 8192
    buffer_load_dword v65, v8, s[76:79], s11 offen
    s_mov_b32 s10, 16384
    buffer_load_dword v66, v8, s[76:79], s10 offen
    s_mov_b32 s11, 24576
    buffer_load_dword v67, v8, s[76:79], s11 offen
    s_mov_b32 s10, 32768
    buffer_load_dword v68, v8, s[76:79], s10 offen
    s_mov_b32 s11, 40960
    buffer_load_dword v69, v8, s[76:79], s11 offen
    s_mov_b32 s10, 49152
    buffer_load_dword v70, v8, s[76:79], s10 offen
    s_mov_b32 s11, 57344
    buffer_load_dword v71, v8, s[76:79], s11 offen
    s_mov_b32 s10, 262144
    buffer_load_dword v72, v8, s[76:79], s10 offen
    s_mov_b32 s11, 270336
    buffer_load_dword v73, v8, s[76:79], s11 offen
    s_mov_b32 s10, 278528
    buffer_load_dword v74, v8, s[76:79], s10 offen
    s_mov_b32 s11, 286720
    buffer_load_dword v75, v8, s[76:79], s11 offen
    s_mov_b32 s10, 294912
    buffer_load_dword v76, v8, s[76:79], s10 offen
    s_mov_b32 s11, 303104
    buffer_load_dword v77, v8, s[76:79], s11 offen
    s_mov_b32 s10, 311296
    buffer_load_dword v78, v8, s[76:79], s10 offen
    s_mov_b32 s11, 319488
    buffer_load_dword v79, v8, s[76:79], s11 offen
    s_mov_b32 s10, 524288
    buffer_load_dword v96, v8, s[76:79], s10 offen
    s_mov_b32 s11, 532480
    buffer_load_dword v97, v8, s[76:79], s11 offen
    s_mov_b32 s10, 540672
    buffer_load_dword v98, v8, s[76:79], s10 offen
    s_mov_b32 s11, 548864
    buffer_load_dword v99, v8, s[76:79], s11 offen
    s_mov_b32 s10, 557056
    buffer_load_dword v100, v8, s[76:79], s10 offen
    s_mov_b32 s11, 565248
    buffer_load_dword v101, v8, s[76:79], s11 offen
    s_mov_b32 s10, 573440
    buffer_load_dword v102, v8, s[76:79], s10 offen
    s_mov_b32 s11, 581632
    buffer_load_dword v103, v8, s[76:79], s11 offen
    s_mov_b32 s10, 786432
    buffer_load_dword v104, v8, s[76:79], s10 offen
    s_mov_b32 s11, 794624
    buffer_load_dword v105, v8, s[76:79], s11 offen
    s_mov_b32 s10, 802816
    buffer_load_dword v106, v8, s[76:79], s10 offen
    s_mov_b32 s11, 811008
    buffer_load_dword v107, v8, s[76:79], s11 offen
    s_mov_b32 s10, 819200
    buffer_load_dword v108, v8, s[76:79], s10 offen
    s_mov_b32 s11, 827392
    buffer_load_dword v109, v8, s[76:79], s11 offen
    s_mov_b32 s10, 835584
    buffer_load_dword v110, v8, s[76:79], s10 offen
    s_mov_b32 s11, 843776
    buffer_load_dword v111, v8, s[76:79], s11 offen
    s_mov_b32 s10, 1048576
    buffer_load_dword v128, v8, s[76:79], s10 offen
    s_mov_b32 s11, 1056768
    buffer_load_dword v129, v8, s[76:79], s11 offen
    s_mov_b32 s10, 1064960
    buffer_load_dword v130, v8, s[76:79], s10 offen
    s_mov_b32 s11, 1073152
    buffer_load_dword v131, v8, s[76:79], s11 offen
    s_mov_b32 s10, 1081344
    buffer_load_dword v132, v8, s[76:79], s10 offen
    s_mov_b32 s11, 1089536
    buffer_load_dword v133, v8, s[76:79], s11 offen
    s_mov_b32 s10, 1097728
    buffer_load_dword v134, v8, s[76:79], s10 offen
    s_mov_b32 s11, 1105920
    buffer_load_dword v135, v8, s[76:79], s11 offen
    s_mov_b32 s10, 1310720
    buffer_load_dword v136, v8, s[76:79], s10 offen
    s_mov_b32 s11, 1318912
    buffer_load_dword v137, v8, s[76:79], s11 offen
    s_mov_b32 s10, 1327104
    buffer_load_dword v138, v8, s[76:79], s10 offen
    s_mov_b32 s11, 1335296
    buffer_load_dword v139, v8, s[76:79], s11 offen
    s_mov_b32 s10, 1343488
    buffer_load_dword v140, v8, s[76:79], s10 offen
    s_mov_b32 s11, 1351680
    buffer_load_dword v141, v8, s[76:79], s11 offen
    s_mov_b32 s10, 1359872
    buffer_load_dword v142, v8, s[76:79], s10 offen
    s_mov_b32 s11, 1368064
    buffer_load_dword v143, v8, s[76:79], s11 offen
    s_waitcnt vmcnt(32)
    v_perm_b32 v11, v65, v64, s24
    v_accvgpr_write_b32 a0, v11
    v_perm_b32 v12, v67, v66, s24
    v_accvgpr_write_b32 a1, v12
    v_perm_b32 v11, v69, v68, s24
    v_accvgpr_write_b32 a2, v11
    v_perm_b32 v12, v71, v70, s24
    v_accvgpr_write_b32 a3, v12
    v_perm_b32 v11, v65, v64, s25
    v_accvgpr_write_b32 a4, v11
    v_perm_b32 v12, v67, v66, s25
    v_accvgpr_write_b32 a5, v12
    v_perm_b32 v11, v69, v68, s25
    v_accvgpr_write_b32 a6, v11
    v_perm_b32 v12, v71, v70, s25
    v_accvgpr_write_b32 a7, v12
    v_perm_b32 v11, v73, v72, s24
    v_accvgpr_write_b32 a8, v11
    v_perm_b32 v12, v75, v74, s24
    v_accvgpr_write_b32 a9, v12
    v_perm_b32 v11, v77, v76, s24
    v_accvgpr_write_b32 a10, v11
    v_perm_b32 v12, v79, v78, s24
    v_accvgpr_write_b32 a11, v12
    v_perm_b32 v11, v73, v72, s25
    v_accvgpr_write_b32 a12, v11
    v_perm_b32 v12, v75, v74, s25
    v_accvgpr_write_b32 a13, v12
    v_perm_b32 v11, v77, v76, s25
    v_accvgpr_write_b32 a14, v11
    v_perm_b32 v12, v79, v78, s25
    v_accvgpr_write_b32 a15, v12
    s_mov_b32 s10, 1572864
    buffer_load_dword v64, v8, s[76:79], s10 offen
    s_mov_b32 s11, 1581056
    buffer_load_dword v65, v8, s[76:79], s11 offen
    s_mov_b32 s10, 1589248
    buffer_load_dword v66, v8, s[76:79], s10 offen
    s_mov_b32 s11, 1597440
    buffer_load_dword v67, v8, s[76:79], s11 offen
    s_mov_b32 s10, 1605632
    buffer_load_dword v68, v8, s[76:79], s10 offen
    s_mov_b32 s11, 1613824
    buffer_load_dword v69, v8, s[76:79], s11 offen
    s_mov_b32 s10, 1622016
    buffer_load_dword v70, v8, s[76:79], s10 offen
    s_mov_b32 s11, 1630208
    buffer_load_dword v71, v8, s[76:79], s11 offen
    s_mov_b32 s10, 1835008
    buffer_load_dword v72, v8, s[76:79], s10 offen
    s_mov_b32 s11, 1843200
    buffer_load_dword v73, v8, s[76:79], s11 offen
    s_mov_b32 s10, 1851392
    buffer_load_dword v74, v8, s[76:79], s10 offen
    s_mov_b32 s11, 1859584
    buffer_load_dword v75, v8, s[76:79], s11 offen
    s_mov_b32 s10, 1867776
    buffer_load_dword v76, v8, s[76:79], s10 offen
    s_mov_b32 s11, 1875968
    buffer_load_dword v77, v8, s[76:79], s11 offen
    s_mov_b32 s10, 1884160
    buffer_load_dword v78, v8, s[76:79], s10 offen
    s_mov_b32 s11, 1892352
    buffer_load_dword v79, v8, s[76:79], s11 offen
    s_waitcnt vmcnt(32)
    v_perm_b32 v11, v97, v96, s24
    v_accvgpr_write_b32 a16, v11
    v_perm_b32 v12, v99, v98, s24
    v_accvgpr_write_b32 a17, v12
    v_perm_b32 v11, v101, v100, s24
    v_accvgpr_write_b32 a18, v11
    v_perm_b32 v12, v103, v102, s24
    v_accvgpr_write_b32 a19, v12
    v_perm_b32 v11, v97, v96, s25
    v_accvgpr_write_b32 a20, v11
    v_perm_b32 v12, v99, v98, s25
    v_accvgpr_write_b32 a21, v12
    v_perm_b32 v11, v101, v100, s25
    v_accvgpr_write_b32 a22, v11
    v_perm_b32 v12, v103, v102, s25
    v_accvgpr_write_b32 a23, v12
    v_perm_b32 v11, v105, v104, s24
    v_accvgpr_write_b32 a24, v11
    v_perm_b32 v12, v107, v106, s24
    v_accvgpr_write_b32 a25, v12
    v_perm_b32 v11, v109, v108, s24
    v_accvgpr_write_b32 a26, v11
    v_perm_b32 v12, v111, v110, s24
    v_accvgpr_write_b32 a27, v12
    v_perm_b32 v11, v105, v104, s25
    v_accvgpr_write_b32 a28, v11
    v_perm_b32 v12, v107, v106, s25
    v_accvgpr_write_b32 a29, v12
    v_perm_b32 v11, v109, v108, s25
    v_accvgpr_write_b32 a30, v11
    v_perm_b32 v12, v111, v110, s25
    v_accvgpr_write_b32 a31, v12
    s_mov_b32 s10, 2097152
    buffer_load_dword v96, v8, s[76:79], s10 offen
    s_mov_b32 s11, 2105344
    buffer_load_dword v97, v8, s[76:79], s11 offen
    s_mov_b32 s10, 2113536
    buffer_load_dword v98, v8, s[76:79], s10 offen
    s_mov_b32 s11, 2121728
    buffer_load_dword v99, v8, s[76:79], s11 offen
    s_mov_b32 s10, 2129920
    buffer_load_dword v100, v8, s[76:79], s10 offen
    s_mov_b32 s11, 2138112
    buffer_load_dword v101, v8, s[76:79], s11 offen
    s_mov_b32 s10, 2146304
    buffer_load_dword v102, v8, s[76:79], s10 offen
    s_mov_b32 s11, 2154496
    buffer_load_dword v103, v8, s[76:79], s11 offen
    s_mov_b32 s10, 2359296
    buffer_load_dword v104, v8, s[76:79], s10 offen
    s_mov_b32 s11, 2367488
    buffer_load_dword v105, v8, s[76:79], s11 offen
    s_mov_b32 s10, 2375680
    buffer_load_dword v106, v8, s[76:79], s10 offen
    s_mov_b32 s11, 2383872
    buffer_load_dword v107, v8, s[76:79], s11 offen
    s_mov_b32 s10, 2392064
    buffer_load_dword v108, v8, s[76:79], s10 offen
    s_mov_b32 s11, 2400256
    buffer_load_dword v109, v8, s[76:79], s11 offen
    s_mov_b32 s10, 2408448
    buffer_load_dword v110, v8, s[76:79], s10 offen
    s_mov_b32 s11, 2416640
    buffer_load_dword v111, v8, s[76:79], s11 offen
    s_waitcnt vmcnt(32)
    v_perm_b32 v11, v129, v128, s24
    v_accvgpr_write_b32 a32, v11
    v_perm_b32 v12, v131, v130, s24
    v_accvgpr_write_b32 a33, v12
    v_perm_b32 v11, v133, v132, s24
    v_accvgpr_write_b32 a34, v11
    v_perm_b32 v12, v135, v134, s24
    v_accvgpr_write_b32 a35, v12
    v_perm_b32 v11, v129, v128, s25
    v_accvgpr_write_b32 a36, v11
    v_perm_b32 v12, v131, v130, s25
    v_accvgpr_write_b32 a37, v12
    v_perm_b32 v11, v133, v132, s25
    v_accvgpr_write_b32 a38, v11
    v_perm_b32 v12, v135, v134, s25
    v_accvgpr_write_b32 a39, v12
    v_perm_b32 v11, v137, v136, s24
    v_accvgpr_write_b32 a40, v11
    v_perm_b32 v12, v139, v138, s24
    v_accvgpr_write_b32 a41, v12
    v_perm_b32 v11, v141, v140, s24
    v_accvgpr_write_b32 a42, v11
    v_perm_b32 v12, v143, v142, s24
    v_accvgpr_write_b32 a43, v12
    v_perm_b32 v11, v137, v136, s25
    v_accvgpr_write_b32 a44, v11
    v_perm_b32 v12, v139, v138, s25
    v_accvgpr_write_b32 a45, v12
    v_perm_b32 v11, v141, v140, s25
    v_accvgpr_write_b32 a46, v11
    v_perm_b32 v12, v143, v142, s25
    v_accvgpr_write_b32 a47, v12
    s_mov_b32 s10, 2621440
    buffer_load_dword v128, v8, s[76:79], s10 offen
    s_mov_b32 s11, 2629632
    buffer_load_dword v129, v8, s[76:79], s11 offen
    s_mov_b32 s10, 2637824
    buffer_load_dword v130, v8, s[76:79], s10 offen
    s_mov_b32 s11, 2646016
    buffer_load_dword v131, v8, s[76:79], s11 offen
    s_mov_b32 s10, 2654208
    buffer_load_dword v132, v8, s[76:79], s10 offen
    s_mov_b32 s11, 2662400
    buffer_load_dword v133, v8, s[76:79], s11 offen
    s_mov_b32 s10, 2670592
    buffer_load_dword v134, v8, s[76:79], s10 offen
    s_mov_b32 s11, 2678784
    buffer_load_dword v135, v8, s[76:79], s11 offen
    s_mov_b32 s10, 2883584
    buffer_load_dword v136, v8, s[76:79], s10 offen
    s_mov_b32 s11, 2891776
    buffer_load_dword v137, v8, s[76:79], s11 offen
    s_mov_b32 s10, 2899968
    buffer_load_dword v138, v8, s[76:79], s10 offen
    s_mov_b32 s11, 2908160
    buffer_load_dword v139, v8, s[76:79], s11 offen
    s_mov_b32 s10, 2916352
    buffer_load_dword v140, v8, s[76:79], s10 offen
    s_mov_b32 s11, 2924544
    buffer_load_dword v141, v8, s[76:79], s11 offen
    s_mov_b32 s10, 2932736
    buffer_load_dword v142, v8, s[76:79], s10 offen
    s_mov_b32 s11, 2940928
    buffer_load_dword v143, v8, s[76:79], s11 offen
    s_waitcnt vmcnt(32)
    v_perm_b32 v11, v65, v64, s24
    v_accvgpr_write_b32 a48, v11
    v_perm_b32 v12, v67, v66, s24
    v_accvgpr_write_b32 a49, v12
    v_perm_b32 v11, v69, v68, s24
    v_accvgpr_write_b32 a50, v11
    v_perm_b32 v12, v71, v70, s24
    v_accvgpr_write_b32 a51, v12
    v_perm_b32 v11, v65, v64, s25
    v_accvgpr_write_b32 a52, v11
    v_perm_b32 v12, v67, v66, s25
    v_accvgpr_write_b32 a53, v12
    v_perm_b32 v11, v69, v68, s25
    v_accvgpr_write_b32 a54, v11
    v_perm_b32 v12, v71, v70, s25
    v_accvgpr_write_b32 a55, v12
    v_perm_b32 v11, v73, v72, s24
    v_accvgpr_write_b32 a56, v11
    v_perm_b32 v12, v75, v74, s24
    v_accvgpr_write_b32 a57, v12
    v_perm_b32 v11, v77, v76, s24
    v_accvgpr_write_b32 a58, v11
    v_perm_b32 v12, v79, v78, s24
    v_accvgpr_write_b32 a59, v12
    v_perm_b32 v11, v73, v72, s25
    v_accvgpr_write_b32 a60, v11
    v_perm_b32 v12, v75, v74, s25
    v_accvgpr_write_b32 a61, v12
    v_perm_b32 v11, v77, v76, s25
    v_accvgpr_write_b32 a62, v11
    v_perm_b32 v12, v79, v78, s25
    v_accvgpr_write_b32 a63, v12
    s_mov_b32 s10, 3145728
    buffer_load_dword v64, v8, s[76:79], s10 offen
    s_mov_b32 s11, 3153920
    buffer_load_dword v65, v8, s[76:79], s11 offen
    s_mov_b32 s10, 3162112
    buffer_load_dword v66, v8, s[76:79], s10 offen
    s_mov_b32 s11, 3170304
    buffer_load_dword v67, v8, s[76:79], s11 offen
    s_mov_b32 s10, 3178496
    buffer_load_dword v68, v8, s[76:79], s10 offen
    s_mov_b32 s11, 3186688
    buffer_load_dword v69, v8, s[76:79], s11 offen
    s_mov_b32 s10, 3194880
    buffer_load_dword v70, v8, s[76:79], s10 offen
    s_mov_b32 s11, 3203072
    buffer_load_dword v71, v8, s[76:79], s11 offen
    s_mov_b32 s10, 3407872
    buffer_load_dword v72, v8, s[76:79], s10 offen
    s_mov_b32 s11, 3416064
    buffer_load_dword v73, v8, s[76:79], s11 offen
    s_mov_b32 s10, 3424256
    buffer_load_dword v74, v8, s[76:79], s10 offen
    s_mov_b32 s11, 3432448
    buffer_load_dword v75, v8, s[76:79], s11 offen
    s_mov_b32 s10, 3440640
    buffer_load_dword v76, v8, s[76:79], s10 offen
    s_mov_b32 s11, 3448832
    buffer_load_dword v77, v8, s[76:79], s11 offen
    s_mov_b32 s10, 3457024
    buffer_load_dword v78, v8, s[76:79], s10 offen
    s_mov_b32 s11, 3465216
    buffer_load_dword v79, v8, s[76:79], s11 offen
    s_waitcnt vmcnt(32)
    v_perm_b32 v11, v97, v96, s24
    v_accvgpr_write_b32 a64, v11
    v_perm_b32 v12, v99, v98, s24
    v_accvgpr_write_b32 a65, v12
    v_perm_b32 v11, v101, v100, s24
    v_accvgpr_write_b32 a66, v11
    v_perm_b32 v12, v103, v102, s24
    v_accvgpr_write_b32 a67, v12
    v_perm_b32 v11, v97, v96, s25
    v_accvgpr_write_b32 a68, v11
    v_perm_b32 v12, v99, v98, s25
    v_accvgpr_write_b32 a69, v12
    v_perm_b32 v11, v101, v100, s25
    v_accvgpr_write_b32 a70, v11
    v_perm_b32 v12, v103, v102, s25
    v_accvgpr_write_b32 a71, v12
    v_perm_b32 v11, v105, v104, s24
    v_accvgpr_write_b32 a72, v11
    v_perm_b32 v12, v107, v106, s24
    v_accvgpr_write_b32 a73, v12
    v_perm_b32 v11, v109, v108, s24
    v_accvgpr_write_b32 a74, v11
    v_perm_b32 v12, v111, v110, s24
    v_accvgpr_write_b32 a75, v12
    v_perm_b32 v11, v105, v104, s25
    v_accvgpr_write_b32 a76, v11
    v_perm_b32 v12, v107, v106, s25
    v_accvgpr_write_b32 a77, v12
    v_perm_b32 v11, v109, v108, s25
    v_accvgpr_write_b32 a78, v11
    v_perm_b32 v12, v111, v110, s25
    v_accvgpr_write_b32 a79, v12
    s_mov_b32 s10, 3670016
    buffer_load_dword v96, v8, s[76:79], s10 offen
    s_mov_b32 s11, 3678208
    buffer_load_dword v97, v8, s[76:79], s11 offen
    s_mov_b32 s10, 3686400
    buffer_load_dword v98, v8, s[76:79], s10 offen
    s_mov_b32 s11, 3694592
    buffer_load_dword v99, v8, s[76:79], s11 offen
    s_mov_b32 s10, 3702784
    buffer_load_dword v100, v8, s[76:79], s10 offen
    s_mov_b32 s11, 3710976
    buffer_load_dword v101, v8, s[76:79], s11 offen
    s_mov_b32 s10, 3719168
    buffer_load_dword v102, v8, s[76:79], s10 offen
    s_mov_b32 s11, 3727360
    buffer_load_dword v103, v8, s[76:79], s11 offen
    s_mov_b32 s10, 3932160
    buffer_load_dword v104, v8, s[76:79], s10 offen
    s_mov_b32 s11, 3940352
    buffer_load_dword v105, v8, s[76:79], s11 offen
    s_mov_b32 s10, 3948544
    buffer_load_dword v106, v8, s[76:79], s10 offen
    s_mov_b32 s11, 3956736
    buffer_load_dword v107, v8, s[76:79], s11 offen
    s_mov_b32 s10, 3964928
    buffer_load_dword v108, v8, s[76:79], s10 offen
    s_mov_b32 s11, 3973120
    buffer_load_dword v109, v8, s[76:79], s11 offen
    s_mov_b32 s10, 3981312
    buffer_load_dword v110, v8, s[76:79], s10 offen
    s_mov_b32 s11, 3989504
    buffer_load_dword v111, v8, s[76:79], s11 offen
    s_waitcnt vmcnt(32)
    v_perm_b32 v11, v129, v128, s24
    v_accvgpr_write_b32 a80, v11
    v_perm_b32 v12, v131, v130, s24
    v_accvgpr_write_b32 a81, v12
    v_perm_b32 v11, v133, v132, s24
    v_accvgpr_write_b32 a82, v11
    v_perm_b32 v12, v135, v134, s24
    v_accvgpr_write_b32 a83, v12
    v_perm_b32 v11, v129, v128, s25
    v_accvgpr_write_b32 a84, v11
    v_perm_b32 v12, v131, v130, s25
    v_accvgpr_write_b32 a85, v12
    v_perm_b32 v11, v133, v132, s25
    v_accvgpr_write_b32 a86, v11
    v_perm_b32 v12, v135, v134, s25
    v_accvgpr_write_b32 a87, v12
    v_perm_b32 v11, v137, v136, s24
    v_accvgpr_write_b32 a88, v11
    v_perm_b32 v12, v139, v138, s24
    v_accvgpr_write_b32 a89, v12
    v_perm_b32 v11, v141, v140, s24
    v_accvgpr_write_b32 a90, v11
    v_perm_b32 v12, v143, v142, s24
    v_accvgpr_write_b32 a91, v12
    v_perm_b32 v11, v137, v136, s25
    v_accvgpr_write_b32 a92, v11
    v_perm_b32 v12, v139, v138, s25
    v_accvgpr_write_b32 a93, v12
    v_perm_b32 v11, v141, v140, s25
    v_accvgpr_write_b32 a94, v11
    v_perm_b32 v12, v143, v142, s25
    v_accvgpr_write_b32 a95, v12
    s_mov_b32 s10, 4194304
    buffer_load_dword v128, v8, s[76:79], s10 offen
    s_mov_b32 s11, 4202496
    buffer_load_dword v129, v8, s[76:79], s11 offen
    s_mov_b32 s10, 4210688
    buffer_load_dword v130, v8, s[76:79], s10 offen
    s_mov_b32 s11, 4218880
    buffer_load_dword v131, v8, s[76:79], s11 offen
    s_mov_b32 s10, 4227072
    buffer_load_dword v132, v8, s[76:79], s10 offen
    s_mov_b32 s11, 4235264
    buffer_load_dword v133, v8, s[76:79], s11 offen
    s_mov_b32 s10, 4243456
    buffer_load_dword v134, v8, s[76:79], s10 offen
    s_mov_b32 s11, 4251648
    buffer_load_dword v135, v8, s[76:79], s11 offen
    s_mov_b32 s10, 4456448
    buffer_load_dword v136, v8, s[76:79], s10 offen
    s_mov_b32 s11, 4464640
    buffer_load_dword v137, v8, s[76:79], s11 offen
    s_mov_b32 s10, 4472832
    buffer_load_dword v138, v8, s[76:79], s10 offen
    s_mov_b32 s11, 4481024
    buffer_load_dword v139, v8, s[76:79], s11 offen
    s_mov_b32 s10, 4489216
    buffer_load_dword v140, v8, s[76:79], s10 offen
    s_mov_b32 s11, 4497408
    buffer_load_dword v141, v8, s[76:79], s11 offen
    s_mov_b32 s10, 4505600
    buffer_load_dword v142, v8, s[76:79], s10 offen
    s_mov_b32 s11, 4513792
    buffer_load_dword v143, v8, s[76:79], s11 offen
    s_waitcnt vmcnt(32)
    v_perm_b32 v11, v65, v64, s24
    v_accvgpr_write_b32 a96, v11
    v_perm_b32 v12, v67, v66, s24
    v_accvgpr_write_b32 a97, v12
    v_perm_b32 v11, v69, v68, s24
    v_accvgpr_write_b32 a98, v11
    v_perm_b32 v12, v71, v70, s24
    v_accvgpr_write_b32 a99, v12
    v_perm_b32 v11, v65, v64, s25
    v_accvgpr_write_b32 a100, v11
    v_perm_b32 v12, v67, v66, s25
    v_accvgpr_write_b32 a101, v12
    v_perm_b32 v11, v69, v68, s25
    v_accvgpr_write_b32 a102, v11
    v_perm_b32 v12, v71, v70, s25
    v_accvgpr_write_b32 a103, v12
    v_perm_b32 v11, v73, v72, s24
    v_accvgpr_write_b32 a104, v11
    v_perm_b32 v12, v75, v74, s24
    v_accvgpr_write_b32 a105, v12
    v_perm_b32 v11, v77, v76, s24
    v_accvgpr_write_b32 a106, v11
    v_perm_b32 v12, v79, v78, s24
    v_accvgpr_write_b32 a107, v12
    v_perm_b32 v11, v73, v72, s25
    v_accvgpr_write_b32 a108, v11
    v_perm_b32 v12, v75, v74, s25
    v_accvgpr_write_b32 a109, v12
    v_perm_b32 v11, v77, v76, s25
    v_accvgpr_write_b32 a110, v11
    v_perm_b32 v12, v79, v78, s25
    v_accvgpr_write_b32 a111, v12
    s_mov_b32 s10, 4718592
    buffer_load_dword v64, v8, s[76:79], s10 offen
    s_mov_b32 s11, 4726784
    buffer_load_dword v65, v8, s[76:79], s11 offen
    s_mov_b32 s10, 4734976
    buffer_load_dword v66, v8, s[76:79], s10 offen
    s_mov_b32 s11, 4743168
    buffer_load_dword v67, v8, s[76:79], s11 offen
    s_mov_b32 s10, 4751360
    buffer_load_dword v68, v8, s[76:79], s10 offen
    s_mov_b32 s11, 4759552
    buffer_load_dword v69, v8, s[76:79], s11 offen
    s_mov_b32 s10, 4767744
    buffer_load_dword v70, v8, s[76:79], s10 offen
    s_mov_b32 s11, 4775936
    buffer_load_dword v71, v8, s[76:79], s11 offen
    s_mov_b32 s10, 4980736
    buffer_load_dword v72, v8, s[76:79], s10 offen
    s_mov_b32 s11, 4988928
    buffer_load_dword v73, v8, s[76:79], s11 offen
    s_mov_b32 s10, 4997120
    buffer_load_dword v74, v8, s[76:79], s10 offen
    s_mov_b32 s11, 5005312
    buffer_load_dword v75, v8, s[76:79], s11 offen
    s_mov_b32 s10, 5013504
    buffer_load_dword v76, v8, s[76:79], s10 offen
    s_mov_b32 s11, 5021696
    buffer_load_dword v77, v8, s[76:79], s11 offen
    s_mov_b32 s10, 5029888
    buffer_load_dword v78, v8, s[76:79], s10 offen
    s_mov_b32 s11, 5038080
    buffer_load_dword v79, v8, s[76:79], s11 offen
    s_waitcnt vmcnt(32)
    v_perm_b32 v11, v97, v96, s24
    v_accvgpr_write_b32 a112, v11
    v_perm_b32 v12, v99, v98, s24
    v_accvgpr_write_b32 a113, v12
    v_perm_b32 v11, v101, v100, s24
    v_accvgpr_write_b32 a114, v11
    v_perm_b32 v12, v103, v102, s24
    v_accvgpr_write_b32 a115, v12
    v_perm_b32 v11, v97, v96, s25
    v_accvgpr_write_b32 a116, v11
    v_perm_b32 v12, v99, v98, s25
    v_accvgpr_write_b32 a117, v12
    v_perm_b32 v11, v101, v100, s25
    v_accvgpr_write_b32 a118, v11
    v_perm_b32 v12, v103, v102, s25
    v_accvgpr_write_b32 a119, v12
    v_perm_b32 v11, v105, v104, s24
    v_accvgpr_write_b32 a120, v11
    v_perm_b32 v12, v107, v106, s24
    v_accvgpr_write_b32 a121, v12
    v_perm_b32 v11, v109, v108, s24
    v_accvgpr_write_b32 a122, v11
    v_perm_b32 v12, v111, v110, s24
    v_accvgpr_write_b32 a123, v12
    v_perm_b32 v11, v105, v104, s25
    v_accvgpr_write_b32 a124, v11
    v_perm_b32 v12, v107, v106, s25
    v_accvgpr_write_b32 a125, v12
    v_perm_b32 v11, v109, v108, s25
    v_accvgpr_write_b32 a126, v11
    v_perm_b32 v12, v111, v110, s25
    v_accvgpr_write_b32 a127, v12
    s_waitcnt vmcnt(16)
    v_perm_b32 v11, v129, v128, s24
    v_accvgpr_write_b32 a128, v11
    v_perm_b32 v12, v131, v130, s24
    v_accvgpr_write_b32 a129, v12
    v_perm_b32 v11, v133, v132, s24
    v_accvgpr_write_b32 a130, v11
    v_perm_b32 v12, v135, v134, s24
    v_accvgpr_write_b32 a131, v12
    v_perm_b32 v11, v129, v128, s25
    v_accvgpr_write_b32 a132, v11
    v_perm_b32 v12, v131, v130, s25
    v_accvgpr_write_b32 a133, v12
    v_perm_b32 v11, v133, v132, s25
    v_accvgpr_write_b32 a134, v11
    v_perm_b32 v12, v135, v134, s25
    v_accvgpr_write_b32 a135, v12
    v_perm_b32 v11, v137, v136, s24
    v_accvgpr_write_b32 a136, v11
    v_perm_b32 v12, v139, v138, s24
    v_accvgpr_write_b32 a137, v12
    v_perm_b32 v11, v141, v140, s24
    v_accvgpr_write_b32 a138, v11
    v_perm_b32 v12, v143, v142, s24
    v_accvgpr_write_b32 a139, v12
    v_perm_b32 v11, v137, v136, s25
    v_accvgpr_write_b32 a140, v11
    v_perm_b32 v12, v139, v138, s25
    v_accvgpr_write_b32 a141, v12
    v_perm_b32 v11, v141, v140, s25
    v_accvgpr_write_b32 a142, v11
    v_perm_b32 v12, v143, v142, s25
    v_accvgpr_write_b32 a143, v12
    s_waitcnt vmcnt(0)
    v_perm_b32 v11, v65, v64, s24
    v_accvgpr_write_b32 a144, v11
    v_perm_b32 v12, v67, v66, s24
    v_accvgpr_write_b32 a145, v12
    v_perm_b32 v11, v69, v68, s24
    v_accvgpr_write_b32 a146, v11
    v_perm_b32 v12, v71, v70, s24
    v_accvgpr_write_b32 a147, v12
    v_perm_b32 v11, v65, v64, s25
    v_accvgpr_write_b32 a148, v11
    v_perm_b32 v12, v67, v66, s25
    v_accvgpr_write_b32 a149, v12
    v_perm_b32 v11, v69, v68, s25
    v_accvgpr_write_b32 a150, v11
    v_perm_b32 v12, v71, v70, s25
    v_accvgpr_write_b32 a151, v12
    v_perm_b32 v11, v73, v72, s24
    v_accvgpr_write_b32 a152, v11
    v_perm_b32 v12, v75, v74, s24
    v_accvgpr_write_b32 a153, v12
    v_perm_b32 v11, v77, v76, s24
    v_accvgpr_write_b32 a154, v11
    v_perm_b32 v12, v79, v78, s24
    v_accvgpr_write_b32 a155, v12
    v_perm_b32 v11, v73, v72, s25
    v_accvgpr_write_b32 a156, v11
    v_perm_b32 v12, v75, v74, s25
    v_accvgpr_write_b32 a157, v12
    v_perm_b32 v11, v77, v76, s25
    v_accvgpr_write_b32 a158, v11
    v_perm_b32 v12, v79, v78, s25
    v_accvgpr_write_b32 a159, v12
    s_lshl_b32 s10, s4, 14
    s_lshl_b32 s11, s5, 10
    s_add_u32 s10, s10, s11
    s_add_u32 s10, s10, 16777216
    s_add_u32 s20, s8, s10
    s_addc_u32 s21, s9, 0
    v_lshlrev_b32 v5, 5, v0
    v_add_u32 v5, 4, v5
    s_mov_b32 s27, 0
L_wi_33:
    s_mov_b64 exec, 0xff
    global_load_dword v6, v5, s[6:7] sc1
    s_waitcnt vmcnt(0)
    s_mov_b64 exec, -1
    v_readlane_b32 s10, v6, 0
    v_readlane_b32 s11, v6, 1
    s_add_u32 s10, s10, s11
    v_readlane_b32 s11, v6, 2
    s_add_u32 s10, s10, s11
    v_readlane_b32 s11, v6, 3
    s_add_u32 s10, s10, s11
    v_readlane_b32 s11, v6, 4
    s_add_u32 s10, s10, s11
    v_readlane_b32 s11, v6, 5
    s_add_u32 s10, s10, s11
    v_readlane_b32 s11, v6, 6
    s_add_u32 s10, s10, s11
    v_readlane_b32 s11, v6, 7
    s_add_u32 s10, s10, s11
    s_cmp_ge_u32 s10, 256
    s_cbranch_scc1 L_wiok_34
    s_sleep 4
    s_add_u32 s27, s27, 1
    s_cmp_lt_u32 s27, 262144
    s_cbranch_scc1 L_wi_33
    s_branch L_timeout
L_wiok_34:
    s_mov_b32 s18, 0
    s_mov_b32 s26, 0
    v_add_u32 v12, 0, v14
    v_add_u32 v13, 0, v15
    s_waitcnt vmcnt(0)
L_kp_loop:
    s_waitcnt vmcnt(2)
    s_barrier
    s_cmp_lt_u32 s18, 2
    s_cbranch_scc1 L_nf_35
    s_sub_u32 s30, s18, 1
    s_cmp_eq_u32 s5, 0
    s_cbranch_scc0 L_fl_36
    v_mov_b32 v5, s29
    v_mov_b32 v6, s30
    s_mov_b64 exec, 1
    global_store_dword v5, v6, s[22:23] sc1
    s_mov_b64 exec, -1
L_fl_36:
L_nf_35:
    s_add_u32 s30, s18, 1
    s_cmp_ge_u32 s30, 64
    s_cbranch_scc1 L_nd_37
    s_add_u32 s16, s16, 40960
    s_addc_u32 s17, s17, 0
    s_xor_b32 s31, s26, 40960
    s_mul_i32 s13, s5, 10240
    s_add_u32 s13, s13, s31
    ds_read_b128 v[16:19], v12 offset:0
    ds_read_b128 v[20:23], v12 offset:20480
    ds_read_b128 v[24:27], v13 offset:0
    ds_read_b128 v[28:31], v13 offset:20480
    ds_read_b128 v[32:35], v12 offset:1024
    ds_read_b128 v[36:39], v12 offset:21504
    s_waitcnt lgkmcnt(4)
    v_mfma_f32_16x16x32_bf16 v[40:43], a[0:3], v[16:19], 0
    v_mfma_f32_16x16x32_bf16 v[44:47], a[4:7], v[16:19], 0
    s_add_u32 m0, s13, 0
    s_nop 0
    global_load_lds_dwordx4 v2, s[16:17] offset:0
    v_mfma_f32_16x16x32_bf16 v[48:51], a[0:3], v[20:23], 0
    v_mfma_f32_16x16x32_bf16 v[52:55], a[4:7], v[20:23], 0
    ds_read_b128 v[16:19], v13 offset:1024
    ds_read_b128 v[20:23], v13 offset:21504
    s_waitcnt lgkmcnt(4)
    v_mfma_f32_16x16x32_bf16 v[40:43], a[8:11], v[24:27], v[40:43]
    v_mfma_f32_16x16x32_bf16 v[44:47], a[12:15], v[24:27], v[44:47]
    v_mfma_f32_16x16x32_bf16 v[48:51], a[8:11], v[28:31], v[48:51]
    v_mfma_f32_16x16x32_bf16 v[52:55], a[12:15], v[28:31], v[52:55]
    ds_read_b128 v[24:27], v12 offset:2048
    ds_read_b128 v[28:31], v12 offset:22528
    s_waitcnt lgkmcnt(4)
    v_mfma_f32_16x16x32_bf16 v[40:43], a[16:19], v[32:35], v[40:43]
    v_mfma_f32_16x16x32_bf16 v[44:47], a[20:23], v[32:35], v[44:47]
    s_add_u32 m0, s13, 896
    s_nop 0
    global_load_lds_dwordx4 v2, s[16:17] offset:128
    v_mfma_f32_16x16x32_bf16 v[48:51], a[16:19], v[36:39], v[48:51]
    v_mfma_f32_16x16x32_bf16 v[52:55], a[20:23], v[36:39], v[52:55]
    ds_read_b128 v[32:35], v13 offset:2048
    ds_read_b128 v[36:39], v13 offset:22528
    s_waitcnt lgkmcnt(4)
    v_mfma_f32_16x16x32_bf16 v[40:43], a[24:27], v[16:19], v[40:43]
    v_mfma_f32_16x16x32_bf16 v[44:47], a[28:31], v[16:19], v[44:47]
    v_mfma_f32_16x16x32_bf16 v[48:51], a[24:27], v[20:23], v[48:51]
    v_mfma_f32_16x16x32_bf16 v[52:55], a[28:31], v[20:23], v[52:55]
    ds_read_b128 v[16:19], v12 offset:3072
    ds_read_b128 v[20:23], v12 offset:23552
    s_waitcnt lgkmcnt(4)
    v_mfma_f32_16x16x32_bf16 v[40:43], a[32:35], v[24:27], v[40:43]
    v_mfma_f32_16x16x32_bf16 v[44:47], a[36:39], v[24:27], v[44:47]
    s_add_u32 m0, s13, 1792
    s_nop 0
    global_load_lds_dwordx4 v2, s[16:17] offset:256
    v_mfma_f32_16x16x32_bf16 v[48:51], a[32:35], v[28:31], v[48:51]
    v_mfma_f32_16x16x32_bf16 v[52:55], a[36:39], v[28:31], v[52:55]
    ds_read_b128 v[24:27], v13 offset:3072
    ds_read_b128 v[28:31], v13 offset:23552
    s_waitcnt lgkmcnt(4)
    v_mfma_f32_16x16x32_bf16 v[40:43], a[40:43], v[32:35], v[40:43]
    v_mfma_f32_16x16x32_bf16 v[44:47], a[44:47], v[32:35], v[44:47]
    v_mfma_f32_16x16x32_bf16 v[48:51], a[40:43], v[36:39], v[48:51]
    v_mfma_f32_16x16x32_bf16 v[52:55], a[44:47], v[36:39], v[52:55]
    ds_read_b128 v[32:35], v12 offset:4096
    ds_read_b128 v[36:39], v12 offset:24576
    s_waitcnt lgkmcnt(4)
    v_mfma_f32_16x16x32_bf16 v[40:43], a[48:51], v[16:19], v[40:43]
    v_mfma_f32_16x16x32_bf16 v[44:47], a[52:55], v[16:19], v[44:47]
    s_add_u32 m0, s13, 2688
    s_nop 0
    global_load_lds_dwordx4 v2, s[16:17] offset:384
    v_mfma_f32_16x16x32_bf16 v[48:51], a[48:51], v[20:23], v[48:51]
    v_mfma_f32_16x16x32_bf16 v[52:55], a[52:55], v[20:23], v[52:55]
    ds_read_b128 v[16:19], v13 offset:4096
    ds_read_b128 v[20:23], v13 offset:24576
    s_waitcnt lgkmcnt(4)
    v_mfma_f32_16x16x32_bf16 v[40:43], a[56:59], v[24:27], v[40:43]
    v_mfma_f32_16x16x32_bf16 v[44:47], a[60:63], v[24:27], v[44:47]
    v_mfma_f32_16x16x32_bf16 v[48:51], a[56:59], v[28:31], v[48:51]
    v_mfma_f32_16x16x32_bf16 v[52:55], a[60:63], v[28:31], v[52:55]
    ds_read_b128 v[24:27], v12 offset:5120
    ds_read_b128 v[28:31], v12 offset:25600
    s_waitcnt lgkmcnt(4)
    v_mfma_f32_16x16x32_bf16 v[40:43], a[64:67], v[32:35], v[40:43]
    v_mfma_f32_16x16x32_bf16 v[44:47], a[68:71], v[32:35], v[44:47]
    s_add_u32 m0, s13, 3584
    s_nop 0
    global_load_lds_dwordx4 v2, s[16:17] offset:512
    v_mfma_f32_16x16x32_bf16 v[48:51], a[64:67], v[36:39], v[48:51]
    v_mfma_f32_16x16x32_bf16 v[52:55], a[68:71], v[36:39], v[52:55]
    ds_read_b128 v[32:35], v13 offset:5120
    ds_read_b128 v[36:39], v13 offset:25600
    s_waitcnt lgkmcnt(4)
    v_mfma_f32_16x16x32_bf16 v[40:43], a[72:75], v[16:19], v[40:43]
    v_mfma_f32_16x16x32_bf16 v[44:47], a[76:79], v[16:19], v[44:47]
    v_mfma_f32_16x16x32_bf16 v[48:51], a[72:75], v[20:23], v[48:51]
    v_mfma_f32_16x16x32_bf16 v[52:55], a[76:79], v[20:23], v[52:55]
    ds_read_b128 v[16:19], v12 offset:6144
    ds_read_b128 v[20:23], v12 offset:26624
    s_waitcnt lgkmcnt(4)
    v_mfma_f32_16x16x32_bf16 v[40:43], a[80:83], v[24:27], v[40:43]
    v_mfma_f32_16x16x32_bf16 v[44:47], a[84:87], v[24:27], v[44:47]
    s_add_u32 m0, s13, 4480
    s_nop 0
    global_load_lds_dwordx4 v2, s[16:17] offset:640
    v_mfma_f32_16x16x32_bf16 v[48:51], a[80:83], v[28:31], v[48:51]
    v_mfma_f32_16x16x32_bf16 v[52:55], a[84:87], v[28:31], v[52:55]
    ds_read_b128 v[24:27], v13 offset:6144
    ds_read_b128 v[28:31], v13 offset:26624
    s_waitcnt lgkmcnt(4)
    v_mfma_f32_16x16x32_bf16 v[40:43], a[88:91], v[32:35], v[40:43]
    v_mfma_f32_16x16x32_bf16 v[44:47], a[92:95], v[32:35], v[44:47]
    v_mfma_f32_16x16x32_bf16 v[48:51], a[88:91], v[36:39], v[48:51]
    v_mfma_f32_16x16x32_bf16 v[52:55], a[92:95], v[36:39], v[52:55]
    ds_read_b128 v[32:35], v12 offset:7168
    ds_read_b128 v[36:39], v12 offset:27648
    s_waitcnt lgkmcnt(4)
    v_mfma_f32_16x16x32_bf16 v[40:43], a[96:99], v[16:19], v[40:43]
    v_mfma_f32_16x16x32_bf16 v[44:47], a[100:103], v[16:19], v[44:47]
    s_add_u32 m0, s13, 5376
    s_nop 0
    global_load_lds_dwordx4 v2, s[16:17] offset:768
    v_mfma_f32_16x16x32_bf16 v[48:51], a[96:99], v[20:23], v[48:51]
    v_mfma_f32_16x16x32_bf16 v[52:55], a[100:103], v[20:23], v[52:55]
    ds_read_b128 v[16:19], v13 offset:7168
    ds_read_b128 v[20:23], v13 offset:27648
    s_waitcnt lgkmcnt(4)
    v_mfma_f32_16x16x32_bf16 v[40:43], a[104:107], v[24:27], v[40:43]
    v_mfma_f32_16x16x32_bf16 v[44:47], a[108:111], v[24:27], v[44:47]
    v_mfma_f32_16x16x32_bf16 v[48:51], a[104:107], v[28:31], v[48:51]
    v_mfma_f32_16x16x32_bf16 v[52:55], a[108:111], v[28:31], v[52:55]
    ds_read_b128 v[24:27], v12 offset:8192
    ds_read_b128 v[28:31], v12 offset:28672
    s_waitcnt lgkmcnt(4)
    v_mfma_f32_16x16x32_bf16 v[40:43], a[112:115], v[32:35], v[40:43]
    v_mfma_f32_16x16x32_bf16 v[44:47], a[116:119], v[32:35], v[44:47]
    s_add_u32 m0, s13, 6272
    s_nop 0
    global_load_lds_dwordx4 v2, s[16:17] offset:896
    v_mfma_f32_16x16x32_bf16 v[48:51], a[112:115], v[36:39], v[48:51]
    v_mfma_f32_16x16x32_bf16 v[52:55], a[116:119], v[36:39], v[52:55]
    ds_read_b128 v[32:35], v13 offset:8192
    ds_read_b128 v[36:39], v13 offset:28672
    s_waitcnt lgkmcnt(4)
    v_mfma_f32_16x16x32_bf16 v[40:43], a[120:123], v[16:19], v[40:43]
    v_mfma_f32_16x16x32_bf16 v[44:47], a[124:127], v[16:19], v[44:47]
    v_mfma_f32_16x16x32_bf16 v[48:51], a[120:123], v[20:23], v[48:51]
    v_mfma_f32_16x16x32_bf16 v[52:55], a[124:127], v[20:23], v[52:55]
    ds_read_b128 v[16:19], v12 offset:9216
    ds_read_b128 v[20:23], v12 offset:29696
    s_waitcnt lgkmcnt(4)
    v_mfma_f32_16x16x32_bf16 v[40:43], a[128:131], v[24:27], v[40:43]
    v_mfma_f32_16x16x32_bf16 v[44:47], a[132:135], v[24:27], v[44:47]
    s_add_u32 m0, s13, 7168
    s_nop 0
    global_load_lds_dwordx4 v2, s[16:17] offset:1024
    v_mfma_f32_16x16x32_bf16 v[48:51], a[128:131], v[28:31], v[48:51]
    v_mfma_f32_16x16x32_bf16 v[52:55], a[132:135], v[28:31], v[52:55]
    ds_read_b128 v[24:27], v13 offset:9216
    ds_read_b128 v[28:31], v13 offset:29696
    s_waitcnt lgkmcnt(4)
    v_mfma_f32_16x16x32_bf16 v[40:43], a[136:139], v[32:35], v[40:43]
    v_mfma_f32_16x16x32_bf16 v[44:47], a[140:143], v[32:35], v[44:47]
    v_mfma_f32_16x16x32_bf16 v[48:51], a[136:139], v[36:39], v[48:51]
    v_mfma_f32_16x16x32_bf16 v[52:55], a[140:143], v[36:39], v[52:55]
    s_waitcnt lgkmcnt(2)
    v_mfma_f32_16x16x32_bf16 v[40:43], a[144:147], v[16:19], v[40:43]
    v_mfma_f32_16x16x32_bf16 v[44:47], a[148:151], v[16:19], v[44:47]
    s_add_u32 m0, s13, 8064
    s_nop 0
    global_load_lds_dwordx4 v2, s[16:17] offset:1152
    v_mfma_f32_16x16x32_bf16 v[48:51], a[144:147], v[20:23], v[48:51]
    v_mfma_f32_16x16x32_bf16 v[52:55], a[148:151], v[20:23], v[52:55]
    s_waitcnt lgkmcnt(0)
    v_mfma_f32_16x16x32_bf16 v[40:43], a[152:155], v[24:27], v[40:43]
    v_mfma_f32_16x16x32_bf16 v[44:47], a[156:159], v[24:27], v[44:47]
    v_mfma_f32_16x16x32_bf16 v[48:51], a[152:155], v[28:31], v[48:51]
    v_mfma_f32_16x16x32_bf16 v[52:55], a[156:159], v[28:31], v[52:55]
    s_branch L_nd2_38
L_nd_37:
    ds_read_b128 v[16:19], v12 offset:0
    ds_read_b128 v[20:23], v12 offset:20480
    ds_read_b128 v[24:27], v13 offset:0
    ds_read_b128 v[28:31], v13 offset:20480
    ds_read_b128 v[32:35], v12 offset:1024
    ds_read_b128 v[36:39], v12 offset:21504
    s_waitcnt lgkmcnt(4)
    v_mfma_f32_16x16x32_bf16 v[40:43], a[0:3], v[16:19], 0
    v_mfma_f32_16x16x32_bf16 v[44:47], a[4:7], v[16:19], 0
    v_mfma_f32_16x16x32_bf16 v[48:51], a[0:3], v[20:23], 0
    v_mfma_f32_16x16x32_bf16 v[52:55], a[4:7], v[20:23], 0
    ds_read_b128 v[16:19], v13 offset:1024
    ds_read_b128 v[20:23], v13 offset:21504
    s_waitcnt lgkmcnt(4)
    v_mfma_f32_16x16x32_bf16 v[40:43], a[8:11], v[24:27], v[40:43]
    v_mfma_f32_16x16x32_bf16 v[44:47], a[12:15], v[24:27], v[44:47]
    v_mfma_f32_16x16x32_bf16 v[48:51], a[8:11], v[28:31], v[48:51]
    v_mfma_f32_16x16x32_bf16 v[52:55], a[12:15], v[28:31], v[52:55]
    ds_read_b128 v[24:27], v12 offset:2048
    ds_read_b128 v[28:31], v12 offset:22528
    s_waitcnt lgkmcnt(4)
    v_mfma_f32_16x16x32_bf16 v[40:43], a[16:19], v[32:35], v[40:43]
    v_mfma_f32_16x16x32_bf16 v[44:47], a[20:23], v[32:35], v[44:47]
    v_mfma_f32_16x16x32_bf16 v[48:51], a[16:19], v[36:39], v[48:51]
    v_mfma_f32_16x16x32_bf16 v[52:55], a[20:23], v[36:39], v[52:55]
    ds_read_b128 v[32:35], v13 offset:2048
    ds_read_b128 v[36:39], v13 offset:22528
    s_waitcnt lgkmcnt(4)
    v_mfma_f32_16x16x32_bf16 v[40:43], a[24:27], v[16:19], v[40:43]
    v_mfma_f32_16x16x32_bf16 v[44:47], a[28:31], v[16:19], v[44:47]
    v_mfma_f32_16x16x32_bf16 v[48:51], a[24:27], v[20:23], v[48:51]
    v_mfma_f32_16x16x32_bf16 v[52:55], a[28:31], v[20:23], v[52:55]
    ds_read_b128 v[16:19], v12 offset:3072
    ds_read_b128 v[20:23], v12 offset:23552
    s_waitcnt lgkmcnt(4)
    v_mfma_f32_16x16x32_bf16 v[40:43], a[32:35], v[24:27], v[40:43]
    v_mfma_f32_16x16x32_bf16 v[44:47], a[36:39], v[24:27], v[44:47]
    v_mfma_f32_16x16x32_bf16 v[48:51], a[32:35], v[28:31], v[48:51]
    v_mfma_f32_16x16x32_bf16 v[52:55], a[36:39], v[28:31], v[52:55]
    ds_read_b128 v[24:27], v13 offset:3072
    ds_read_b128 v[28:31], v13 offset:23552
    s_waitcnt lgkmcnt(4)
    v_mfma_f32_16x16x32_bf16 v[40:43], a[40:43], v[32:35], v[40:43]
    v_mfma_f32_16x16x32_bf16 v[44:47], a[44:47], v[32:35], v[44:47]
    v_mfma_f32_16x16x32_bf16 v[48:51], a[40:43], v[36:39], v[48:51]
    v_mfma_f32_16x16x32_bf16 v[52:55], a[44:47], v[36:39], v[52:55]
    ds_read_b128 v[32:35], v12 offset:4096
    ds_read_b128 v[36:39], v12 offset:24576
    s_waitcnt lgkmcnt(4)
    v_mfma_f32_16x16x32_bf16 v[40:43], a[48:51], v[16:19], v[40:43]
    v_mfma_f32_16x16x32_bf16 v[44:47], a[52:55], v[16:19], v[44:47]
    v_mfma_f32_16x16x32_bf16 v[48:51], a[48:51], v[20:23], v[48:51]
    v_mfma_f32_16x16x32_bf16 v[52:55], a[52:55], v[20:23], v[52:55]
    ds_read_b128 v[16:19], v13 offset:4096
    ds_read_b128 v[20:23], v13 offset:24576
    s_waitcnt lgkmcnt(4)
    v_mfma_f32_16x16x32_bf16 v[40:43], a[56:59], v[24:27], v[40:43]
    v_mfma_f32_16x16x32_bf16 v[44:47], a[60:63], v[24:27], v[44:47]
    v_mfma_f32_16x16x32_bf16 v[48:51], a[56:59], v[28:31], v[48:51]
    v_mfma_f32_16x16x32_bf16 v[52:55], a[60:63], v[28:31], v[52:55]
    ds_read_b128 v[24:27], v12 offset:5120
    ds_read_b128 v[28:31], v12 offset:25600
    s_waitcnt lgkmcnt(4)
    v_mfma_f32_16x16x32_bf16 v[40:43], a[64:67], v[32:35], v[40:43]
    v_mfma_f32_16x16x32_bf16 v[44:47], a[68:71], v[32:35], v[44:47]
    v_mfma_f32_16x16x32_bf16 v[48:51], a[64:67], v[36:39], v[48:51]
    v_mfma_f32_16x16x32_bf16 v[52:55], a[68:71], v[36:39], v[52:55]
    ds_read_b128 v[32:35], v13 offset:5120
    ds_read_b128 v[36:39], v13 offset:25600
    s_waitcnt lgkmcnt(4)
    v_mfma_f32_16x16x32_bf16 v[40:43], a[72:75], v[16:19], v[40:43]
    v_mfma_f32_16x16x32_bf16 v[44:47], a[76:79], v[16:19], v[44:47]
    v_mfma_f32_16x16x32_bf16 v[48:51], a[72:75], v[20:23], v[48:51]
    v_mfma_f32_16x16x32_bf16 v[52:55], a[76:79], v[20:23], v[52:55]
    ds_read_b128 v[16:19], v12 offset:6144
    ds_read_b128 v[20:23], v12 offset:26624
    s_waitcnt lgkmcnt(4)
    v_mfma_f32_16x16x32_bf16 v[40:43], a[80:83], v[24:27], v[40:43]
    v_mfma_f32_16x16x32_bf16 v[44:47], a[84:87], v[24:27], v[44:47]
    v_mfma_f32_16x16x32_bf16 v[48:51], a[80:83], v[28:31], v[48:51]
    v_mfma_f32_16x16x32_bf16 v[52:55], a[84:87], v[28:31], v[52:55]
    ds_read_b128 v[24:27], v13 offset:6144
    ds_read_b128 v[28:31], v13 offset:26624
    s_waitcnt lgkmcnt(4)
    v_mfma_f32_16x16x32_bf16 v[40:43], a[88:91], v[32:35], v[40:43]
    v_mfma_f32_16x16x32_bf16 v[44:47], a[92:95], v[32:35], v[44:47]
    v_mfma_f32_16x16x32_bf16 v[48:51], a[88:91], v[36:39], v[48:51]
    v_mfma_f32_16x16x32_bf16 v[52:55], a[92:95], v[36:39], v[52:55]
    ds_read_b128 v[32:35], v12 offset:7168
    ds_read_b128 v[36:39], v12 offset:27648
    s_waitcnt lgkmcnt(4)
    v_mfma_f32_16x16x32_bf16 v[40:43], a[96:99], v[16:19], v[40:43]
    v_mfma_f32_16x16x32_bf16 v[44:47], a[100:103], v[16:19], v[44:47]
    v_mfma_f32_16x16x32_bf16 v[48:51], a[96:99], v[20:23], v[48:51]
    v_mfma_f32_16x16x32_bf16 v[52:55], a[100:103], v[20:23], v[52:55]
    ds_read_b128 v[16:19], v13 offset:7168
    ds_read_b128 v[20:23], v13 offset:27648
    s_waitcnt lgkmcnt(4)
    v_mfma_f32_16x16x32_bf16 v[40:43], a[104:107], v[24:27], v[40:43]
    v_mfma_f32_16x16x32_bf16 v[44:47], a[108:111], v[24:27], v[44:47]
    v_mfma_f32_16x16x32_bf16 v[48:51], a[104:107], v[28:31], v[48:51]
    v_mfma_f32_16x16x32_bf16 v[52:55], a[108:111], v[28:31], v[52:55]
    ds_read_b128 v[24:27], v12 offset:8192
    ds_read_b128 v[28:31], v12 offset:28672
    s_waitcnt lgkmcnt(4)
    v_mfma_f32_16x16x32_bf16 v[40:43], a[112:115], v[32:35], v[40:43]
    v_mfma_f32_16x16x32_bf16 v[44:47], a[116:119], v[32:35], v[44:47]
    v_mfma_f32_16x16x32_bf16 v[48:51], a[112:115], v[36:39], v[48:51]
    v_mfma_f32_16x16x32_bf16 v[52:55], a[116:119], v[36:39], v[52:55]
    ds_read_b128 v[32:35], v13 offset:8192
    ds_read_b128 v[36:39], v13 offset:28672
    s_waitcnt lgkmcnt(4)
    v_mfma_f32_16x16x32_bf16 v[40:43], a[120:123], v[16:19], v[40:43]
    v_mfma_f32_16x16x32_bf16 v[44:47], a[124:127], v[16:19], v[44:47]
    v_mfma_f32_16x16x32_bf16 v[48:51], a[120:123], v[20:23], v[48:51]
    v_mfma_f32_16x16x32_bf16 v[52:55], a[124:127], v[20:23], v[52:55]
    ds_read_b128 v[16:19], v12 offset:9216
    ds_read_b128 v[20:23], v12 offset:29696
    s_waitcnt lgkmcnt(4)
    v_mfma_f32_16x16x32_bf16 v[40:43], a[128:131], v[24:27], v[40:43]
    v_mfma_f32_16x16x32_bf16 v[44:47], a[132:135], v[24:27], v[44:47]
    v_mfma_f32_16x16x32_bf16 v[48:51], a[128:131], v[28:31], v[48:51]
    v_mfma_f32_16x16x32_bf16 v[52:55], a[132:135], v[28:31], v[52:55]
    ds_read_b128 v[24:27], v13 offset:9216
    ds_read_b128 v[28:31], v13 offset:29696
    s_waitcnt lgkmcnt(4)
    v_mfma_f32_16x16x32_bf16 v[40:43], a[136:139], v[32:35], v[40:43]
    v_mfma_f32_16x16x32_bf16 v[44:47], a[140:143], v[32:35], v[44:47]
    v_mfma_f32_16x16x32_bf16 v[48:51], a[136:139], v[36:39], v[48:51]
    v_mfma_f32_16x16x32_bf16 v[52:55], a[140:143], v[36:39], v[52:55]
    s_waitcnt lgkmcnt(2)
    v_mfma_f32_16x16x32_bf16 v[40:43], a[144:147], v[16:19], v[40:43]
    v_mfma_f32_16x16x32_bf16 v[44:47], a[148:151], v[16:19], v[44:47]
    v_mfma_f32_16x16x32_bf16 v[48:51], a[144:147], v[20:23], v[48:51]
    v_mfma_f32_16x16x32_bf16 v[52:55], a[148:151], v[20:23], v[52:55]
    s_waitcnt lgkmcnt(0)
    v_mfma_f32_16x16x32_bf16 v[40:43], a[152:155], v[24:27], v[40:43]
    v_mfma_f32_16x16x32_bf16 v[44:47], a[156:159], v[24:27], v[44:47]
    v_mfma_f32_16x16x32_bf16 v[48:51], a[152:155], v[28:31], v[48:51]
    v_mfma_f32_16x16x32_bf16 v[52:55], a[156:159], v[28:31], v[52:55]
L_nd2_38:
    s_nop 1
    v_cvt_pk_bf16_f32 v56, v40, v44
    v_cvt_pk_bf16_f32 v57, v41, v45
    v_cvt_pk_bf16_f32 v58, v42, v46
    v_cvt_pk_bf16_f32 v59, v43, v47
    global_store_dwordx4 v1, v[56:59], s[20:21] offset:0 sc1
    s_nop 0
    v_cvt_pk_bf16_f32 v60, v48, v52
    v_cvt_pk_bf16_f32 v61, v49, v53
    v_cvt_pk_bf16_f32 v62, v50, v54
    v_cvt_pk_bf16_f32 v63, v51, v55
    s_add_u32 s14, s20, 4096
    s_addc_u32 s15, s21, 0
    global_store_dwordx4 v1, v[60:63], s[14:15] sc1
    s_add_u32 s20, s20, 524288
    s_addc_u32 s21, s21, 0
    s_xor_b32 s26, s26, 40960
    v_add_u32 v12, s26, v14
    v_add_u32 v13, s26, v15
    s_add_u32 s18, s18, 1
    s_cmp_lt_u32 s18, 64
    s_cbranch_scc1 L_kp_loop
    s_waitcnt vmcnt(0)
    s_barrier
    s_mov_b32 s30, 64
    s_cmp_eq_u32 s5, 0
    s_cbranch_scc0 L_fl_39
    v_mov_b32 v5, s29
    v_mov_b32 v6, s30
    s_mov_b64 exec, 1
    global_store_dword v5, v6, s[22:23] sc1
    s_mov_b64 exec, -1
L_fl_39:
    s_waitcnt vmcnt(0)
    s_endpgm
L_vp:
    s_add_u32 s22, s8, 5767168
    s_addc_u32 s23, s9, 0
    s_lshl_b32 s29, s4, 7
    s_add_u32 s29, s29, 4096
    s_mov_b32 s30, 0
    s_cmp_eq_u32 s5, 0
    s_cbranch_scc0 L_fl_40
    v_mov_b32 v5, s29
    v_mov_b32 v6, s30
    s_mov_b64 exec, 1
    global_store_dword v5, v6, s[22:23] sc1
    s_mov_b64 exec, -1
L_fl_40:
    s_waitcnt vmcnt(0)
    s_barrier
    s_cmp_eq_u32 s5, 0
    s_cbranch_scc0 L_si_41
    s_lshl_b32 s10, s3, 5
    s_add_u32 s10, s10, 4
    v_mov_b32 v5, s10
    v_mov_b32 v6, 1
    s_mov_b64 exec, 1
    global_atomic_add v5, v6, s[6:7]
    s_mov_b64 exec, -1
L_si_41:
    s_load_dwordx2 s[16:17], s[0:1], 0
    v_lshlrev_b32 v1, 4, v0
    v_lshrrev_b32 v5, 3, v0
    v_and_b32 v6, 7, v0
    v_xor_b32 v6, v6, v5
    s_lshl_b32 s10, s5, 3
    v_add_u32 v5, s10, v5
    v_mul_u32_u24 v2, 1280, v5
    v_lshl_add_u32 v2, v6, 4, v2
    v_and_b32 v5, 7, v0
    v_bfe_u32 v6, v0, 3, 1
    v_mul_u32_u24 v3, 10240, v6
    v_lshl_add_u32 v3, v5, 7, v3
    v_lshrrev_b32 v6, 4, v0
    v_xor_b32 v14, v6, v5
    v_xor_b32 v6, 4, v14
    v_lshl_add_u32 v15, v6, 4, v3
    v_lshl_add_u32 v14, v14, 4, v3
    s_waitcnt lgkmcnt(0)
    s_mov_b32 s31, 0
    s_mul_i32 s13, s5, 10240
    s_add_u32 s13, s13, s31
    s_add_u32 m0, s13, 0
    s_nop 0
    global_load_lds_dwordx4 v2, s[16:17] offset:0
    s_add_u32 m0, s13, 896
    s_nop 0
    global_load_lds_dwordx4 v2, s[16:17] offset:128
    s_add_u32 m0, s13, 1792
    s_nop 0
    global_load_lds_dwordx4 v2, s[16:17] offset:256
    s_add_u32 m0, s13, 2688
    s_nop 0
    global_load_lds_dwordx4 v2, s[16:17] offset:384
    s_add_u32 m0, s13, 3584
    s_nop 0
    global_load_lds_dwordx4 v2, s[16:17] offset:512
    s_add_u32 m0, s13, 4480
    s_nop 0
    global_load_lds_dwordx4 v2, s[16:17] offset:640
    s_add_u32 m0, s13, 5376
    s_nop 0
    global_load_lds_dwordx4 v2, s[16:17] offset:768
    s_add_u32 m0, s13, 6272
    s_nop 0
    global_load_lds_dwordx4 v2, s[16:17] offset:896
    s_add_u32 m0, s13, 7168
    s_nop 0
    global_load_lds_dwordx4 v2, s[16:17] offset:1024
    s_add_u32 m0, s13, 8064
    s_nop 0
    global_load_lds_dwordx4 v2, s[16:17] offset:1152
    s_lshl_b32 s30, s4, 8
    s_lshl_b32 s31, s5, 6
    s_add_u32 s30, s30, s31
    s_load_dwordx2 s[10:11], s[0:1], 32
    v_and_b32 v9, 15, v0
    v_lshrrev_b32 v10, 4, v0
    v_lshlrev_b32 v10, 3, v10
    s_mov_b32 s12, 8192
    v_mul_lo_u32 v8, v10, s12
    v_lshl_add_u32 v8, v9, 2, v8
    v_add_u32 v8, s30, v8
    s_mov_b32 s24, 0x05040100
    s_mov_b32 s25, 0x07060302
    s_waitcnt lgkmcnt(0)
    s_mov_b32 s76, s10
    s_and_b32 s77, s11, 0xffff
    s_mov_b32 s78, 5242880
    s_mov_b32 s79, 0x20000
    s_mov_b32 s10, 0
    buffer_load_dword v64, v8, s[76:79], s10 offen
    s_mov_b32 s11, 8192
    buffer_load_dword v65, v8, s[76:79], s11 offen
    s_mov_b32 s10, 16384
    buffer_load_dword v66, v8, s[76:79], s10 offen
    s_mov_b32 s11, 24576
    buffer_load_dword v67, v8, s[76:79], s11 offen
    s_mov_b32 s10, 32768
    buffer_load_dword v68, v8, s[76:79], s10 offen
    s_mov_b32 s11, 40960
    buffer_load_dword v69, v8, s[76:79], s11 offen
    s_mov_b32 s10, 49152
    buffer_load_dword v70, v8, s[76:79], s10 offen
    s_mov_b32 s11, 57344
    buffer_load_dword v71, v8, s[76:79], s11 offen
    s_mov_b32 s10, 262144
    buffer_load_dword v72, v8, s[76:79], s10 offen
    s_mov_b32 s11, 270336
    buffer_load_dword v73, v8, s[76:79], s11 offen
    s_mov_b32 s10, 278528
    buffer_load_dword v74, v8, s[76:79], s10 offen
    s_mov_b32 s11, 286720
    buffer_load_dword v75, v8, s[76:79], s11 offen
    s_mov_b32 s10, 294912
    buffer_load_dword v76, v8, s[76:79], s10 offen
    s_mov_b32 s11, 303104
    buffer_load_dword v77, v8, s[76:79], s11 offen
    s_mov_b32 s10, 311296
    buffer_load_dword v78, v8, s[76:79], s10 offen
    s_mov_b32 s11, 319488
    buffer_load_dword v79, v8, s[76:79], s11 offen
    s_mov_b32 s10, 524288
    buffer_load_dword v96, v8, s[76:79], s10 offen
    s_mov_b32 s11, 532480
    buffer_load_dword v97, v8, s[76:79], s11 offen
    s_mov_b32 s10, 540672
    buffer_load_dword v98, v8, s[76:79], s10 offen
    s_mov_b32 s11, 548864
    buffer_load_dword v99, v8, s[76:79], s11 offen
    s_mov_b32 s10, 557056
    buffer_load_dword v100, v8, s[76:79], s10 offen
    s_mov_b32 s11, 565248
    buffer_load_dword v101, v8, s[76:79], s11 offen
    s_mov_b32 s10, 573440
    buffer_load_dword v102, v8, s[76:79], s10 offen
    s_mov_b32 s11, 581632
    buffer_load_dword v103, v8, s[76:79], s11 offen
    s_mov_b32 s10, 786432
    buffer_load_dword v104, v8, s[76:79], s10 offen
    s_mov_b32 s11, 794624
    buffer_load_dword v105, v8, s[76:79], s11 offen
    s_mov_b32 s10, 802816
    buffer_load_dword v106, v8, s[76:79], s10 offen
    s_mov_b32 s11, 811008
    buffer_load_dword v107, v8, s[76:79], s11 offen
    s_mov_b32 s10, 819200
    buffer_load_dword v108, v8, s[76:79], s10 offen
    s_mov_b32 s11, 827392
    buffer_load_dword v109, v8, s[76:79], s11 offen
    s_mov_b32 s10, 835584
    buffer_load_dword v110, v8, s[76:79], s10 offen
    s_mov_b32 s11, 843776
    buffer_load_dword v111, v8, s[76:79], s11 offen
    s_mov_b32 s10, 1048576
    buffer_load_dword v128, v8, s[76:79], s10 offen
    s_mov_b32 s11, 1056768
    buffer_load_dword v129, v8, s[76:79], s11 offen
    s_mov_b32 s10, 1064960
    buffer_load_dword v130, v8, s[76:79], s10 offen
    s_mov_b32 s11, 1073152
    buffer_load_dword v131, v8, s[76:79], s11 offen
    s_mov_b32 s10, 1081344
    buffer_load_dword v132, v8, s[76:79], s10 offen
    s_mov_b32 s11, 1089536
    buffer_load_dword v133, v8, s[76:79], s11 offen
    s_mov_b32 s10, 1097728
    buffer_load_dword v134, v8, s[76:79], s10 offen
    s_mov_b32 s11, 1105920
    buffer_load_dword v135, v8, s[76:79], s11 offen
    s_mov_b32 s10, 1310720
    buffer_load_dword v136, v8, s[76:79], s10 offen
    s_mov_b32 s11, 1318912
    buffer_load_dword v137, v8, s[76:79], s11 offen
    s_mov_b32 s10, 1327104
    buffer_load_dword v138, v8, s[76:79], s10 offen
    s_mov_b32 s11, 1335296
    buffer_load_dword v139, v8, s[76:79], s11 offen
    s_mov_b32 s10, 1343488
    buffer_load_dword v140, v8, s[76:79], s10 offen
    s_mov_b32 s11, 1351680
    buffer_load_dword v141, v8, s[76:79], s11 offen
    s_mov_b32 s10, 1359872
    buffer_load_dword v142, v8, s[76:79], s10 offen
    s_mov_b32 s11, 1368064
    buffer_load_dword v143, v8, s[76:79], s11 offen
    s_waitcnt vmcnt(32)
    v_perm_b32 v11, v65, v64, s24
    v_accvgpr_write_b32 a0, v11
    v_perm_b32 v12, v67, v66, s24
    v_accvgpr_write_b32 a1, v12
    v_perm_b32 v11, v69, v68, s24
    v_accvgpr_write_b32 a2, v11
    v_perm_b32 v12, v71, v70, s24
    v_accvgpr_write_b32 a3, v12
    v_perm_b32 v11, v65, v64, s25
    v_accvgpr_write_b32 a4, v11
    v_perm_b32 v12, v67, v66, s25
    v_accvgpr_write_b32 a5, v12
    v_perm_b32 v11, v69, v68, s25
    v_accvgpr_write_b32 a6, v11
    v_perm_b32 v12, v71, v70, s25
    v_accvgpr_write_b32 a7, v12
    v_perm_b32 v11, v73, v72, s24
    v_accvgpr_write_b32 a8, v11
    v_perm_b32 v12, v75, v74, s24
    v_accvgpr_write_b32 a9, v12
    v_perm_b32 v11, v77, v76, s24
    v_accvgpr_write_b32 a10, v11
    v_perm_b32 v12, v79, v78, s24
    v_accvgpr_write_b32 a11, v12
    v_perm_b32 v11, v73, v72, s25
    v_accvgpr_write_b32 a12, v11
    v_perm_b32 v12, v75, v74, s25
    v_accvgpr_write_b32 a13, v12
    v_perm_b32 v11, v77, v76, s25
    v_accvgpr_write_b32 a14, v11
    v_perm_b32 v12, v79, v78, s25
    v_accvgpr_write_b32 a15, v12
    s_mov_b32 s10, 1572864
    buffer_load_dword v64, v8, s[76:79], s10 offen
    s_mov_b32 s11, 1581056
    buffer_load_dword v65, v8, s[76:79], s11 offen
    s_mov_b32 s10, 1589248
    buffer_load_dword v66, v8, s[76:79], s10 offen
    s_mov_b32 s11, 1597440
    buffer_load_dword v67, v8, s[76:79], s11 offen
    s_mov_b32 s10, 1605632
    buffer_load_dword v68, v8, s[76:79], s10 offen
    s_mov_b32 s11, 1613824
    buffer_load_dword v69, v8, s[76:79], s11 offen
    s_mov_b32 s10, 1622016
    buffer_load_dword v70, v8, s[76:79], s10 offen
    s_mov_b32 s11, 1630208
    buffer_load_dword v71, v8, s[76:79], s11 offen
    s_mov_b32 s10, 1835008
    buffer_load_dword v72, v8, s[76:79], s10 offen
    s_mov_b32 s11, 1843200
    buffer_load_dword v73, v8, s[76:79], s11 offen
    s_mov_b32 s10, 1851392
    buffer_load_dword v74, v8, s[76:79], s10 offen
    s_mov_b32 s11, 1859584
    buffer_load_dword v75, v8, s[76:79], s11 offen
    s_mov_b32 s10, 1867776
    buffer_load_dword v76, v8, s[76:79], s10 offen
    s_mov_b32 s11, 1875968
    buffer_load_dword v77, v8, s[76:79], s11 offen
    s_mov_b32 s10, 1884160
    buffer_load_dword v78, v8, s[76:79], s10 offen
    s_mov_b32 s11, 1892352
    buffer_load_dword v79, v8, s[76:79], s11 offen
    s_waitcnt vmcnt(32)
    v_perm_b32 v11, v97, v96, s24
    v_accvgpr_write_b32 a16, v11
    v_perm_b32 v12, v99, v98, s24
    v_accvgpr_write_b32 a17, v12
    v_perm_b32 v11, v101, v100, s24
    v_accvgpr_write_b32 a18, v11
    v_perm_b32 v12, v103, v102, s24
    v_accvgpr_write_b32 a19, v12
    v_perm_b32 v11, v97, v96, s25
    v_accvgpr_write_b32 a20, v11
    v_perm_b32 v12, v99, v98, s25
    v_accvgpr_write_b32 a21, v12
    v_perm_b32 v11, v101, v100, s25
    v_accvgpr_write_b32 a22, v11
    v_perm_b32 v12, v103, v102, s25
    v_accvgpr_write_b32 a23, v12
    v_perm_b32 v11, v105, v104, s24
    v_accvgpr_write_b32 a24, v11
    v_perm_b32 v12, v107, v106, s24
    v_accvgpr_write_b32 a25, v12
    v_perm_b32 v11, v109, v108, s24
    v_accvgpr_write_b32 a26, v11
    v_perm_b32 v12, v111, v110, s24
    v_accvgpr_write_b32 a27, v12
    v_perm_b32 v11, v105, v104, s25
    v_accvgpr_write_b32 a28, v11
    v_perm_b32 v12, v107, v106, s25
    v_accvgpr_write_b32 a29, v12
    v_perm_b32 v11, v109, v108, s25
    v_accvgpr_write_b32 a30, v11
    v_perm_b32 v12, v111, v110, s25
    v_accvgpr_write_b32 a31, v12
    s_mov_b32 s10, 2097152
    buffer_load_dword v96, v8, s[76:79], s10 offen
    s_mov_b32 s11, 2105344
    buffer_load_dword v97, v8, s[76:79], s11 offen
    s_mov_b32 s10, 2113536
    buffer_load_dword v98, v8, s[76:79], s10 offen
    s_mov_b32 s11, 2121728
    buffer_load_dword v99, v8, s[76:79], s11 offen
    s_mov_b32 s10, 2129920
    buffer_load_dword v100, v8, s[76:79], s10 offen
    s_mov_b32 s11, 2138112
    buffer_load_dword v101, v8, s[76:79], s11 offen
    s_mov_b32 s10, 2146304
    buffer_load_dword v102, v8, s[76:79], s10 offen
    s_mov_b32 s11, 2154496
    buffer_load_dword v103, v8, s[76:79], s11 offen
    s_mov_b32 s10, 2359296
    buffer_load_dword v104, v8, s[76:79], s10 offen
    s_mov_b32 s11, 2367488
    buffer_load_dword v105, v8, s[76:79], s11 offen
    s_mov_b32 s10, 2375680
    buffer_load_dword v106, v8, s[76:79], s10 offen
    s_mov_b32 s11, 2383872
    buffer_load_dword v107, v8, s[76:79], s11 offen
    s_mov_b32 s10, 2392064
    buffer_load_dword v108, v8, s[76:79], s10 offen
    s_mov_b32 s11, 2400256
    buffer_load_dword v109, v8, s[76:79], s11 offen
    s_mov_b32 s10, 2408448
    buffer_load_dword v110, v8, s[76:79], s10 offen
    s_mov_b32 s11, 2416640
    buffer_load_dword v111, v8, s[76:79], s11 offen
    s_waitcnt vmcnt(32)
    v_perm_b32 v11, v129, v128, s24
    v_accvgpr_write_b32 a32, v11
    v_perm_b32 v12, v131, v130, s24
    v_accvgpr_write_b32 a33, v12
    v_perm_b32 v11, v133, v132, s24
    v_accvgpr_write_b32 a34, v11
    v_perm_b32 v12, v135, v134, s24
    v_accvgpr_write_b32 a35, v12
    v_perm_b32 v11, v129, v128, s25
    v_accvgpr_write_b32 a36, v11
    v_perm_b32 v12, v131, v130, s25
    v_accvgpr_write_b32 a37, v12
    v_perm_b32 v11, v133, v132, s25
    v_accvgpr_write_b32 a38, v11
    v_perm_b32 v12, v135, v134, s25
    v_accvgpr_write_b32 a39, v12
    v_perm_b32 v11, v137, v136, s24
    v_accvgpr_write_b32 a40, v11
    v_perm_b32 v12, v139, v138, s24
    v_accvgpr_write_b32 a41, v12
    v_perm_b32 v11, v141, v140, s24
    v_accvgpr_write_b32 a42, v11
    v_perm_b32 v12, v143, v142, s24
    v_accvgpr_write_b32 a43, v12
    v_perm_b32 v11, v137, v136, s25
    v_accvgpr_write_b32 a44, v11
    v_perm_b32 v12, v139, v138, s25
    v_accvgpr_write_b32 a45, v12
    v_perm_b32 v11, v141, v140, s25
    v_accvgpr_write_b32 a46, v11
    v_perm_b32 v12, v143, v142, s25
    v_accvgpr_write_b32 a47, v12
    s_mov_b32 s10, 2621440
    buffer_load_dword v128, v8, s[76:79], s10 offen
    s_mov_b32 s11, 2629632
    buffer_load_dword v129, v8, s[76:79], s11 offen
    s_mov_b32 s10, 2637824
    buffer_load_dword v130, v8, s[76:79], s10 offen
    s_mov_b32 s11, 2646016
    buffer_load_dword v131, v8, s[76:79], s11 offen
    s_mov_b32 s10, 2654208
    buffer_load_dword v132, v8, s[76:79], s10 offen
    s_mov_b32 s11, 2662400
    buffer_load_dword v133, v8, s[76:79], s11 offen
    s_mov_b32 s10, 2670592
    buffer_load_dword v134, v8, s[76:79], s10 offen
    s_mov_b32 s11, 2678784
    buffer_load_dword v135, v8, s[76:79], s11 offen
    s_mov_b32 s10, 2883584
    buffer_load_dword v136, v8, s[76:79], s10 offen
    s_mov_b32 s11, 2891776
    buffer_load_dword v137, v8, s[76:79], s11 offen
    s_mov_b32 s10, 2899968
    buffer_load_dword v138, v8, s[76:79], s10 offen
    s_mov_b32 s11, 2908160
    buffer_load_dword v139, v8, s[76:79], s11 offen
    s_mov_b32 s10, 2916352
    buffer_load_dword v140, v8, s[76:79], s10 offen
    s_mov_b32 s11, 2924544
    buffer_load_dword v141, v8, s[76:79], s11 offen
    s_mov_b32 s10, 2932736
    buffer_load_dword v142, v8, s[76:79], s10 offen
    s_mov_b32 s11, 2940928
    buffer_load_dword v143, v8, s[76:79], s11 offen
    s_waitcnt vmcnt(32)
    v_perm_b32 v11, v65, v64, s24
    v_accvgpr_write_b32 a48, v11
    v_perm_b32 v12, v67, v66, s24
    v_accvgpr_write_b32 a49, v12
    v_perm_b32 v11, v69, v68, s24
    v_accvgpr_write_b32 a50, v11
    v_perm_b32 v12, v71, v70, s24
    v_accvgpr_write_b32 a51, v12
    v_perm_b32 v11, v65, v64, s25
    v_accvgpr_write_b32 a52, v11
    v_perm_b32 v12, v67, v66, s25
    v_accvgpr_write_b32 a53, v12
    v_perm_b32 v11, v69, v68, s25
    v_accvgpr_write_b32 a54, v11
    v_perm_b32 v12, v71, v70, s25
    v_accvgpr_write_b32 a55, v12
    v_perm_b32 v11, v73, v72, s24
    v_accvgpr_write_b32 a56, v11
    v_perm_b32 v12, v75, v74, s24
    v_accvgpr_write_b32 a57, v12
    v_perm_b32 v11, v77, v76, s24
    v_accvgpr_write_b32 a58, v11
    v_perm_b32 v12, v79, v78, s24
    v_accvgpr_write_b32 a59, v12
    v_perm_b32 v11, v73, v72, s25
    v_accvgpr_write_b32 a60, v11
    v_perm_b32 v12, v75, v74, s25
    v_accvgpr_write_b32 a61, v12
    v_perm_b32 v11, v77, v76, s25
    v_accvgpr_write_b32 a62, v11
    v_perm_b32 v12, v79, v78, s25
    v_accvgpr_write_b32 a63, v12
    s_mov_b32 s10, 3145728
    buffer_load_dword v64, v8, s[76:79], s10 offen
    s_mov_b32 s11, 3153920
    buffer_load_dword v65, v8, s[76:79], s11 offen
    s_mov_b32 s10, 3162112
    buffer_load_dword v66, v8, s[76:79], s10 offen
    s_mov_b32 s11, 3170304
    buffer_load_dword v67, v8, s[76:79], s11 offen
    s_mov_b32 s10, 3178496
    buffer_load_dword v68, v8, s[76:79], s10 offen
    s_mov_b32 s11, 3186688
    buffer_load_dword v69, v8, s[76:79], s11 offen
    s_mov_b32 s10, 3194880
    buffer_load_dword v70, v8, s[76:79], s10 offen
    s_mov_b32 s11, 3203072
    buffer_load_dword v71, v8, s[76:79], s11 offen
    s_mov_b32 s10, 3407872
    buffer_load_dword v72, v8, s[76:79], s10 offen
    s_mov_b32 s11, 3416064
    buffer_load_dword v73, v8, s[76:79], s11 offen
    s_mov_b32 s10, 3424256
    buffer_load_dword v74, v8, s[76:79], s10 offen
    s_mov_b32 s11, 3432448
    buffer_load_dword v75, v8, s[76:79], s11 offen
    s_mov_b32 s10, 3440640
    buffer_load_dword v76, v8, s[76:79], s10 offen
    s_mov_b32 s11, 3448832
    buffer_load_dword v77, v8, s[76:79], s11 offen
    s_mov_b32 s10, 3457024
    buffer_load_dword v78, v8, s[76:79], s10 offen
    s_mov_b32 s11, 3465216
    buffer_load_dword v79, v8, s[76:79], s11 offen
    s_waitcnt vmcnt(32)
    v_perm_b32 v11, v97, v96, s24
    v_accvgpr_write_b32 a64, v11
    v_perm_b32 v12, v99, v98, s24
    v_accvgpr_write_b32 a65, v12
    v_perm_b32 v11, v101, v100, s24
    v_accvgpr_write_b32 a66, v11
    v_perm_b32 v12, v103, v102, s24
    v_accvgpr_write_b32 a67, v12
    v_perm_b32 v11, v97, v96, s25
    v_accvgpr_write_b32 a68, v11
    v_perm_b32 v12, v99, v98, s25
    v_accvgpr_write_b32 a69, v12
    v_perm_b32 v11, v101, v100, s25
    v_accvgpr_write_b32 a70, v11
    v_perm_b32 v12, v103, v102, s25
    v_accvgpr_write_b32 a71, v12
    v_perm_b32 v11, v105, v104, s24
    v_accvgpr_write_b32 a72, v11
    v_perm_b32 v12, v107, v106, s24
    v_accvgpr_write_b32 a73, v12
    v_perm_b32 v11, v109, v108, s24
    v_accvgpr_write_b32 a74, v11
    v_perm_b32 v12, v111, v110, s24
    v_accvgpr_write_b32 a75, v12
    v_perm_b32 v11, v105, v104, s25
    v_accvgpr_write_b32 a76, v11
    v_perm_b32 v12, v107, v106, s25
    v_accvgpr_write_b32 a77, v12
    v_perm_b32 v11, v109, v108, s25
    v_accvgpr_write_b32 a78, v11
    v_perm_b32 v12, v111, v110, s25
    v_accvgpr_write_b32 a79, v12
    s_mov_b32 s10, 3670016
    buffer_load_dword v96, v8, s[76:79], s10 offen
    s_mov_b32 s11, 3678208
    buffer_load_dword v97, v8, s[76:79], s11 offen
    s_mov_b32 s10, 3686400
    buffer_load_dword v98, v8, s[76:79], s10 offen
    s_mov_b32 s11, 3694592
    buffer_load_dword v99, v8, s[76:79], s11 offen
    s_mov_b32 s10, 3702784
    buffer_load_dword v100, v8, s[76:79], s10 offen
    s_mov_b32 s11, 3710976
    buffer_load_dword v101, v8, s[76:79], s11 offen
    s_mov_b32 s10, 3719168
    buffer_load_dword v102, v8, s[76:79], s10 offen
    s_mov_b32 s11, 3727360
    buffer_load_dword v103, v8, s[76:79], s11 offen
    s_mov_b32 s10, 3932160
    buffer_load_dword v104, v8, s[76:79], s10 offen
    s_mov_b32 s11, 3940352
    buffer_load_dword v105, v8, s[76:79], s11 offen
    s_mov_b32 s10, 3948544
    buffer_load_dword v106, v8, s[76:79], s10 offen
    s_mov_b32 s11, 3956736
    buffer_load_dword v107, v8, s[76:79], s11 offen
    s_mov_b32 s10, 3964928
    buffer_load_dword v108, v8, s[76:79], s10 offen
    s_mov_b32 s11, 3973120
    buffer_load_dword v109, v8, s[76:79], s11 offen
    s_mov_b32 s10, 3981312
    buffer_load_dword v110, v8, s[76:79], s10 offen
    s_mov_b32 s11, 3989504
    buffer_load_dword v111, v8, s[76:79], s11 offen
    s_waitcnt vmcnt(32)
    v_perm_b32 v11, v129, v128, s24
    v_accvgpr_write_b32 a80, v11
    v_perm_b32 v12, v131, v130, s24
    v_accvgpr_write_b32 a81, v12
    v_perm_b32 v11, v133, v132, s24
    v_accvgpr_write_b32 a82, v11
    v_perm_b32 v12, v135, v134, s24
    v_accvgpr_write_b32 a83, v12
    v_perm_b32 v11, v129, v128, s25
    v_accvgpr_write_b32 a84, v11
    v_perm_b32 v12, v131, v130, s25
    v_accvgpr_write_b32 a85, v12
    v_perm_b32 v11, v133, v132, s25
    v_accvgpr_write_b32 a86, v11
    v_perm_b32 v12, v135, v134, s25
    v_accvgpr_write_b32 a87, v12
    v_perm_b32 v11, v137, v136, s24
    v_accvgpr_write_b32 a88, v11
    v_perm_b32 v12, v139, v138, s24
    v_accvgpr_write_b32 a89, v12
    v_perm_b32 v11, v141, v140, s24
    v_accvgpr_write_b32 a90, v11
    v_perm_b32 v12, v143, v142, s24
    v_accvgpr_write_b32 a91, v12
    v_perm_b32 v11, v137, v136, s25
    v_accvgpr_write_b32 a92, v11
    v_perm_b32 v12, v139, v138, s25
    v_accvgpr_write_b32 a93, v12
    v_perm_b32 v11, v141, v140, s25
    v_accvgpr_write_b32 a94, v11
    v_perm_b32 v12, v143, v142, s25
    v_accvgpr_write_b32 a95, v12
    s_mov_b32 s10, 4194304
    buffer_load_dword v128, v8, s[76:79], s10 offen
    s_mov_b32 s11, 4202496
    buffer_load_dword v129, v8, s[76:79], s11 offen
    s_mov_b32 s10, 4210688
    buffer_load_dword v130, v8, s[76:79], s10 offen
    s_mov_b32 s11, 4218880
    buffer_load_dword v131, v8, s[76:79], s11 offen
    s_mov_b32 s10, 4227072
    buffer_load_dword v132, v8, s[76:79], s10 offen
    s_mov_b32 s11, 4235264
    buffer_load_dword v133, v8, s[76:79], s11 offen
    s_mov_b32 s10, 4243456
    buffer_load_dword v134, v8, s[76:79], s10 offen
    s_mov_b32 s11, 4251648
    buffer_load_dword v135, v8, s[76:79], s11 offen
    s_mov_b32 s10, 4456448
    buffer_load_dword v136, v8, s[76:79], s10 offen
    s_mov_b32 s11, 4464640
    buffer_load_dword v137, v8, s[76:79], s11 offen
    s_mov_b32 s10, 4472832
    buffer_load_dword v138, v8, s[76:79], s10 offen
    s_mov_b32 s11, 4481024
    buffer_load_dword v139, v8, s[76:79], s11 offen
    s_mov_b32 s10, 4489216
    buffer_load_dword v140, v8, s[76:79], s10 offen
    s_mov_b32 s11, 4497408
    buffer_load_dword v141, v8, s[76:79], s11 offen
    s_mov_b32 s10, 4505600
    buffer_load_dword v142, v8, s[76:79], s10 offen
    s_mov_b32 s11, 4513792
    buffer_load_dword v143, v8, s[76:79], s11 offen
    s_waitcnt vmcnt(32)
    v_perm_b32 v11, v65, v64, s24
    v_accvgpr_write_b32 a96, v11
    v_perm_b32 v12, v67, v66, s24
    v_accvgpr_write_b32 a97, v12
    v_perm_b32 v11, v69, v68, s24
    v_accvgpr_write_b32 a98, v11
    v_perm_b32 v12, v71, v70, s24
    v_accvgpr_write_b32 a99, v12
    v_perm_b32 v11, v65, v64, s25
    v_accvgpr_write_b32 a100, v11
    v_perm_b32 v12, v67, v66, s25
    v_accvgpr_write_b32 a101, v12
    v_perm_b32 v11, v69, v68, s25
    v_accvgpr_write_b32 a102, v11
    v_perm_b32 v12, v71, v70, s25
    v_accvgpr_write_b32 a103, v12
    v_perm_b32 v11, v73, v72, s24
    v_accvgpr_write_b32 a104, v11
    v_perm_b32 v12, v75, v74, s24
    v_accvgpr_write_b32 a105, v12
    v_perm_b32 v11, v77, v76, s24
    v_accvgpr_write_b32 a106, v11
    v_perm_b32 v12, v79, v78, s24
    v_accvgpr_write_b32 a107, v12
    v_perm_b32 v11, v73, v72, s25
    v_accvgpr_write_b32 a108, v11
    v_perm_b32 v12, v75, v74, s25
    v_accvgpr_write_b32 a109, v12
    v_perm_b32 v11, v77, v76, s25
    v_accvgpr_write_b32 a110, v11
    v_perm_b32 v12, v79, v78, s25
    v_accvgpr_write_b32 a111, v12
    s_mov_b32 s10, 4718592
    buffer_load_dword v64, v8, s[76:79], s10 offen
    s_mov_b32 s11, 4726784
    buffer_load_dword v65, v8, s[76:79], s11 offen
    s_mov_b32 s10, 4734976
    buffer_load_dword v66, v8, s[76:79], s10 offen
    s_mov_b32 s11, 4743168
    buffer_load_dword v67, v8, s[76:79], s11 offen
    s_mov_b32 s10, 4751360
    buffer_load_dword v68, v8, s[76:79], s10 offen
    s_mov_b32 s11, 4759552
    buffer_load_dword v69, v8, s[76:79], s11 offen
    s_mov_b32 s10, 4767744
    buffer_load_dword v70, v8, s[76:79], s10 offen
    s_mov_b32 s11, 4775936
    buffer_load_dword v71, v8, s[76:79], s11 offen
    s_mov_b32 s10, 4980736
    buffer_load_dword v72, v8, s[76:79], s10 offen
    s_mov_b32 s11, 4988928
    buffer_load_dword v73, v8, s[76:79], s11 offen
    s_mov_b32 s10, 4997120
    buffer_load_dword v74, v8, s[76:79], s10 offen
    s_mov_b32 s11, 5005312
    buffer_load_dword v75, v8, s[76:79], s11 offen
    s_mov_b32 s10, 5013504
    buffer_load_dword v76, v8, s[76:79], s10 offen
    s_mov_b32 s11, 5021696
    buffer_load_dword v77, v8, s[76:79], s11 offen
    s_mov_b32 s10, 5029888
    buffer_load_dword v78, v8, s[76:79], s10 offen
    s_mov_b32 s11, 5038080
    buffer_load_dword v79, v8, s[76:79], s11 offen
    s_waitcnt vmcnt(32)
    v_perm_b32 v11, v97, v96, s24
    v_accvgpr_write_b32 a112, v11
    v_perm_b32 v12, v99, v98, s24
    v_accvgpr_write_b32 a113, v12
    v_perm_b32 v11, v101, v100, s24
    v_accvgpr_write_b32 a114, v11
    v_perm_b32 v12, v103, v102, s24
    v_accvgpr_write_b32 a115, v12
    v_perm_b32 v11, v97, v96, s25
    v_accvgpr_write_b32 a116, v11
    v_perm_b32 v12, v99, v98, s25
    v_accvgpr_write_b32 a117, v12
    v_perm_b32 v11, v101, v100, s25
    v_accvgpr_write_b32 a118, v11
    v_perm_b32 v12, v103, v102, s25
    v_accvgpr_write_b32 a119, v12
    v_perm_b32 v11, v105, v104, s24
    v_accvgpr_write_b32 a120, v11
    v_perm_b32 v12, v107, v106, s24
    v_accvgpr_write_b32 a121, v12
    v_perm_b32 v11, v109, v108, s24
    v_accvgpr_write_b32 a122, v11
    v_perm_b32 v12, v111, v110, s24
    v_accvgpr_write_b32 a123, v12
    v_perm_b32 v11, v105, v104, s25
    v_accvgpr_write_b32 a124, v11
    v_perm_b32 v12, v107, v106, s25
    v_accvgpr_write_b32 a125, v12
    v_perm_b32 v11, v109, v108, s25
    v_accvgpr_write_b32 a126, v11
    v_perm_b32 v12, v111, v110, s25
    v_accvgpr_write_b32 a127, v12
    s_waitcnt vmcnt(16)
    v_perm_b32 v11, v129, v128, s24
    v_accvgpr_write_b32 a128, v11
    v_perm_b32 v12, v131, v130, s24
    v_accvgpr_write_b32 a129, v12
    v_perm_b32 v11, v133, v132, s24
    v_accvgpr_write_b32 a130, v11
    v_perm_b32 v12, v135, v134, s24
    v_accvgpr_write_b32 a131, v12
    v_perm_b32 v11, v129, v128, s25
    v_accvgpr_write_b32 a132, v11
    v_perm_b32 v12, v131, v130, s25
    v_accvgpr_write_b32 a133, v12
    v_perm_b32 v11, v133, v132, s25
    v_accvgpr_write_b32 a134, v11
    v_perm_b32 v12, v135, v134, s25
    v_accvgpr_write_b32 a135, v12
    v_perm_b32 v11, v137, v136, s24
    v_accvgpr_write_b32 a136, v11
    v_perm_b32 v12, v139, v138, s24
    v_accvgpr_write_b32 a137, v12
    v_perm_b32 v11, v141, v140, s24
    v_accvgpr_write_b32 a138, v11
    v_perm_b32 v12, v143, v142, s24
    v_accvgpr_write_b32 a139, v12
    v_perm_b32 v11, v137, v136, s25
    v_accvgpr_write_b32 a140, v11
    v_perm_b32 v12, v139, v138, s25
    v_accvgpr_write_b32 a141, v12
    v_perm_b32 v11, v141, v140, s25
    v_accvgpr_write_b32 a142, v11
    v_perm_b32 v12, v143, v142, s25
    v_accvgpr_write_b32 a143, v12
    s_waitcnt vmcnt(0)
    v_perm_b32 v11, v65, v64, s24
    v_accvgpr_write_b32 a144, v11
    v_perm_b32 v12, v67, v66, s24
    v_accvgpr_write_b32 a145, v12
    v_perm_b32 v11, v69, v68, s24
    v_accvgpr_write_b32 a146, v11
    v_perm_b32 v12, v71, v70, s24
    v_accvgpr_write_b32 a147, v12
    v_perm_b32 v11, v65, v64, s25
    v_accvgpr_write_b32 a148, v11
    v_perm_b32 v12, v67, v66, s25
    v_accvgpr_write_b32 a149, v12
    v_perm_b32 v11, v69, v68, s25
    v_accvgpr_write_b32 a150, v11
    v_perm_b32 v12, v71, v70, s25
    v_accvgpr_write_b32 a151, v12
    v_perm_b32 v11, v73, v72, s24
    v_accvgpr_write_b32 a152, v11
    v_perm_b32 v12, v75, v74, s24
    v_accvgpr_write_b32 a153, v12
    v_perm_b32 v11, v77, v76, s24
    v_accvgpr_write_b32 a154, v11
    v_perm_b32 v12, v79, v78, s24
    v_accvgpr_write_b32 a155, v12
    v_perm_b32 v11, v73, v72, s25
    v_accvgpr_write_b32 a156, v11
    v_perm_b32 v12, v75, v74, s25
    v_accvgpr_write_b32 a157, v12
    v_perm_b32 v11, v77, v76, s25
    v_accvgpr_write_b32 a158, v11
    v_perm_b32 v12, v79, v78, s25
    v_accvgpr_write_b32 a159, v12
    s_lshl_b32 s10, s4, 14
    s_lshl_b32 s11, s5, 11
    s_add_u32 s10, s10, s11
    s_add_u32 s10, s10, 16785408
    s_add_u32 s20, s8, s10
    s_addc_u32 s21, s9, 0
    v_lshlrev_b32 v5, 5, v0
    v_add_u32 v5, 4, v5
    s_mov_b32 s27, 0
L_wi_42:
    s_mov_b64 exec, 0xff
    global_load_dword v6, v5, s[6:7] sc1
    s_waitcnt vmcnt(0)
    s_mov_b64 exec, -1
    v_readlane_b32 s10, v6, 0
    v_readlane_b32 s11, v6, 1
    s_add_u32 s10, s10, s11
    v_readlane_b32 s11, v6, 2
    s_add_u32 s10, s10, s11
    v_readlane_b32 s11, v6, 3
    s_add_u32 s10, s10, s11
    v_readlane_b32 s11, v6, 4
    s_add_u32 s10, s10, s11
    v_readlane_b32 s11, v6, 5
    s_add_u32 s10, s10, s11
    v_readlane_b32 s11, v6, 6
    s_add_u32 s10, s10, s11
    v_readlane_b32 s11, v6, 7
    s_add_u32 s10, s10, s11
    s_cmp_ge_u32 s10, 256
    s_cbranch_scc1 L_wiok_43
    s_sleep 4
    s_add_u32 s27, s27, 1
    s_cmp_lt_u32 s27, 262144
    s_cbranch_scc1 L_wi_42
    s_branch L_timeout
L_wiok_43:
    s_mov_b32 s18, 0
    s_mov_b32 s26, 0
    v_add_u32 v12, 0, v14
    v_add_u32 v13, 0, v15
    s_waitcnt vmcnt(0)
L_vp_loop:
    s_waitcnt vmcnt(2)
    s_barrier
    s_cmp_lt_u32 s18, 2
    s_cbranch_scc1 L_nf_44
    s_sub_u32 s30, s18, 1
    s_cmp_eq_u32 s5, 0
    s_cbranch_scc0 L_fl_45
    v_mov_b32 v5, s29
    v_mov_b32 v6, s30
    s_mov_b64 exec, 1
    global_store_dword v5, v6, s[22:23] sc1
    s_mov_b64 exec, -1
L_fl_45:
L_nf_44:
    s_add_u32 s30, s18, 1
    s_cmp_ge_u32 s30, 64
    s_cbranch_scc1 L_nd_46
    s_add_u32 s16, s16, 40960
    s_addc_u32 s17, s17, 0
    s_xor_b32 s31, s26, 40960
    s_mul_i32 s13, s5, 10240
    s_add_u32 s13, s13, s31
    ds_read_b128 v[16:19], v12 offset:0
    ds_read_b128 v[20:23], v12 offset:20480
    ds_read_b128 v[24:27], v13 offset:0
    ds_read_b128 v[28:31], v13 offset:20480
    ds_read_b128 v[32:35], v12 offset:1024
    ds_read_b128 v[36:39], v12 offset:21504
    s_waitcnt lgkmcnt(4)
    v_mfma_f32_16x16x32_bf16 v[40:43], v[16:19], a[0:3], 0
    v_mfma_f32_16x16x32_bf16 v[44:47], v[16:19], a[4:7], 0
    s_add_u32 m0, s13, 0
    s_nop 0
    global_load_lds_dwordx4 v2, s[16:17] offset:0
    v_mfma_f32_16x16x32_bf16 v[48:51], v[20:23], a[0:3], 0
    v_mfma_f32_16x16x32_bf16 v[52:55], v[20:23], a[4:7], 0
    ds_read_b128 v[16:19], v13 offset:1024
    ds_read_b128 v[20:23], v13 offset:21504
    s_waitcnt lgkmcnt(4)
    v_mfma_f32_16x16x32_bf16 v[40:43], v[24:27], a[8:11], v[40:43]
    v_mfma_f32_16x16x32_bf16 v[44:47], v[24:27], a[12:15], v[44:47]
    v_mfma_f32_16x16x32_bf16 v[48:51], v[28:31], a[8:11], v[48:51]
    v_mfma_f32_16x16x32_bf16 v[52:55], v[28:31], a[12:15], v[52:55]
    ds_read_b128 v[24:27], v12 offset:2048
    ds_read_b128 v[28:31], v12 offset:22528
    s_waitcnt lgkmcnt(4)
    v_mfma_f32_16x16x32_bf16 v[40:43], v[32:35], a[16:19], v[40:43]
    v_mfma_f32_16x16x32_bf16 v[44:47], v[32:35], a[20:23], v[44:47]
    s_add_u32 m0, s13, 896
    s_nop 0
    global_load_lds_dwordx4 v2, s[16:17] offset:128
    v_mfma_f32_16x16x32_bf16 v[48:51], v[36:39], a[16:19], v[48:51]
    v_mfma_f32_16x16x32_bf16 v[52:55], v[36:39], a[20:23], v[52:55]
    ds_read_b128 v[32:35], v13 offset:2048
    ds_read_b128 v[36:39], v13 offset:22528
    s_waitcnt lgkmcnt(4)
    v_mfma_f32_16x16x32_bf16 v[40:43], v[16:19], a[24:27], v[40:43]
    v_mfma_f32_16x16x32_bf16 v[44:47], v[16:19], a[28:31], v[44:47]
    v_mfma_f32_16x16x32_bf16 v[48:51], v[20:23], a[24:27], v[48:51]
    v_mfma_f32_16x16x32_bf16 v[52:55], v[20:23], a[28:31], v[52:55]
    ds_read_b128 v[16:19], v12 offset:3072
    ds_read_b128 v[20:23], v12 offset:23552
    s_waitcnt lgkmcnt(4)
    v_mfma_f32_16x16x32_bf16 v[40:43], v[24:27], a[32:35], v[40:43]
    v_mfma_f32_16x16x32_bf16 v[44:47], v[24:27], a[36:39], v[44:47]
    s_add_u32 m0, s13, 1792
    s_nop 0
    global_load_lds_dwordx4 v2, s[16:17] offset:256
    v_mfma_f32_16x16x32_bf16 v[48:51], v[28:31], a[32:35], v[48:51]
    v_mfma_f32_16x16x32_bf16 v[52:55], v[28:31], a[36:39], v[52:55]
    ds_read_b128 v[24:27], v13 offset:3072
    ds_read_b128 v[28:31], v13 offset:23552
    s_waitcnt lgkmcnt(4)
    v_mfma_f32_16x16x32_bf16 v[40:43], v[32:35], a[40:43], v[40:43]
    v_mfma_f32_16x16x32_bf16 v[44:47], v[32:35], a[44:47], v[44:47]
    v_mfma_f32_16x16x32_bf16 v[48:51], v[36:39], a[40:43], v[48:51]
    v_mfma_f32_16x16x32_bf16 v[52:55], v[36:39], a[44:47], v[52:55]
    ds_read_b128 v[32:35], v12 offset:4096
    ds_read_b128 v[36:39], v12 offset:24576
    s_waitcnt lgkmcnt(4)
    v_mfma_f32_16x16x32_bf16 v[40:43], v[16:19], a[48:51], v[40:43]
    v_mfma_f32_16x16x32_bf16 v[44:47], v[16:19], a[52:55], v[44:47]
    s_add_u32 m0, s13, 2688
    s_nop 0
    global_load_lds_dwordx4 v2, s[16:17] offset:384
    v_mfma_f32_16x16x32_bf16 v[48:51], v[20:23], a[48:51], v[48:51]
    v_mfma_f32_16x16x32_bf16 v[52:55], v[20:23], a[52:55], v[52:55]
    ds_read_b128 v[16:19], v13 offset:4096
    ds_read_b128 v[20:23], v13 offset:24576
    s_waitcnt lgkmcnt(4)
    v_mfma_f32_16x16x32_bf16 v[40:43], v[24:27], a[56:59], v[40:43]
    v_mfma_f32_16x16x32_bf16 v[44:47], v[24:27], a[60:63], v[44:47]
    v_mfma_f32_16x16x32_bf16 v[48:51], v[28:31], a[56:59], v[48:51]
    v_mfma_f32_16x16x32_bf16 v[52:55], v[28:31], a[60:63], v[52:55]
    ds_read_b128 v[24:27], v12 offset:5120
    ds_read_b128 v[28:31], v12 offset:25600
    s_waitcnt lgkmcnt(4)
    v_mfma_f32_16x16x32_bf16 v[40:43], v[32:35], a[64:67], v[40:43]
    v_mfma_f32_16x16x32_bf16 v[44:47], v[32:35], a[68:71], v[44:47]
    s_add_u32 m0, s13, 3584
    s_nop 0
    global_load_lds_dwordx4 v2, s[16:17] offset:512
    v_mfma_f32_16x16x32_bf16 v[48:51], v[36:39], a[64:67], v[48:51]
    v_mfma_f32_16x16x32_bf16 v[52:55], v[36:39], a[68:71], v[52:55]
    ds_read_b128 v[32:35], v13 offset:5120
    ds_read_b128 v[36:39], v13 offset:25600
    s_waitcnt lgkmcnt(4)
    v_mfma_f32_16x16x32_bf16 v[40:43], v[16:19], a[72:75], v[40:43]
    v_mfma_f32_16x16x32_bf16 v[44:47], v[16:19], a[76:79], v[44:47]
    v_mfma_f32_16x16x32_bf16 v[48:51], v[20:23], a[72:75], v[48:51]
    v_mfma_f32_16x16x32_bf16 v[52:55], v[20:23], a[76:79], v[52:55]
    ds_read_b128 v[16:19], v12 offset:6144
    ds_read_b128 v[20:23], v12 offset:26624
    s_waitcnt lgkmcnt(4)
    v_mfma_f32_16x16x32_bf16 v[40:43], v[24:27], a[80:83], v[40:43]
    v_mfma_f32_16x16x32_bf16 v[44:47], v[24:27], a[84:87], v[44:47]
    s_add_u32 m0, s13, 4480
    s_nop 0
    global_load_lds_dwordx4 v2, s[16:17] offset:640
    v_mfma_f32_16x16x32_bf16 v[48:51], v[28:31], a[80:83], v[48:51]
    v_mfma_f32_16x16x32_bf16 v[52:55], v[28:31], a[84:87], v[52:55]
    ds_read_b128 v[24:27], v13 offset:6144
    ds_read_b128 v[28:31], v13 offset:26624
    s_waitcnt lgkmcnt(4)
    v_mfma_f32_16x16x32_bf16 v[40:43], v[32:35], a[88:91], v[40:43]
    v_mfma_f32_16x16x32_bf16 v[44:47], v[32:35], a[92:95], v[44:47]
    v_mfma_f32_16x16x32_bf16 v[48:51], v[36:39], a[88:91], v[48:51]
    v_mfma_f32_16x16x32_bf16 v[52:55], v[36:39], a[92:95], v[52:55]
    ds_read_b128 v[32:35], v12 offset:7168
    ds_read_b128 v[36:39], v12 offset:27648
    s_waitcnt lgkmcnt(4)
    v_mfma_f32_16x16x32_bf16 v[40:43], v[16:19], a[96:99], v[40:43]
    v_mfma_f32_16x16x32_bf16 v[44:47], v[16:19], a[100:103], v[44:47]
    s_add_u32 m0, s13, 5376
    s_nop 0
    global_load_lds_dwordx4 v2, s[16:17] offset:768
    v_mfma_f32_16x16x32_bf16 v[48:51], v[20:23], a[96:99], v[48:51]
    v_mfma_f32_16x16x32_bf16 v[52:55], v[20:23], a[100:103], v[52:55]
    ds_read_b128 v[16:19], v13 offset:7168
    ds_read_b128 v[20:23], v13 offset:27648
    s_waitcnt lgkmcnt(4)
    v_mfma_f32_16x16x32_bf16 v[40:43], v[24:27], a[104:107], v[40:43]
    v_mfma_f32_16x16x32_bf16 v[44:47], v[24:27], a[108:111], v[44:47]
    v_mfma_f32_16x16x32_bf16 v[48:51], v[28:31], a[104:107], v[48:51]
    v_mfma_f32_16x16x32_bf16 v[52:55], v[28:31], a[108:111], v[52:55]
    ds_read_b128 v[24:27], v12 offset:8192
    ds_read_b128 v[28:31], v12 offset:28672
    s_waitcnt lgkmcnt(4)
    v_mfma_f32_16x16x32_bf16 v[40:43], v[32:35], a[112:115], v[40:43]
    v_mfma_f32_16x16x32_bf16 v[44:47], v[32:35], a[116:119], v[44:47]
    s_add_u32 m0, s13, 6272
    s_nop 0
    global_load_lds_dwordx4 v2, s[16:17] offset:896
    v_mfma_f32_16x16x32_bf16 v[48:51], v[36:39], a[112:115], v[48:51]
    v_mfma_f32_16x16x32_bf16 v[52:55], v[36:39], a[116:119], v[52:55]
    ds_read_b128 v[32:35], v13 offset:8192
    ds_read_b128 v[36:39], v13 offset:28672
    s_waitcnt lgkmcnt(4)
    v_mfma_f32_16x16x32_bf16 v[40:43], v[16:19], a[120:123], v[40:43]
    v_mfma_f32_16x16x32_bf16 v[44:47], v[16:19], a[124:127], v[44:47]
    v_mfma_f32_16x16x32_bf16 v[48:51], v[20:23], a[120:123], v[48:51]
    v_mfma_f32_16x16x32_bf16 v[52:55], v[20:23], a[124:127], v[52:55]
    ds_read_b128 v[16:19], v12 offset:9216
    ds_read_b128 v[20:23], v12 offset:29696
    s_waitcnt lgkmcnt(4)
    v_mfma_f32_16x16x32_bf16 v[40:43], v[24:27], a[128:131], v[40:43]
    v_mfma_f32_16x16x32_bf16 v[44:47], v[24:27], a[132:135], v[44:47]
    s_add_u32 m0, s13, 7168
    s_nop 0
    global_load_lds_dwordx4 v2, s[16:17] offset:1024
    v_mfma_f32_16x16x32_bf16 v[48:51], v[28:31], a[128:131], v[48:51]
    v_mfma_f32_16x16x32_bf16 v[52:55], v[28:31], a[132:135], v[52:55]
    ds_read_b128 v[24:27], v13 offset:9216
    ds_read_b128 v[28:31], v13 offset:29696
    s_waitcnt lgkmcnt(4)
    v_mfma_f32_16x16x32_bf16 v[40:43], v[32:35], a[136:139], v[40:43]
    v_mfma_f32_16x16x32_bf16 v[44:47], v[32:35], a[140:143], v[44:47]
    v_mfma_f32_16x16x32_bf16 v[48:51], v[36:39], a[136:139], v[48:51]
    v_mfma_f32_16x16x32_bf16 v[52:55], v[36:39], a[140:143], v[52:55]
    s_waitcnt lgkmcnt(2)
    v_mfma_f32_16x16x32_bf16 v[40:43], v[16:19], a[144:147], v[40:43]
    v_mfma_f32_16x16x32_bf16 v[44:47], v[16:19], a[148:151], v[44:47]
    s_add_u32 m0, s13, 8064
    s_nop 0
    global_load_lds_dwordx4 v2, s[16:17] offset:1152
    v_mfma_f32_16x16x32_bf16 v[48:51], v[20:23], a[144:147], v[48:51]
    v_mfma_f32_16x16x32_bf16 v[52:55], v[20:23], a[148:151], v[52:55]
    s_waitcnt lgkmcnt(0)
    v_mfma_f32_16x16x32_bf16 v[40:43], v[24:27], a[152:155], v[40:43]
    v_mfma_f32_16x16x32_bf16 v[44:47], v[24:27], a[156:159], v[44:47]
    v_mfma_f32_16x16x32_bf16 v[48:51], v[28:31], a[152:155], v[48:51]
    v_mfma_f32_16x16x32_bf16 v[52:55], v[28:31], a[156:159], v[52:55]
    s_branch L_nd2_47
L_nd_46:
    ds_read_b128 v[16:19], v12 offset:0
    ds_read_b128 v[20:23], v12 offset:20480
    ds_read_b128 v[24:27], v13 offset:0
    ds_read_b128 v[28:31], v13 offset:20480
    ds_read_b128 v[32:35], v12 offset:1024
    ds_read_b128 v[36:39], v12 offset:21504
    s_waitcnt lgkmcnt(4)
    v_mfma_f32_16x16x32_bf16 v[40:43], v[16:19], a[0:3], 0
    v_mfma_f32_16x16x32_bf16 v[44:47], v[16:19], a[4:7], 0
    v_mfma_f32_16x16x32_bf16 v[48:51], v[20:23], a[0:3], 0
    v_mfma_f32_16x16x32_bf16 v[52:55], v[20:23], a[4:7], 0
    ds_read_b128 v[16:19], v13 offset:1024
    ds_read_b128 v[20:23], v13 offset:21504
    s_waitcnt lgkmcnt(4)
    v_mfma_f32_16x16x32_bf16 v[40:43], v[24:27], a[8:11], v[40:43]
    v_mfma_f32_16x16x32_bf16 v[44:47], v[24:27], a[12:15], v[44:47]
    v_mfma_f32_16x16x32_bf16 v[48:51], v[28:31], a[8:11], v[48:51]
    v_mfma_f32_16x16x32_bf16 v[52:55], v[28:31], a[12:15], v[52:55]
    ds_read_b128 v[24:27], v12 offset:2048
    ds_read_b128 v[28:31], v12 offset:22528
    s_waitcnt lgkmcnt(4)
    v_mfma_f32_16x16x32_bf16 v[40:43], v[32:35], a[16:19], v[40:43]
    v_mfma_f32_16x16x32_bf16 v[44:47], v[32:35], a[20:23], v[44:47]
    v_mfma_f32_16x16x32_bf16 v[48:51], v[36:39], a[16:19], v[48:51]
    v_mfma_f32_16x16x32_bf16 v[52:55], v[36:39], a[20:23], v[52:55]
    ds_read_b128 v[32:35], v13 offset:2048
    ds_read_b128 v[36:39], v13 offset:22528
    s_waitcnt lgkmcnt(4)
    v_mfma_f32_16x16x32_bf16 v[40:43], v[16:19], a[24:27], v[40:43]
    v_mfma_f32_16x16x32_bf16 v[44:47], v[16:19], a[28:31], v[44:47]
    v_mfma_f32_16x16x32_bf16 v[48:51], v[20:23], a[24:27], v[48:51]
    v_mfma_f32_16x16x32_bf16 v[52:55], v[20:23], a[28:31], v[52:55]
    ds_read_b128 v[16:19], v12 offset:3072
    ds_read_b128 v[20:23], v12 offset:23552
    s_waitcnt lgkmcnt(4)
    v_mfma_f32_16x16x32_bf16 v[40:43], v[24:27], a[32:35], v[40:43]
    v_mfma_f32_16x16x32_bf16 v[44:47], v[24:27], a[36:39], v[44:47]
    v_mfma_f32_16x16x32_bf16 v[48:51], v[28:31], a[32:35], v[48:51]
    v_mfma_f32_16x16x32_bf16 v[52:55], v[28:31], a[36:39], v[52:55]
    ds_read_b128 v[24:27], v13 offset:3072
    ds_read_b128 v[28:31], v13 offset:23552
    s_waitcnt lgkmcnt(4)
    v_mfma_f32_16x16x32_bf16 v[40:43], v[32:35], a[40:43], v[40:43]
    v_mfma_f32_16x16x32_bf16 v[44:47], v[32:35], a[44:47], v[44:47]
    v_mfma_f32_16x16x32_bf16 v[48:51], v[36:39], a[40:43], v[48:51]
    v_mfma_f32_16x16x32_bf16 v[52:55], v[36:39], a[44:47], v[52:55]
    ds_read_b128 v[32:35], v12 offset:4096
    ds_read_b128 v[36:39], v12 offset:24576
    s_waitcnt lgkmcnt(4)
    v_mfma_f32_16x16x32_bf16 v[40:43], v[16:19], a[48:51], v[40:43]
    v_mfma_f32_16x16x32_bf16 v[44:47], v[16:19], a[52:55], v[44:47]
    v_mfma_f32_16x16x32_bf16 v[48:51], v[20:23], a[48:51], v[48:51]
    v_mfma_f32_16x16x32_bf16 v[52:55], v[20:23], a[52:55], v[52:55]
    ds_read_b128 v[16:19], v13 offset:4096
    ds_read_b128 v[20:23], v13 offset:24576
    s_waitcnt lgkmcnt(4)
    v_mfma_f32_16x16x32_bf16 v[40:43], v[24:27], a[56:59], v[40:43]
    v_mfma_f32_16x16x32_bf16 v[44:47], v[24:27], a[60:63], v[44:47]
    v_mfma_f32_16x16x32_bf16 v[48:51], v[28:31], a[56:59], v[48:51]
    v_mfma_f32_16x16x32_bf16 v[52:55], v[28:31], a[60:63], v[52:55]
    ds_read_b128 v[24:27], v12 offset:5120
    ds_read_b128 v[28:31], v12 offset:25600
    s_waitcnt lgkmcnt(4)
    v_mfma_f32_16x16x32_bf16 v[40:43], v[32:35], a[64:67], v[40:43]
    v_mfma_f32_16x16x32_bf16 v[44:47], v[32:35], a[68:71], v[44:47]
    v_mfma_f32_16x16x32_bf16 v[48:51], v[36:39], a[64:67], v[48:51]
    v_mfma_f32_16x16x32_bf16 v[52:55], v[36:39], a[68:71], v[52:55]
    ds_read_b128 v[32:35], v13 offset:5120
    ds_read_b128 v[36:39], v13 offset:25600
    s_waitcnt lgkmcnt(4)
    v_mfma_f32_16x16x32_bf16 v[40:43], v[16:19], a[72:75], v[40:43]
    v_mfma_f32_16x16x32_bf16 v[44:47], v[16:19], a[76:79], v[44:47]
    v_mfma_f32_16x16x32_bf16 v[48:51], v[20:23], a[72:75], v[48:51]
    v_mfma_f32_16x16x32_bf16 v[52:55], v[20:23], a[76:79], v[52:55]
    ds_read_b128 v[16:19], v12 offset:6144
    ds_read_b128 v[20:23], v12 offset:26624
    s_waitcnt lgkmcnt(4)
    v_mfma_f32_16x16x32_bf16 v[40:43], v[24:27], a[80:83], v[40:43]
    v_mfma_f32_16x16x32_bf16 v[44:47], v[24:27], a[84:87], v[44:47]
    v_mfma_f32_16x16x32_bf16 v[48:51], v[28:31], a[80:83], v[48:51]
    v_mfma_f32_16x16x32_bf16 v[52:55], v[28:31], a[84:87], v[52:55]
    ds_read_b128 v[24:27], v13 offset:6144
    ds_read_b128 v[28:31], v13 offset:26624
    s_waitcnt lgkmcnt(4)
    v_mfma_f32_16x16x32_bf16 v[40:43], v[32:35], a[88:91], v[40:43]
    v_mfma_f32_16x16x32_bf16 v[44:47], v[32:35], a[92:95], v[44:47]
    v_mfma_f32_16x16x32_bf16 v[48:51], v[36:39], a[88:91], v[48:51]
    v_mfma_f32_16x16x32_bf16 v[52:55], v[36:39], a[92:95], v[52:55]
    ds_read_b128 v[32:35], v12 offset:7168
    ds_read_b128 v[36:39], v12 offset:27648
    s_waitcnt lgkmcnt(4)
    v_mfma_f32_16x16x32_bf16 v[40:43], v[16:19], a[96:99], v[40:43]
    v_mfma_f32_16x16x32_bf16 v[44:47], v[16:19], a[100:103], v[44:47]
    v_mfma_f32_16x16x32_bf16 v[48:51], v[20:23], a[96:99], v[48:51]
    v_mfma_f32_16x16x32_bf16 v[52:55], v[20:23], a[100:103], v[52:55]
    ds_read_b128 v[16:19], v13 offset:7168
    ds_read_b128 v[20:23], v13 offset:27648
    s_waitcnt lgkmcnt(4)
    v_mfma_f32_16x16x32_bf16 v[40:43], v[24:27], a[104:107], v[40:43]
    v_mfma_f32_16x16x32_bf16 v[44:47], v[24:27], a[108:111], v[44:47]
    v_mfma_f32_16x16x32_bf16 v[48:51], v[28:31], a[104:107], v[48:51]
    v_mfma_f32_16x16x32_bf16 v[52:55], v[28:31], a[108:111], v[52:55]
    ds_read_b128 v[24:27], v12 offset:8192
    ds_read_b128 v[28:31], v12 offset:28672
    s_waitcnt lgkmcnt(4)
    v_mfma_f32_16x16x32_bf16 v[40:43], v[32:35], a[112:115], v[40:43]
    v_mfma_f32_16x16x32_bf16 v[44:47], v[32:35], a[116:119], v[44:47]
    v_mfma_f32_16x16x32_bf16 v[48:51], v[36:39], a[112:115], v[48:51]
    v_mfma_f32_16x16x32_bf16 v[52:55], v[36:39], a[116:119], v[52:55]
    ds_read_b128 v[32:35], v13 offset:8192
    ds_read_b128 v[36:39], v13 offset:28672
    s_waitcnt lgkmcnt(4)
    v_mfma_f32_16x16x32_bf16 v[40:43], v[16:19], a[120:123], v[40:43]
    v_mfma_f32_16x16x32_bf16 v[44:47], v[16:19], a[124:127], v[44:47]
    v_mfma_f32_16x16x32_bf16 v[48:51], v[20:23], a[120:123], v[48:51]
    v_mfma_f32_16x16x32_bf16 v[52:55], v[20:23], a[124:127], v[52:55]
    ds_read_b128 v[16:19], v12 offset:9216
    ds_read_b128 v[20:23], v12 offset:29696
    s_waitcnt lgkmcnt(4)
    v_mfma_f32_16x16x32_bf16 v[40:43], v[24:27], a[128:131], v[40:43]
    v_mfma_f32_16x16x32_bf16 v[44:47], v[24:27], a[132:135], v[44:47]
    v_mfma_f32_16x16x32_bf16 v[48:51], v[28:31], a[128:131], v[48:51]
    v_mfma_f32_16x16x32_bf16 v[52:55], v[28:31], a[132:135], v[52:55]
    ds_read_b128 v[24:27], v13 offset:9216
    ds_read_b128 v[28:31], v13 offset:29696
    s_waitcnt lgkmcnt(4)
    v_mfma_f32_16x16x32_bf16 v[40:43], v[32:35], a[136:139], v[40:43]
    v_mfma_f32_16x16x32_bf16 v[44:47], v[32:35], a[140:143], v[44:47]
    v_mfma_f32_16x16x32_bf16 v[48:51], v[36:39], a[136:139], v[48:51]
    v_mfma_f32_16x16x32_bf16 v[52:55], v[36:39], a[140:143], v[52:55]
    s_waitcnt lgkmcnt(2)
    v_mfma_f32_16x16x32_bf16 v[40:43], v[16:19], a[144:147], v[40:43]
    v_mfma_f32_16x16x32_bf16 v[44:47], v[16:19], a[148:151], v[44:47]
    v_mfma_f32_16x16x32_bf16 v[48:51], v[20:23], a[144:147], v[48:51]
    v_mfma_f32_16x16x32_bf16 v[52:55], v[20:23], a[148:151], v[52:55]
    s_waitcnt lgkmcnt(0)
    v_mfma_f32_16x16x32_bf16 v[40:43], v[24:27], a[152:155], v[40:43]
    v_mfma_f32_16x16x32_bf16 v[44:47], v[24:27], a[156:159], v[44:47]
    v_mfma_f32_16x16x32_bf16 v[48:51], v[28:31], a[152:155], v[48:51]
    v_mfma_f32_16x16x32_bf16 v[52:55], v[28:31], a[156:159], v[52:55]
L_nd2_47:
    v_cvt_pk_bf16_f32 v56, v40, v41
    v_cvt_pk_bf16_f32 v57, v42, v43
    s_nop 2
    v_cvt_pk_bf16_f32 v58, v48, v49
    v_cvt_pk_bf16_f32 v59, v50, v51
    global_store_dwordx4 v1, v[56:59], s[20:21] offset:0 sc1
    v_cvt_pk_bf16_f32 v60, v44, v45
    v_cvt_pk_bf16_f32 v61, v46, v47
    v_cvt_pk_bf16_f32 v62, v52, v53
    v_cvt_pk_bf16_f32 v63, v54, v55
    global_store_dwordx4 v1, v[60:63], s[20:21] offset:1024 sc1
    s_add_u32 s20, s20, 524288
    s_addc_u32 s21, s21, 0
    s_xor_b32 s26, s26, 40960
    v_add_u32 v12, s26, v14
    v_add_u32 v13, s26, v15
    s_add_u32 s18, s18, 1
    s_cmp_lt_u32 s18, 64
    s_cbranch_scc1 L_vp_loop
    s_waitcnt vmcnt(0)
    s_barrier
    s_mov_b32 s30, 64
    s_cmp_eq_u32 s5, 0
    s_cbranch_scc0 L_fl_48
    v_mov_b32 v5, s29
    v_mov_b32 v6, s30
    s_mov_b64 exec, 1
    global_store_dword v5, v6, s[22:23] sc1
    s_mov_b64 exec, -1
L_fl_48:
    s_waitcnt vmcnt(0)
    s_endpgm
L_qp:
    s_add_u32 s22, s8, 5767168
    s_addc_u32 s23, s9, 0
    s_lshl_b32 s29, s4, 7
    s_add_u32 s29, s29, 28672
    s_mov_b32 s30, 0
    s_cmp_eq_u32 s5, 0
    s_cbranch_scc0 L_fl_49
    v_mov_b32 v5, s29
    v_mov_b32 v6, s30
    s_mov_b64 exec, 1
    global_store_dword v5, v6, s[22:23] sc1
    s_mov_b64 exec, -1
L_fl_49:
    s_waitcnt vmcnt(0)
    s_barrier
    s_cmp_eq_u32 s5, 0
    s_cbranch_scc0 L_si_50
    s_lshl_b32 s10, s3, 5
    s_add_u32 s10, s10, 4
    v_mov_b32 v5, s10
    v_mov_b32 v6, 1
    s_mov_b64 exec, 1
    global_atomic_add v5, v6, s[6:7]
    s_mov_b64 exec, -1
L_si_50:
    s_load_dwordx2 s[16:17], s[0:1], 0
    v_lshlrev_b32 v1, 4, v0
    v_lshrrev_b32 v5, 3, v0
    v_and_b32 v6, 7, v0
    v_xor_b32 v6, v6, v5
    s_lshl_b32 s10, s5, 3
    v_add_u32 v5, s10, v5
    v_mul_u32_u24 v2, 1280, v5
    v_lshl_add_u32 v2, v6, 4, v2
    v_and_b32 v5, 7, v0
    v_bfe_u32 v6, v0, 3, 1
    v_mul_u32_u24 v3, 10240, v6
    v_lshl_add_u32 v3, v5, 7, v3
    v_lshrrev_b32 v6, 4, v0
    v_xor_b32 v14, v6, v5
    v_xor_b32 v6, 4, v14
    v_lshl_add_u32 v15, v6, 4, v3
    v_lshl_add_u32 v14, v14, 4, v3
    s_waitcnt lgkmcnt(0)
    s_mov_b32 s31, 0
    s_mul_i32 s13, s5, 10240
    s_add_u32 s13, s13, s31
    s_add_u32 m0, s13, 0
    s_nop 0
    global_load_lds_dwordx4 v2, s[16:17] offset:0
    s_add_u32 m0, s13, 896
    s_nop 0
    global_load_lds_dwordx4 v2, s[16:17] offset:128
    s_add_u32 m0, s13, 1792
    s_nop 0
    global_load_lds_dwordx4 v2, s[16:17] offset:256
    s_add_u32 m0, s13, 2688
    s_nop 0
    global_load_lds_dwordx4 v2, s[16:17] offset:384
    s_add_u32 m0, s13, 3584
    s_nop 0
    global_load_lds_dwordx4 v2, s[16:17] offset:512
    s_add_u32 m0, s13, 4480
    s_nop 0
    global_load_lds_dwordx4 v2, s[16:17] offset:640
    s_add_u32 m0, s13, 5376
    s_nop 0
    global_load_lds_dwordx4 v2, s[16:17] offset:768
    s_add_u32 m0, s13, 6272
    s_nop 0
    global_load_lds_dwordx4 v2, s[16:17] offset:896
    s_add_u32 m0, s13, 7168
    s_nop 0
    global_load_lds_dwordx4 v2, s[16:17] offset:1024
    s_add_u32 m0, s13, 8064
    s_nop 0
    global_load_lds_dwordx4 v2, s[16:17] offset:1152
    s_lshl_b32 s30, s4, 8
    s_lshl_b32 s31, s5, 6
    s_add_u32 s30, s30, s31
    s_load_dwordx2 s[10:11], s[0:1], 16
    v_and_b32 v9, 15, v0
    v_lshrrev_b32 v10, 4, v0
    v_lshlrev_b32 v10, 3, v10
    s_mov_b32 s12, 8192
    v_mul_lo_u32 v8, v10, s12
    v_lshl_add_u32 v8, v9, 2, v8
    v_add_u32 v8, s30, v8
    s_mov_b32 s24, 0x05040100
    s_mov_b32 s25, 0x07060302
    s_waitcnt lgkmcnt(0)
    s_mov_b32 s76, s10
    s_and_b32 s77, s11, 0xffff
    s_mov_b32 s78, 5242880
    s_mov_b32 s79, 0x20000
    s_mov_b32 s10, 0
    buffer_load_dword v64, v8, s[76:79], s10 offen
    s_mov_b32 s11, 8192
    buffer_load_dword v65, v8, s[76:79], s11 offen
    s_mov_b32 s10, 16384
    buffer_load_dword v66, v8, s[76:79], s10 offen
    s_mov_b32 s11, 24576
    buffer_load_dword v67, v8, s[76:79], s11 offen
    s_mov_b32 s10, 32768
    buffer_load_dword v68, v8, s[76:79], s10 offen
    s_mov_b32 s11, 40960
    buffer_load_dword v69, v8, s[76:79], s11 offen
    s_mov_b32 s10, 49152
    buffer_load_dword v70, v8, s[76:79], s10 offen
    s_mov_b32 s11, 57344
    buffer_load_dword v71, v8, s[76:79], s11 offen
    s_mov_b32 s10, 262144
    buffer_load_dword v72, v8, s[76:79], s10 offen
    s_mov_b32 s11, 270336
    buffer_load_dword v73, v8, s[76:79], s11 offen
    s_mov_b32 s10, 278528
    buffer_load_dword v74, v8, s[76:79], s10 offen
    s_mov_b32 s11, 286720
    buffer_load_dword v75, v8, s[76:79], s11 offen
    s_mov_b32 s10, 294912
    buffer_load_dword v76, v8, s[76:79], s10 offen
    s_mov_b32 s11, 303104
    buffer_load_dword v77, v8, s[76:79], s11 offen
    s_mov_b32 s10, 311296
    buffer_load_dword v78, v8, s[76:79], s10 offen
    s_mov_b32 s11, 319488
    buffer_load_dword v79, v8, s[76:79], s11 offen
    s_mov_b32 s10, 524288
    buffer_load_dword v96, v8, s[76:79], s10 offen
    s_mov_b32 s11, 532480
    buffer_load_dword v97, v8, s[76:79], s11 offen
    s_mov_b32 s10, 540672
    buffer_load_dword v98, v8, s[76:79], s10 offen
    s_mov_b32 s11, 548864
    buffer_load_dword v99, v8, s[76:79], s11 offen
    s_mov_b32 s10, 557056
    buffer_load_dword v100, v8, s[76:79], s10 offen
    s_mov_b32 s11, 565248
    buffer_load_dword v101, v8, s[76:79], s11 offen
    s_mov_b32 s10, 573440
    buffer_load_dword v102, v8, s[76:79], s10 offen
    s_mov_b32 s11, 581632
    buffer_load_dword v103, v8, s[76:79], s11 offen
    s_mov_b32 s10, 786432
    buffer_load_dword v104, v8, s[76:79], s10 offen
    s_mov_b32 s11, 794624
    buffer_load_dword v105, v8, s[76:79], s11 offen
    s_mov_b32 s10, 802816
    buffer_load_dword v106, v8, s[76:79], s10 offen
    s_mov_b32 s11, 811008
    buffer_load_dword v107, v8, s[76:79], s11 offen
    s_mov_b32 s10, 819200
    buffer_load_dword v108, v8, s[76:79], s10 offen
    s_mov_b32 s11, 827392
    buffer_load_dword v109, v8, s[76:79], s11 offen
    s_mov_b32 s10, 835584
    buffer_load_dword v110, v8, s[76:79], s10 offen
    s_mov_b32 s11, 843776
    buffer_load_dword v111, v8, s[76:79], s11 offen
    s_mov_b32 s10, 1048576
    buffer_load_dword v128, v8, s[76:79], s10 offen
    s_mov_b32 s11, 1056768
    buffer_load_dword v129, v8, s[76:79], s11 offen
    s_mov_b32 s10, 1064960
    buffer_load_dword v130, v8, s[76:79], s10 offen
    s_mov_b32 s11, 1073152
    buffer_load_dword v131, v8, s[76:79], s11 offen
    s_mov_b32 s10, 1081344
    buffer_load_dword v132, v8, s[76:79], s10 offen
    s_mov_b32 s11, 1089536
    buffer_load_dword v133, v8, s[76:79], s11 offen
    s_mov_b32 s10, 1097728
    buffer_load_dword v134, v8, s[76:79], s10 offen
    s_mov_b32 s11, 1105920
    buffer_load_dword v135, v8, s[76:79], s11 offen
    s_mov_b32 s10, 1310720
    buffer_load_dword v136, v8, s[76:79], s10 offen
    s_mov_b32 s11, 1318912
    buffer_load_dword v137, v8, s[76:79], s11 offen
    s_mov_b32 s10, 1327104
    buffer_load_dword v138, v8, s[76:79], s10 offen
    s_mov_b32 s11, 1335296
    buffer_load_dword v139, v8, s[76:79], s11 offen
    s_mov_b32 s10, 1343488
    buffer_load_dword v140, v8, s[76:79], s10 offen
    s_mov_b32 s11, 1351680
    buffer_load_dword v141, v8, s[76:79], s11 offen
    s_mov_b32 s10, 1359872
    buffer_load_dword v142, v8, s[76:79], s10 offen
    s_mov_b32 s11, 1368064
    buffer_load_dword v143, v8, s[76:79], s11 offen
    s_waitcnt vmcnt(32)
    v_perm_b32 v11, v65, v64, s24
    v_accvgpr_write_b32 a0, v11
    v_perm_b32 v12, v67, v66, s24
    v_accvgpr_write_b32 a1, v12
    v_perm_b32 v11, v69, v68, s24
    v_accvgpr_write_b32 a2, v11
    v_perm_b32 v12, v71, v70, s24
    v_accvgpr_write_b32 a3, v12
    v_perm_b32 v11, v65, v64, s25
    v_accvgpr_write_b32 a4, v11
    v_perm_b32 v12, v67, v66, s25
    v_accvgpr_write_b32 a5, v12
    v_perm_b32 v11, v69, v68, s25
    v_accvgpr_write_b32 a6, v11
    v_perm_b32 v12, v71, v70, s25
    v_accvgpr_write_b32 a7, v12
    v_perm_b32 v11, v73, v72, s24
    v_accvgpr_write_b32 a8, v11
    v_perm_b32 v12, v75, v74, s24
    v_accvgpr_write_b32 a9, v12
    v_perm_b32 v11, v77, v76, s24
    v_accvgpr_write_b32 a10, v11
    v_perm_b32 v12, v79, v78, s24
    v_accvgpr_write_b32 a11, v12
    v_perm_b32 v11, v73, v72, s25
    v_accvgpr_write_b32 a12, v11
    v_perm_b32 v12, v75, v74, s25
    v_accvgpr_write_b32 a13, v12
    v_perm_b32 v11, v77, v76, s25
    v_accvgpr_write_b32 a14, v11
    v_perm_b32 v12, v79, v78, s25
    v_accvgpr_write_b32 a15, v12
    s_mov_b32 s10, 1572864
    buffer_load_dword v64, v8, s[76:79], s10 offen
    s_mov_b32 s11, 1581056
    buffer_load_dword v65, v8, s[76:79], s11 offen
    s_mov_b32 s10, 1589248
    buffer_load_dword v66, v8, s[76:79], s10 offen
    s_mov_b32 s11, 1597440
    buffer_load_dword v67, v8, s[76:79], s11 offen
    s_mov_b32 s10, 1605632
    buffer_load_dword v68, v8, s[76:79], s10 offen
    s_mov_b32 s11, 1613824
    buffer_load_dword v69, v8, s[76:79], s11 offen
    s_mov_b32 s10, 1622016
    buffer_load_dword v70, v8, s[76:79], s10 offen
    s_mov_b32 s11, 1630208
    buffer_load_dword v71, v8, s[76:79], s11 offen
    s_mov_b32 s10, 1835008
    buffer_load_dword v72, v8, s[76:79], s10 offen
    s_mov_b32 s11, 1843200
    buffer_load_dword v73, v8, s[76:79], s11 offen
    s_mov_b32 s10, 1851392
    buffer_load_dword v74, v8, s[76:79], s10 offen
    s_mov_b32 s11, 1859584
    buffer_load_dword v75, v8, s[76:79], s11 offen
    s_mov_b32 s10, 1867776
    buffer_load_dword v76, v8, s[76:79], s10 offen
    s_mov_b32 s11, 1875968
    buffer_load_dword v77, v8, s[76:79], s11 offen
    s_mov_b32 s10, 1884160
    buffer_load_dword v78, v8, s[76:79], s10 offen
    s_mov_b32 s11, 1892352
    buffer_load_dword v79, v8, s[76:79], s11 offen
    s_waitcnt vmcnt(32)
    v_perm_b32 v11, v97, v96, s24
    v_accvgpr_write_b32 a16, v11
    v_perm_b32 v12, v99, v98, s24
    v_accvgpr_write_b32 a17, v12
    v_perm_b32 v11, v101, v100, s24
    v_accvgpr_write_b32 a18, v11
    v_perm_b32 v12, v103, v102, s24
    v_accvgpr_write_b32 a19, v12
    v_perm_b32 v11, v97, v96, s25
    v_accvgpr_write_b32 a20, v11
    v_perm_b32 v12, v99, v98, s25
    v_accvgpr_write_b32 a21, v12
    v_perm_b32 v11, v101, v100, s25
    v_accvgpr_write_b32 a22, v11
    v_perm_b32 v12, v103, v102, s25
    v_accvgpr_write_b32 a23, v12
    v_perm_b32 v11, v105, v104, s24
    v_accvgpr_write_b32 a24, v11
    v_perm_b32 v12, v107, v106, s24
    v_accvgpr_write_b32 a25, v12
    v_perm_b32 v11, v109, v108, s24
    v_accvgpr_write_b32 a26, v11
    v_perm_b32 v12, v111, v110, s24
    v_accvgpr_write_b32 a27, v12
    v_perm_b32 v11, v105, v104, s25
    v_accvgpr_write_b32 a28, v11
    v_perm_b32 v12, v107, v106, s25
    v_accvgpr_write_b32 a29, v12
    v_perm_b32 v11, v109, v108, s25
    v_accvgpr_write_b32 a30, v11
    v_perm_b32 v12, v111, v110, s25
    v_accvgpr_write_b32 a31, v12
    s_mov_b32 s10, 2097152
    buffer_load_dword v96, v8, s[76:79], s10 offen
    s_mov_b32 s11, 2105344
    buffer_load_dword v97, v8, s[76:79], s11 offen
    s_mov_b32 s10, 2113536
    buffer_load_dword v98, v8, s[76:79], s10 offen
    s_mov_b32 s11, 2121728
    buffer_load_dword v99, v8, s[76:79], s11 offen
    s_mov_b32 s10, 2129920
    buffer_load_dword v100, v8, s[76:79], s10 offen
    s_mov_b32 s11, 2138112
    buffer_load_dword v101, v8, s[76:79], s11 offen
    s_mov_b32 s10, 2146304
    buffer_load_dword v102, v8, s[76:79], s10 offen
    s_mov_b32 s11, 2154496
    buffer_load_dword v103, v8, s[76:79], s11 offen
    s_mov_b32 s10, 2359296
    buffer_load_dword v104, v8, s[76:79], s10 offen
    s_mov_b32 s11, 2367488
    buffer_load_dword v105, v8, s[76:79], s11 offen
    s_mov_b32 s10, 2375680
    buffer_load_dword v106, v8, s[76:79], s10 offen
    s_mov_b32 s11, 2383872
    buffer_load_dword v107, v8, s[76:79], s11 offen
    s_mov_b32 s10, 2392064
    buffer_load_dword v108, v8, s[76:79], s10 offen
    s_mov_b32 s11, 2400256
    buffer_load_dword v109, v8, s[76:79], s11 offen
    s_mov_b32 s10, 2408448
    buffer_load_dword v110, v8, s[76:79], s10 offen
    s_mov_b32 s11, 2416640
    buffer_load_dword v111, v8, s[76:79], s11 offen
    s_waitcnt vmcnt(32)
    v_perm_b32 v11, v129, v128, s24
    v_accvgpr_write_b32 a32, v11
    v_perm_b32 v12, v131, v130, s24
    v_accvgpr_write_b32 a33, v12
    v_perm_b32 v11, v133, v132, s24
    v_accvgpr_write_b32 a34, v11
    v_perm_b32 v12, v135, v134, s24
    v_accvgpr_write_b32 a35, v12
    v_perm_b32 v11, v129, v128, s25
    v_accvgpr_write_b32 a36, v11
    v_perm_b32 v12, v131, v130, s25
    v_accvgpr_write_b32 a37, v12
    v_perm_b32 v11, v133, v132, s25
    v_accvgpr_write_b32 a38, v11
    v_perm_b32 v12, v135, v134, s25
    v_accvgpr_write_b32 a39, v12
    v_perm_b32 v11, v137, v136, s24
    v_accvgpr_write_b32 a40, v11
    v_perm_b32 v12, v139, v138, s24
    v_accvgpr_write_b32 a41, v12
    v_perm_b32 v11, v141, v140, s24
    v_accvgpr_write_b32 a42, v11
    v_perm_b32 v12, v143, v142, s24
    v_accvgpr_write_b32 a43, v12
    v_perm_b32 v11, v137, v136, s25
    v_accvgpr_write_b32 a44, v11
    v_perm_b32 v12, v139, v138, s25
    v_accvgpr_write_b32 a45, v12
    v_perm_b32 v11, v141, v140, s25
    v_accvgpr_write_b32 a46, v11
    v_perm_b32 v12, v143, v142, s25
    v_accvgpr_write_b32 a47, v12
    s_mov_b32 s10, 2621440
    buffer_load_dword v128, v8, s[76:79], s10 offen
    s_mov_b32 s11, 2629632
    buffer_load_dword v129, v8, s[76:79], s11 offen
    s_mov_b32 s10, 2637824
    buffer_load_dword v130, v8, s[76:79], s10 offen
    s_mov_b32 s11, 2646016
    buffer_load_dword v131, v8, s[76:79], s11 offen
    s_mov_b32 s10, 2654208
    buffer_load_dword v132, v8, s[76:79], s10 offen
    s_mov_b32 s11, 2662400
    buffer_load_dword v133, v8, s[76:79], s11 offen
    s_mov_b32 s10, 2670592
    buffer_load_dword v134, v8, s[76:79], s10 offen
    s_mov_b32 s11, 2678784
    buffer_load_dword v135, v8, s[76:79], s11 offen
    s_mov_b32 s10, 2883584
    buffer_load_dword v136, v8, s[76:79], s10 offen
    s_mov_b32 s11, 2891776
    buffer_load_dword v137, v8, s[76:79], s11 offen
    s_mov_b32 s10, 2899968
    buffer_load_dword v138, v8, s[76:79], s10 offen
    s_mov_b32 s11, 2908160
    buffer_load_dword v139, v8, s[76:79], s11 offen
    s_mov_b32 s10, 2916352
    buffer_load_dword v140, v8, s[76:79], s10 offen
    s_mov_b32 s11, 2924544
    buffer_load_dword v141, v8, s[76:79], s11 offen
    s_mov_b32 s10, 2932736
    buffer_load_dword v142, v8, s[76:79], s10 offen
    s_mov_b32 s11, 2940928
    buffer_load_dword v143, v8, s[76:79], s11 offen
    s_waitcnt vmcnt(32)
    v_perm_b32 v11, v65, v64, s24
    v_accvgpr_write_b32 a48, v11
    v_perm_b32 v12, v67, v66, s24
    v_accvgpr_write_b32 a49, v12
    v_perm_b32 v11, v69, v68, s24
    v_accvgpr_write_b32 a50, v11
    v_perm_b32 v12, v71, v70, s24
    v_accvgpr_write_b32 a51, v12
    v_perm_b32 v11, v65, v64, s25
    v_accvgpr_write_b32 a52, v11
    v_perm_b32 v12, v67, v66, s25
    v_accvgpr_write_b32 a53, v12
    v_perm_b32 v11, v69, v68, s25
    v_accvgpr_write_b32 a54, v11
    v_perm_b32 v12, v71, v70, s25
    v_accvgpr_write_b32 a55, v12
    v_perm_b32 v11, v73, v72, s24
    v_accvgpr_write_b32 a56, v11
    v_perm_b32 v12, v75, v74, s24
    v_accvgpr_write_b32 a57, v12
    v_perm_b32 v11, v77, v76, s24
    v_accvgpr_write_b32 a58, v11
    v_perm_b32 v12, v79, v78, s24
    v_accvgpr_write_b32 a59, v12
    v_perm_b32 v11, v73, v72, s25
    v_accvgpr_write_b32 a60, v11
    v_perm_b32 v12, v75, v74, s25
    v_accvgpr_write_b32 a61, v12
    v_perm_b32 v11, v77, v76, s25
    v_accvgpr_write_b32 a62, v11
    v_perm_b32 v12, v79, v78, s25
    v_accvgpr_write_b32 a63, v12
    s_mov_b32 s10, 3145728
    buffer_load_dword v64, v8, s[76:79], s10 offen
    s_mov_b32 s11, 3153920
    buffer_load_dword v65, v8, s[76:79], s11 offen
    s_mov_b32 s10, 3162112
    buffer_load_dword v66, v8, s[76:79], s10 offen
    s_mov_b32 s11, 3170304
    buffer_load_dword v67, v8, s[76:79], s11 offen
    s_mov_b32 s10, 3178496
    buffer_load_dword v68, v8, s[76:79], s10 offen
    s_mov_b32 s11, 3186688
    buffer_load_dword v69, v8, s[76:79], s11 offen
    s_mov_b32 s10, 3194880
    buffer_load_dword v70, v8, s[76:79], s10 offen
    s_mov_b32 s11, 3203072
    buffer_load_dword v71, v8, s[76:79], s11 offen
    s_mov_b32 s10, 3407872
    buffer_load_dword v72, v8, s[76:79], s10 offen
    s_mov_b32 s11, 3416064
    buffer_load_dword v73, v8, s[76:79], s11 offen
    s_mov_b32 s10, 3424256
    buffer_load_dword v74, v8, s[76:79], s10 offen
    s_mov_b32 s11, 3432448
    buffer_load_dword v75, v8, s[76:79], s11 offen
    s_mov_b32 s10, 3440640
    buffer_load_dword v76, v8, s[76:79], s10 offen
    s_mov_b32 s11, 3448832
    buffer_load_dword v77, v8, s[76:79], s11 offen
    s_mov_b32 s10, 3457024
    buffer_load_dword v78, v8, s[76:79], s10 offen
    s_mov_b32 s11, 3465216
    buffer_load_dword v79, v8, s[76:79], s11 offen
    s_waitcnt vmcnt(32)
    v_perm_b32 v11, v97, v96, s24
    v_accvgpr_write_b32 a64, v11
    v_perm_b32 v12, v99, v98, s24
    v_accvgpr_write_b32 a65, v12
    v_perm_b32 v11, v101, v100, s24
    v_accvgpr_write_b32 a66, v11
    v_perm_b32 v12, v103, v102, s24
    v_accvgpr_write_b32 a67, v12
    v_perm_b32 v11, v97, v96, s25
    v_accvgpr_write_b32 a68, v11
    v_perm_b32 v12, v99, v98, s25
    v_accvgpr_write_b32 a69, v12
    v_perm_b32 v11, v101, v100, s25
    v_accvgpr_write_b32 a70, v11
    v_perm_b32 v12, v103, v102, s25
    v_accvgpr_write_b32 a71, v12
    v_perm_b32 v11, v105, v104, s24
    v_accvgpr_write_b32 a72, v11
    v_perm_b32 v12, v107, v106, s24
    v_accvgpr_write_b32 a73, v12
    v_perm_b32 v11, v109, v108, s24
    v_accvgpr_write_b32 a74, v11
    v_perm_b32 v12, v111, v110, s24
    v_accvgpr_write_b32 a75, v12
    v_perm_b32 v11, v105, v104, s25
    v_accvgpr_write_b32 a76, v11
    v_perm_b32 v12, v107, v106, s25
    v_accvgpr_write_b32 a77, v12
    v_perm_b32 v11, v109, v108, s25
    v_accvgpr_write_b32 a78, v11
    v_perm_b32 v12, v111, v110, s25
    v_accvgpr_write_b32 a79, v12
    s_mov_b32 s10, 3670016
    buffer_load_dword v96, v8, s[76:79], s10 offen
    s_mov_b32 s11, 3678208
    buffer_load_dword v97, v8, s[76:79], s11 offen
    s_mov_b32 s10, 3686400
    buffer_load_dword v98, v8, s[76:79], s10 offen
    s_mov_b32 s11, 3694592
    buffer_load_dword v99, v8, s[76:79], s11 offen
    s_mov_b32 s10, 3702784
    buffer_load_dword v100, v8, s[76:79], s10 offen
    s_mov_b32 s11, 3710976
    buffer_load_dword v101, v8, s[76:79], s11 offen
    s_mov_b32 s10, 3719168
    buffer_load_dword v102, v8, s[76:79], s10 offen
    s_mov_b32 s11, 3727360
    buffer_load_dword v103, v8, s[76:79], s11 offen
    s_mov_b32 s10, 3932160
    buffer_load_dword v104, v8, s[76:79], s10 offen
    s_mov_b32 s11, 3940352
    buffer_load_dword v105, v8, s[76:79], s11 offen
    s_mov_b32 s10, 3948544
    buffer_load_dword v106, v8, s[76:79], s10 offen
    s_mov_b32 s11, 3956736
    buffer_load_dword v107, v8, s[76:79], s11 offen
    s_mov_b32 s10, 3964928
    buffer_load_dword v108, v8, s[76:79], s10 offen
    s_mov_b32 s11, 3973120
    buffer_load_dword v109, v8, s[76:79], s11 offen
    s_mov_b32 s10, 3981312
    buffer_load_dword v110, v8, s[76:79], s10 offen
    s_mov_b32 s11, 3989504
    buffer_load_dword v111, v8, s[76:79], s11 offen
    s_waitcnt vmcnt(32)
    v_perm_b32 v11, v129, v128, s24
    v_accvgpr_write_b32 a80, v11
    v_perm_b32 v12, v131, v130, s24
    v_accvgpr_write_b32 a81, v12
    v_perm_b32 v11, v133, v132, s24
    v_accvgpr_write_b32 a82, v11
    v_perm_b32 v12, v135, v134, s24
    v_accvgpr_write_b32 a83, v12
    v_perm_b32 v11, v129, v128, s25
    v_accvgpr_write_b32 a84, v11
    v_perm_b32 v12, v131, v130, s25
    v_accvgpr_write_b32 a85, v12
    v_perm_b32 v11, v133, v132, s25
    v_accvgpr_write_b32 a86, v11
    v_perm_b32 v12, v135, v134, s25
    v_accvgpr_write_b32 a87, v12
    v_perm_b32 v11, v137, v136, s24
    v_accvgpr_write_b32 a88, v11
    v_perm_b32 v12, v139, v138, s24
    v_accvgpr_write_b32 a89, v12
    v_perm_b32 v11, v141, v140, s24
    v_accvgpr_write_b32 a90, v11
    v_perm_b32 v12, v143, v142, s24
    v_accvgpr_write_b32 a91, v12
    v_perm_b32 v11, v137, v136, s25
    v_accvgpr_write_b32 a92, v11
    v_perm_b32 v12, v139, v138, s25
    v_accvgpr_write_b32 a93, v12
    v_perm_b32 v11, v141, v140, s25
    v_accvgpr_write_b32 a94, v11
    v_perm_b32 v12, v143, v142, s25
    v_accvgpr_write_b32 a95, v12
    s_mov_b32 s10, 4194304
    buffer_load_dword v128, v8, s[76:79], s10 offen
    s_mov_b32 s11, 4202496
    buffer_load_dword v129, v8, s[76:79], s11 offen
    s_mov_b32 s10, 4210688
    buffer_load_dword v130, v8, s[76:79], s10 offen
    s_mov_b32 s11, 4218880
    buffer_load_dword v131, v8, s[76:79], s11 offen
    s_mov_b32 s10, 4227072
    buffer_load_dword v132, v8, s[76:79], s10 offen
    s_mov_b32 s11, 4235264
    buffer_load_dword v133, v8, s[76:79], s11 offen
    s_mov_b32 s10, 4243456
    buffer_load_dword v134, v8, s[76:79], s10 offen
    s_mov_b32 s11, 4251648
    buffer_load_dword v135, v8, s[76:79], s11 offen
    s_mov_b32 s10, 4456448
    buffer_load_dword v136, v8, s[76:79], s10 offen
    s_mov_b32 s11, 4464640
    buffer_load_dword v137, v8, s[76:79], s11 offen
    s_mov_b32 s10, 4472832
    buffer_load_dword v138, v8, s[76:79], s10 offen
    s_mov_b32 s11, 4481024
    buffer_load_dword v139, v8, s[76:79], s11 offen
    s_mov_b32 s10, 4489216
    buffer_load_dword v140, v8, s[76:79], s10 offen
    s_mov_b32 s11, 4497408
    buffer_load_dword v141, v8, s[76:79], s11 offen
    s_mov_b32 s10, 4505600
    buffer_load_dword v142, v8, s[76:79], s10 offen
    s_mov_b32 s11, 4513792
    buffer_load_dword v143, v8, s[76:79], s11 offen
    s_waitcnt vmcnt(32)
    v_perm_b32 v11, v65, v64, s24
    v_accvgpr_write_b32 a96, v11
    v_perm_b32 v12, v67, v66, s24
    v_accvgpr_write_b32 a97, v12
    v_perm_b32 v11, v69, v68, s24
    v_accvgpr_write_b32 a98, v11
    v_perm_b32 v12, v71, v70, s24
    v_accvgpr_write_b32 a99, v12
    v_perm_b32 v11, v65, v64, s25
    v_accvgpr_write_b32 a100, v11
    v_perm_b32 v12, v67, v66, s25
    v_accvgpr_write_b32 a101, v12
    v_perm_b32 v11, v69, v68, s25
    v_accvgpr_write_b32 a102, v11
    v_perm_b32 v12, v71, v70, s25
    v_accvgpr_write_b32 a103, v12
    v_perm_b32 v11, v73, v72, s24
    v_accvgpr_write_b32 a104, v11
    v_perm_b32 v12, v75, v74, s24
    v_accvgpr_write_b32 a105, v12
    v_perm_b32 v11, v77, v76, s24
    v_accvgpr_write_b32 a106, v11
    v_perm_b32 v12, v79, v78, s24
    v_accvgpr_write_b32 a107, v12
    v_perm_b32 v11, v73, v72, s25
    v_accvgpr_write_b32 a108, v11
    v_perm_b32 v12, v75, v74, s25
    v_accvgpr_write_b32 a109, v12
    v_perm_b32 v11, v77, v76, s25
    v_accvgpr_write_b32 a110, v11
    v_perm_b32 v12, v79, v78, s25
    v_accvgpr_write_b32 a111, v12
    s_mov_b32 s10, 4718592
    buffer_load_dword v64, v8, s[76:79], s10 offen
    s_mov_b32 s11, 4726784
    buffer_load_dword v65, v8, s[76:79], s11 offen
    s_mov_b32 s10, 4734976
    buffer_load_dword v66, v8, s[76:79], s10 offen
    s_mov_b32 s11, 4743168
    buffer_load_dword v67, v8, s[76:79], s11 offen
    s_mov_b32 s10, 4751360
    buffer_load_dword v68, v8, s[76:79], s10 offen
    s_mov_b32 s11, 4759552
    buffer_load_dword v69, v8, s[76:79], s11 offen
    s_mov_b32 s10, 4767744
    buffer_load_dword v70, v8, s[76:79], s10 offen
    s_mov_b32 s11, 4775936
    buffer_load_dword v71, v8, s[76:79], s11 offen
    s_mov_b32 s10, 4980736
    buffer_load_dword v72, v8, s[76:79], s10 offen
    s_mov_b32 s11, 4988928
    buffer_load_dword v73, v8, s[76:79], s11 offen
    s_mov_b32 s10, 4997120
    buffer_load_dword v74, v8, s[76:79], s10 offen
    s_mov_b32 s11, 5005312
    buffer_load_dword v75, v8, s[76:79], s11 offen
    s_mov_b32 s10, 5013504
    buffer_load_dword v76, v8, s[76:79], s10 offen
    s_mov_b32 s11, 5021696
    buffer_load_dword v77, v8, s[76:79], s11 offen
    s_mov_b32 s10, 5029888
    buffer_load_dword v78, v8, s[76:79], s10 offen
    s_mov_b32 s11, 5038080
    buffer_load_dword v79, v8, s[76:79], s11 offen
    s_waitcnt vmcnt(32)
    v_perm_b32 v11, v97, v96, s24
    v_accvgpr_write_b32 a112, v11
    v_perm_b32 v12, v99, v98, s24
    v_accvgpr_write_b32 a113, v12
    v_perm_b32 v11, v101, v100, s24
    v_accvgpr_write_b32 a114, v11
    v_perm_b32 v12, v103, v102, s24
    v_accvgpr_write_b32 a115, v12
    v_perm_b32 v11, v97, v96, s25
    v_accvgpr_write_b32 a116, v11
    v_perm_b32 v12, v99, v98, s25
    v_accvgpr_write_b32 a117, v12
    v_perm_b32 v11, v101, v100, s25
    v_accvgpr_write_b32 a118, v11
    v_perm_b32 v12, v103, v102, s25
    v_accvgpr_write_b32 a119, v12
    v_perm_b32 v11, v105, v104, s24
    v_accvgpr_write_b32 a120, v11
    v_perm_b32 v12, v107, v106, s24
    v_accvgpr_write_b32 a121, v12
    v_perm_b32 v11, v109, v108, s24
    v_accvgpr_write_b32 a122, v11
    v_perm_b32 v12, v111, v110, s24
    v_accvgpr_write_b32 a123, v12
    v_perm_b32 v11, v105, v104, s25
    v_accvgpr_write_b32 a124, v11
    v_perm_b32 v12, v107, v106, s25
    v_accvgpr_write_b32 a125, v12
    v_perm_b32 v11, v109, v108, s25
    v_accvgpr_write_b32 a126, v11
    v_perm_b32 v12, v111, v110, s25
    v_accvgpr_write_b32 a127, v12
    s_waitcnt vmcnt(16)
    v_perm_b32 v11, v129, v128, s24
    v_accvgpr_write_b32 a128, v11
    v_perm_b32 v12, v131, v130, s24
    v_accvgpr_write_b32 a129, v12
    v_perm_b32 v11, v133, v132, s24
    v_accvgpr_write_b32 a130, v11
    v_perm_b32 v12, v135, v134, s24
    v_accvgpr_write_b32 a131, v12
    v_perm_b32 v11, v129, v128, s25
    v_accvgpr_write_b32 a132, v11
    v_perm_b32 v12, v131, v130, s25
    v_accvgpr_write_b32 a133, v12
    v_perm_b32 v11, v133, v132, s25
    v_accvgpr_write_b32 a134, v11
    v_perm_b32 v12, v135, v134, s25
    v_accvgpr_write_b32 a135, v12
    v_perm_b32 v11, v137, v136, s24
    v_accvgpr_write_b32 a136, v11
    v_perm_b32 v12, v139, v138, s24
    v_accvgpr_write_b32 a137, v12
    v_perm_b32 v11, v141, v140, s24
    v_accvgpr_write_b32 a138, v11
    v_perm_b32 v12, v143, v142, s24
    v_accvgpr_write_b32 a139, v12
    v_perm_b32 v11, v137, v136, s25
    v_accvgpr_write_b32 a140, v11
    v_perm_b32 v12, v139, v138, s25
    v_accvgpr_write_b32 a141, v12
    v_perm_b32 v11, v141, v140, s25
    v_accvgpr_write_b32 a142, v11
    v_perm_b32 v12, v143, v142, s25
    v_accvgpr_write_b32 a143, v12
    s_waitcnt vmcnt(0)
    v_perm_b32 v11, v65, v64, s24
    v_accvgpr_write_b32 a144, v11
    v_perm_b32 v12, v67, v66, s24
    v_accvgpr_write_b32 a145, v12
    v_perm_b32 v11, v69, v68, s24
    v_accvgpr_write_b32 a146, v11
    v_perm_b32 v12, v71, v70, s24
    v_accvgpr_write_b32 a147, v12
    v_perm_b32 v11, v65, v64, s25
    v_accvgpr_write_b32 a148, v11
    v_perm_b32 v12, v67, v66, s25
    v_accvgpr_write_b32 a149, v12
    v_perm_b32 v11, v69, v68, s25
    v_accvgpr_write_b32 a150, v11
    v_perm_b32 v12, v71, v70, s25
    v_accvgpr_write_b32 a151, v12
    v_perm_b32 v11, v73, v72, s24
    v_accvgpr_write_b32 a152, v11
    v_perm_b32 v12, v75, v74, s24
    v_accvgpr_write_b32 a153, v12
    v_perm_b32 v11, v77, v76, s24
    v_accvgpr_write_b32 a154, v11
    v_perm_b32 v12, v79, v78, s24
    v_accvgpr_write_b32 a155, v12
    v_perm_b32 v11, v73, v72, s25
    v_accvgpr_write_b32 a156, v11
    v_perm_b32 v12, v75, v74, s25
    v_accvgpr_write_b32 a157, v12
    v_perm_b32 v11, v77, v76, s25
    v_accvgpr_write_b32 a158, v11
    v_perm_b32 v12, v79, v78, s25
    v_accvgpr_write_b32 a159, v12
    s_lshl_b32 s10, s4, 13
    s_lshl_b32 s11, s5, 10
    s_add_u32 s10, s10, s11
    s_add_u32 s10, s10, 92274688
    s_mov_b32 s34, 1040356334
    s_mov_b32 s35, 1040356334
    s_add_u32 s20, s8, s10
    s_addc_u32 s21, s9, 0
    v_lshlrev_b32 v5, 5, v0
    v_add_u32 v5, 4, v5
    s_mov_b32 s27, 0
L_wi_51:
    s_mov_b64 exec, 0xff
    global_load_dword v6, v5, s[6:7] sc1
    s_waitcnt vmcnt(0)
    s_mov_b64 exec, -1
    v_readlane_b32 s10, v6, 0
    v_readlane_b32 s11, v6, 1
    s_add_u32 s10, s10, s11
    v_readlane_b32 s11, v6, 2
    s_add_u32 s10, s10, s11
    v_readlane_b32 s11, v6, 3
    s_add_u32 s10, s10, s11
    v_readlane_b32 s11, v6, 4
    s_add_u32 s10, s10, s11
    v_readlane_b32 s11, v6, 5
    s_add_u32 s10, s10, s11
    v_readlane_b32 s11, v6, 6
    s_add_u32 s10, s10, s11
    v_readlane_b32 s11, v6, 7
    s_add_u32 s10, s10, s11
    s_cmp_ge_u32 s10, 256
    s_cbranch_scc1 L_wiok_52
    s_sleep 4
    s_add_u32 s27, s27, 1
    s_cmp_lt_u32 s27, 262144
    s_cbranch_scc1 L_wi_51
    s_branch L_timeout
L_wiok_52:
    s_mov_b32 s18, 0
    s_mov_b32 s26, 0
    v_add_u32 v12, 0, v14
    v_add_u32 v13, 0, v15
    s_waitcnt vmcnt(0)
L_qp_loop:
    s_waitcnt vmcnt(2)
    s_barrier
    s_cmp_lt_u32 s18, 2
    s_cbranch_scc1 L_nf_53
    s_sub_u32 s30, s18, 1
    s_cmp_eq_u32 s5, 0
    s_cbranch_scc0 L_fl_54
    v_mov_b32 v5, s29
    v_mov_b32 v6, s30
    s_mov_b64 exec, 1
    global_store_dword v5, v6, s[22:23] sc1
    s_mov_b64 exec, -1
L_fl_54:
L_nf_53:
    s_add_u32 s30, s18, 1
    s_cmp_ge_u32 s30, 64
    s_cbranch_scc1 L_nd_55
    s_add_u32 s16, s16, 40960
    s_addc_u32 s17, s17, 0
    s_xor_b32 s31, s26, 40960
    s_mul_i32 s13, s5, 10240
    s_add_u32 s13, s13, s31
    ds_read_b128 v[16:19], v12 offset:0
    ds_read_b128 v[20:23], v12 offset:20480
    ds_read_b128 v[24:27], v13 offset:0
    ds_read_b128 v[28:31], v13 offset:20480
    ds_read_b128 v[32:35], v12 offset:1024
    ds_read_b128 v[36:39], v12 offset:21504
    s_waitcnt lgkmcnt(4)
    v_mfma_f32_16x16x32_bf16 v[40:43], a[0:3], v[16:19], 0
    v_mfma_f32_16x16x32_bf16 v[44:47], a[4:7], v[16:19], 0
    s_add_u32 m0, s13, 0
    s_nop 0
    global_load_lds_dwordx4 v2, s[16:17] offset:0
    v_mfma_f32_16x16x32_bf16 v[48:51], a[0:3], v[20:23], 0
    v_mfma_f32_16x16x32_bf16 v[52:55], a[4:7], v[20:23], 0
    ds_read_b128 v[16:19], v13 offset:1024
    ds_read_b128 v[20:23], v13 offset:21504
    s_waitcnt lgkmcnt(4)
    v_mfma_f32_16x16x32_bf16 v[40:43], a[8:11], v[24:27], v[40:43]
    v_mfma_f32_16x16x32_bf16 v[44:47], a[12:15], v[24:27], v[44:47]
    v_mfma_f32_16x16x32_bf16 v[48:51], a[8:11], v[28:31], v[48:51]
    v_mfma_f32_16x16x32_bf16 v[52:55], a[12:15], v[28:31], v[52:55]
    ds_read_b128 v[24:27], v12 offset:2048
    ds_read_b128 v[28:31], v12 offset:22528
    s_waitcnt lgkmcnt(4)
    v_mfma_f32_16x16x32_bf16 v[40:43], a[16:19], v[32:35], v[40:43]
    v_mfma_f32_16x16x32_bf16 v[44:47], a[20:23], v[32:35], v[44:47]
    s_add_u32 m0, s13, 896
    s_nop 0
    global_load_lds_dwordx4 v2, s[16:17] offset:128
    v_mfma_f32_16x16x32_bf16 v[48:51], a[16:19], v[36:39], v[48:51]
    v_mfma_f32_16x16x32_bf16 v[52:55], a[20:23], v[36:39], v[52:55]
    ds_read_b128 v[32:35], v13 offset:2048
    ds_read_b128 v[36:39], v13 offset:22528
    s_waitcnt lgkmcnt(4)
    v_mfma_f32_16x16x32_bf16 v[40:43], a[24:27], v[16:19], v[40:43]
    v_mfma_f32_16x16x32_bf16 v[44:47], a[28:31], v[16:19], v[44:47]
    v_mfma_f32_16x16x32_bf16 v[48:51], a[24:27], v[20:23], v[48:51]
    v_mfma_f32_16x16x32_bf16 v[52:55], a[28:31], v[20:23], v[52:55]
    ds_read_b128 v[16:19], v12 offset:3072
    ds_read_b128 v[20:23], v12 offset:23552
    s_waitcnt lgkmcnt(4)
    v_mfma_f32_16x16x32_bf16 v[40:43], a[32:35], v[24:27], v[40:43]
    v_mfma_f32_16x16x32_bf16 v[44:47], a[36:39], v[24:27], v[44:47]
    s_add_u32 m0, s13, 1792
    s_nop 0
    global_load_lds_dwordx4 v2, s[16:17] offset:256
    v_mfma_f32_16x16x32_bf16 v[48:51], a[32:35], v[28:31], v[48:51]
    v_mfma_f32_16x16x32_bf16 v[52:55], a[36:39], v[28:31], v[52:55]
    ds_read_b128 v[24:27], v13 offset:3072
    ds_read_b128 v[28:31], v13 offset:23552
    s_waitcnt lgkmcnt(4)
    v_mfma_f32_16x16x32_bf16 v[40:43], a[40:43], v[32:35], v[40:43]
    v_mfma_f32_16x16x32_bf16 v[44:47], a[44:47], v[32:35], v[44:47]
    v_mfma_f32_16x16x32_bf16 v[48:51], a[40:43], v[36:39], v[48:51]
    v_mfma_f32_16x16x32_bf16 v[52:55], a[44:47], v[36:39], v[52:55]
    ds_read_b128 v[32:35], v12 offset:4096
    ds_read_b128 v[36:39], v12 offset:24576
    s_waitcnt lgkmcnt(4)
    v_mfma_f32_16x16x32_bf16 v[40:43], a[48:51], v[16:19], v[40:43]
    v_mfma_f32_16x16x32_bf16 v[44:47], a[52:55], v[16:19], v[44:47]
    s_add_u32 m0, s13, 2688
    s_nop 0
    global_load_lds_dwordx4 v2, s[16:17] offset:384
    v_mfma_f32_16x16x32_bf16 v[48:51], a[48:51], v[20:23], v[48:51]
    v_mfma_f32_16x16x32_bf16 v[52:55], a[52:55], v[20:23], v[52:55]
    ds_read_b128 v[16:19], v13 offset:4096
    ds_read_b128 v[20:23], v13 offset:24576
    s_waitcnt lgkmcnt(4)
    v_mfma_f32_16x16x32_bf16 v[40:43], a[56:59], v[24:27], v[40:43]
    v_mfma_f32_16x16x32_bf16 v[44:47], a[60:63], v[24:27], v[44:47]
    v_mfma_f32_16x16x32_bf16 v[48:51], a[56:59], v[28:31], v[48:51]
    v_mfma_f32_16x16x32_bf16 v[52:55], a[60:63], v[28:31], v[52:55]
    ds_read_b128 v[24:27], v12 offset:5120
    ds_read_b128 v[28:31], v12 offset:25600
    s_waitcnt lgkmcnt(4)
    v_mfma_f32_16x16x32_bf16 v[40:43], a[64:67], v[32:35], v[40:43]
    v_mfma_f32_16x16x32_bf16 v[44:47], a[68:71], v[32:35], v[44:47]
    s_add_u32 m0, s13, 3584
    s_nop 0
    global_load_lds_dwordx4 v2, s[16:17] offset:512
    v_mfma_f32_16x16x32_bf16 v[48:51], a[64:67], v[36:39], v[48:51]
    v_mfma_f32_16x16x32_bf16 v[52:55], a[68:71], v[36:39], v[52:55]
    ds_read_b128 v[32:35], v13 offset:5120
    ds_read_b128 v[36:39], v13 offset:25600
    s_waitcnt lgkmcnt(4)
    v_mfma_f32_16x16x32_bf16 v[40:43], a[72:75], v[16:19], v[40:43]
    v_mfma_f32_16x16x32_bf16 v[44:47], a[76:79], v[16:19], v[44:47]
    v_mfma_f32_16x16x32_bf16 v[48:51], a[72:75], v[20:23], v[48:51]
    v_mfma_f32_16x16x32_bf16 v[52:55], a[76:79], v[20:23], v[52:55]
    ds_read_b128 v[16:19], v12 offset:6144
    ds_read_b128 v[20:23], v12 offset:26624
    s_waitcnt lgkmcnt(4)
    v_mfma_f32_16x16x32_bf16 v[40:43], a[80:83], v[24:27], v[40:43]
    v_mfma_f32_16x16x32_bf16 v[44:47], a[84:87], v[24:27], v[44:47]
    s_add_u32 m0, s13, 4480
    s_nop 0
    global_load_lds_dwordx4 v2, s[16:17] offset:640
    v_mfma_f32_16x16x32_bf16 v[48:51], a[80:83], v[28:31], v[48:51]
    v_mfma_f32_16x16x32_bf16 v[52:55], a[84:87], v[28:31], v[52:55]
    ds_read_b128 v[24:27], v13 offset:6144
    ds_read_b128 v[28:31], v13 offset:26624
    s_waitcnt lgkmcnt(4)
    v_mfma_f32_16x16x32_bf16 v[40:43], a[88:91], v[32:35], v[40:43]
    v_mfma_f32_16x16x32_bf16 v[44:47], a[92:95], v[32:35], v[44:47]
    v_mfma_f32_16x16x32_bf16 v[48:51], a[88:91], v[36:39], v[48:51]
    v_mfma_f32_16x16x32_bf16 v[52:55], a[92:95], v[36:39], v[52:55]
    ds_read_b128 v[32:35], v12 offset:7168
    ds_read_b128 v[36:39], v12 offset:27648
    s_waitcnt lgkmcnt(4)
    v_mfma_f32_16x16x32_bf16 v[40:43], a[96:99], v[16:19], v[40:43]
    v_mfma_f32_16x16x32_bf16 v[44:47], a[100:103], v[16:19], v[44:47]
    s_add_u32 m0, s13, 5376
    s_nop 0
    global_load_lds_dwordx4 v2, s[16:17] offset:768
    v_mfma_f32_16x16x32_bf16 v[48:51], a[96:99], v[20:23], v[48:51]
    v_mfma_f32_16x16x32_bf16 v[52:55], a[100:103], v[20:23], v[52:55]
    ds_read_b128 v[16:19], v13 offset:7168
    ds_read_b128 v[20:23], v13 offset:27648
    s_waitcnt lgkmcnt(4)
    v_mfma_f32_16x16x32_bf16 v[40:43], a[104:107], v[24:27], v[40:43]
    v_mfma_f32_16x16x32_bf16 v[44:47], a[108:111], v[24:27], v[44:47]
    v_mfma_f32_16x16x32_bf16 v[48:51], a[104:107], v[28:31], v[48:51]
    v_mfma_f32_16x16x32_bf16 v[52:55], a[108:111], v[28:31], v[52:55]
    ds_read_b128 v[24:27], v12 offset:8192
    ds_read_b128 v[28:31], v12 offset:28672
    s_waitcnt lgkmcnt(4)
    v_mfma_f32_16x16x32_bf16 v[40:43], a[112:115], v[32:35], v[40:43]
    v_mfma_f32_16x16x32_bf16 v[44:47], a[116:119], v[32:35], v[44:47]
    s_add_u32 m0, s13, 6272
    s_nop 0
    global_load_lds_dwordx4 v2, s[16:17] offset:896
    v_mfma_f32_16x16x32_bf16 v[48:51], a[112:115], v[36:39], v[48:51]
    v_mfma_f32_16x16x32_bf16 v[52:55], a[116:119], v[36:39], v[52:55]
    ds_read_b128 v[32:35], v13 offset:8192
    ds_read_b128 v[36:39], v13 offset:28672
    s_waitcnt lgkmcnt(4)
    v_mfma_f32_16x16x32_bf16 v[40:43], a[120:123], v[16:19], v[40:43]
    v_mfma_f32_16x16x32_bf16 v[44:47], a[124:127], v[16:19], v[44:47]
    v_mfma_f32_16x16x32_bf16 v[48:51], a[120:123], v[20:23], v[48:51]
    v_mfma_f32_16x16x32_bf16 v[52:55], a[124:127], v[20:23], v[52:55]
    ds_read_b128 v[16:19], v12 offset:9216
    ds_read_b128 v[20:23], v12 offset:29696
    s_waitcnt lgkmcnt(4)
    v_mfma_f32_16x16x32_bf16 v[40:43], a[128:131], v[24:27], v[40:43]
    v_mfma_f32_16x16x32_bf16 v[44:47], a[132:135], v[24:27], v[44:47]
    s_add_u32 m0, s13, 7168
    s_nop 0
    global_load_lds_dwordx4 v2, s[16:17] offset:1024
    v_mfma_f32_16x16x32_bf16 v[48:51], a[128:131], v[28:31], v[48:51]
    v_mfma_f32_16x16x32_bf16 v[52:55], a[132:135], v[28:31], v[52:55]
    ds_read_b128 v[24:27], v13 offset:9216
    ds_read_b128 v[28:31], v13 offset:29696
    s_waitcnt lgkmcnt(4)
    v_mfma_f32_16x16x32_bf16 v[40:43], a[136:139], v[32:35], v[40:43]
    v_mfma_f32_16x16x32_bf16 v[44:47], a[140:143], v[32:35], v[44:47]
    v_mfma_f32_16x16x32_bf16 v[48:51], a[136:139], v[36:39], v[48:51]
    v_mfma_f32_16x16x32_bf16 v[52:55], a[140:143], v[36:39], v[52:55]
    s_waitcnt lgkmcnt(2)
    v_mfma_f32_16x16x32_bf16 v[40:43], a[144:147], v[16:19], v[40:43]
    v_mfma_f32_16x16x32_bf16 v[44:47], a[148:151], v[16:19], v[44:47]
    s_add_u32 m0, s13, 8064
    s_nop 0
    global_load_lds_dwordx4 v2, s[16:17] offset:1152
    v_mfma_f32_16x16x32_bf16 v[48:51], a[144:147], v[20:23], v[48:51]
    v_mfma_f32_16x16x32_bf16 v[52:55], a[148:151], v[20:23], v[52:55]
    s_waitcnt lgkmcnt(0)
    v_mfma_f32_16x16x32_bf16 v[40:43], a[152:155], v[24:27], v[40:43]
    v_mfma_f32_16x16x32_bf16 v[44:47], a[156:159], v[24:27], v[44:47]
    v_mfma_f32_16x16x32_bf16 v[48:51], a[152:155], v[28:31], v[48:51]
    v_mfma_f32_16x16x32_bf16 v[52:55], a[156:159], v[28:31], v[52:55]
    s_branch L_nd2_56
L_nd_55:
    ds_read_b128 v[16:19], v12 offset:0
    ds_read_b128 v[20:23], v12 offset:20480
    ds_read_b128 v[24:27], v13 offset:0
    ds_read_b128 v[28:31], v13 offset:20480
    ds_read_b128 v[32:35], v12 offset:1024
    ds_read_b128 v[36:39], v12 offset:21504
    s_waitcnt lgkmcnt(4)
    v_mfma_f32_16x16x32_bf16 v[40:43], a[0:3], v[16:19], 0
    v_mfma_f32_16x16x32_bf16 v[44:47], a[4:7], v[16:19], 0
    v_mfma_f32_16x16x32_bf16 v[48:51], a[0:3], v[20:23], 0
    v_mfma_f32_16x16x32_bf16 v[52:55], a[4:7], v[20:23], 0
    ds_read_b128 v[16:19], v13 offset:1024
    ds_read_b128 v[20:23], v13 offset:21504
    s_waitcnt lgkmcnt(4)
    v_mfma_f32_16x16x32_bf16 v[40:43], a[8:11], v[24:27], v[40:43]
    v_mfma_f32_16x16x32_bf16 v[44:47], a[12:15], v[24:27], v[44:47]
    v_mfma_f32_16x16x32_bf16 v[48:51], a[8:11], v[28:31], v[48:51]
    v_mfma_f32_16x16x32_bf16 v[52:55], a[12:15], v[28:31], v[52:55]
    ds_read_b128 v[24:27], v12 offset:2048
    ds_read_b128 v[28:31], v12 offset:22528
    s_waitcnt lgkmcnt(4)
    v_mfma_f32_16x16x32_bf16 v[40:43], a[16:19], v[32:35], v[40:43]
    v_mfma_f32_16x16x32_bf16 v[44:47], a[20:23], v[32:35], v[44:47]
    v_mfma_f32_16x16x32_bf16 v[48:51], a[16:19], v[36:39], v[48:51]
    v_mfma_f32_16x16x32_bf16 v[52:55], a[20:23], v[36:39], v[52:55]
    ds_read_b128 v[32:35], v13 offset:2048
    ds_read_b128 v[36:39], v13 offset:22528
    s_waitcnt lgkmcnt(4)
    v_mfma_f32_16x16x32_bf16 v[40:43], a[24:27], v[16:19], v[40:43]
    v_mfma_f32_16x16x32_bf16 v[44:47], a[28:31], v[16:19], v[44:47]
    v_mfma_f32_16x16x32_bf16 v[48:51], a[24:27], v[20:23], v[48:51]
    v_mfma_f32_16x16x32_bf16 v[52:55], a[28:31], v[20:23], v[52:55]
    ds_read_b128 v[16:19], v12 offset:3072
    ds_read_b128 v[20:23], v12 offset:23552
    s_waitcnt lgkmcnt(4)
    v_mfma_f32_16x16x32_bf16 v[40:43], a[32:35], v[24:27], v[40:43]
    v_mfma_f32_16x16x32_bf16 v[44:47], a[36:39], v[24:27], v[44:47]
    v_mfma_f32_16x16x32_bf16 v[48:51], a[32:35], v[28:31], v[48:51]
    v_mfma_f32_16x16x32_bf16 v[52:55], a[36:39], v[28:31], v[52:55]
    ds_read_b128 v[24:27], v13 offset:3072
    ds_read_b128 v[28:31], v13 offset:23552
    s_waitcnt lgkmcnt(4)
    v_mfma_f32_16x16x32_bf16 v[40:43], a[40:43], v[32:35], v[40:43]
    v_mfma_f32_16x16x32_bf16 v[44:47], a[44:47], v[32:35], v[44:47]
    v_mfma_f32_16x16x32_bf16 v[48:51], a[40:43], v[36:39], v[48:51]
    v_mfma_f32_16x16x32_bf16 v[52:55], a[44:47], v[36:39], v[52:55]
    ds_read_b128 v[32:35], v12 offset:4096
    ds_read_b128 v[36:39], v12 offset:24576
    s_waitcnt lgkmcnt(4)
    v_mfma_f32_16x16x32_bf16 v[40:43], a[48:51], v[16:19], v[40:43]
    v_mfma_f32_16x16x32_bf16 v[44:47], a[52:55], v[16:19], v[44:47]
    v_mfma_f32_16x16x32_bf16 v[48:51], a[48:51], v[20:23], v[48:51]
    v_mfma_f32_16x16x32_bf16 v[52:55], a[52:55], v[20:23], v[52:55]
    ds_read_b128 v[16:19], v13 offset:4096
    ds_read_b128 v[20:23], v13 offset:24576
    s_waitcnt lgkmcnt(4)
    v_mfma_f32_16x16x32_bf16 v[40:43], a[56:59], v[24:27], v[40:43]
    v_mfma_f32_16x16x32_bf16 v[44:47], a[60:63], v[24:27], v[44:47]
    v_mfma_f32_16x16x32_bf16 v[48:51], a[56:59], v[28:31], v[48:51]
    v_mfma_f32_16x16x32_bf16 v[52:55], a[60:63], v[28:31], v[52:55]
    ds_read_b128 v[24:27], v12 offset:5120
    ds_read_b128 v[28:31], v12 offset:25600
    s_waitcnt lgkmcnt(4)
    v_mfma_f32_16x16x32_bf16 v[40:43], a[64:67], v[32:35], v[40:43]
    v_mfma_f32_16x16x32_bf16 v[44:47], a[68:71], v[32:35], v[44:47]
    v_mfma_f32_16x16x32_bf16 v[48:51], a[64:67], v[36:39], v[48:51]
    v_mfma_f32_16x16x32_bf16 v[52:55], a[68:71], v[36:39], v[52:55]
    ds_read_b128 v[32:35], v13 offset:5120
    ds_read_b128 v[36:39], v13 offset:25600
    s_waitcnt lgkmcnt(4)
    v_mfma_f32_16x16x32_bf16 v[40:43], a[72:75], v[16:19], v[40:43]
    v_mfma_f32_16x16x32_bf16 v[44:47], a[76:79], v[16:19], v[44:47]
    v_mfma_f32_16x16x32_bf16 v[48:51], a[72:75], v[20:23], v[48:51]
    v_mfma_f32_16x16x32_bf16 v[52:55], a[76:79], v[20:23], v[52:55]
    ds_read_b128 v[16:19], v12 offset:6144
    ds_read_b128 v[20:23], v12 offset:26624
    s_waitcnt lgkmcnt(4)
    v_mfma_f32_16x16x32_bf16 v[40:43], a[80:83], v[24:27], v[40:43]
    v_mfma_f32_16x16x32_bf16 v[44:47], a[84:87], v[24:27], v[44:47]
    v_mfma_f32_16x16x32_bf16 v[48:51], a[80:83], v[28:31], v[48:51]
    v_mfma_f32_16x16x32_bf16 v[52:55], a[84:87], v[28:31], v[52:55]
    ds_read_b128 v[24:27], v13 offset:6144
    ds_read_b128 v[28:31], v13 offset:26624
    s_waitcnt lgkmcnt(4)
    v_mfma_f32_16x16x32_bf16 v[40:43], a[88:91], v[32:35], v[40:43]
    v_mfma_f32_16x16x32_bf16 v[44:47], a[92:95], v[32:35], v[44:47]
    v_mfma_f32_16x16x32_bf16 v[48:51], a[88:91], v[36:39], v[48:51]
    v_mfma_f32_16x16x32_bf16 v[52:55], a[92:95], v[36:39], v[52:55]
    ds_read_b128 v[32:35], v12 offset:7168
    ds_read_b128 v[36:39], v12 offset:27648
    s_waitcnt lgkmcnt(4)
    v_mfma_f32_16x16x32_bf16 v[40:43], a[96:99], v[16:19], v[40:43]
    v_mfma_f32_16x16x32_bf16 v[44:47], a[100:103], v[16:19], v[44:47]
    v_mfma_f32_16x16x32_bf16 v[48:51], a[96:99], v[20:23], v[48:51]
    v_mfma_f32_16x16x32_bf16 v[52:55], a[100:103], v[20:23], v[52:55]
    ds_read_b128 v[16:19], v13 offset:7168
    ds_read_b128 v[20:23], v13 offset:27648
    s_waitcnt lgkmcnt(4)
    v_mfma_f32_16x16x32_bf16 v[40:43], a[104:107], v[24:27], v[40:43]
    v_mfma_f32_16x16x32_bf16 v[44:47], a[108:111], v[24:27], v[44:47]
    v_mfma_f32_16x16x32_bf16 v[48:51], a[104:107], v[28:31], v[48:51]
    v_mfma_f32_16x16x32_bf16 v[52:55], a[108:111], v[28:31], v[52:55]
    ds_read_b128 v[24:27], v12 offset:8192
    ds_read_b128 v[28:31], v12 offset:28672
    s_waitcnt lgkmcnt(4)
    v_mfma_f32_16x16x32_bf16 v[40:43], a[112:115], v[32:35], v[40:43]
    v_mfma_f32_16x16x32_bf16 v[44:47], a[116:119], v[32:35], v[44:47]
    v_mfma_f32_16x16x32_bf16 v[48:51], a[112:115], v[36:39], v[48:51]
    v_mfma_f32_16x16x32_bf16 v[52:55], a[116:119], v[36:39], v[52:55]
    ds_read_b128 v[32:35], v13 offset:8192
    ds_read_b128 v[36:39], v13 offset:28672
    s_waitcnt lgkmcnt(4)
    v_mfma_f32_16x16x32_bf16 v[40:43], a[120:123], v[16:19], v[40:43]
    v_mfma_f32_16x16x32_bf16 v[44:47], a[124:127], v[16:19], v[44:47]
    v_mfma_f32_16x16x32_bf16 v[48:51], a[120:123], v[20:23], v[48:51]
    v_mfma_f32_16x16x32_bf16 v[52:55], a[124:127], v[20:23], v[52:55]
    ds_read_b128 v[16:19], v12 offset:9216
    ds_read_b128 v[20:23], v12 offset:29696
    s_waitcnt lgkmcnt(4)
    v_mfma_f32_16x16x32_bf16 v[40:43], a[128:131], v[24:27], v[40:43]
    v_mfma_f32_16x16x32_bf16 v[44:47], a[132:135], v[24:27], v[44:47]
    v_mfma_f32_16x16x32_bf16 v[48:51], a[128:131], v[28:31], v[48:51]
    v_mfma_f32_16x16x32_bf16 v[52:55], a[132:135], v[28:31], v[52:55]
    ds_read_b128 v[24:27], v13 offset:9216
    ds_read_b128 v[28:31], v13 offset:29696
    s_waitcnt lgkmcnt(4)
    v_mfma_f32_16x16x32_bf16 v[40:43], a[136:139], v[32:35], v[40:43]
    v_mfma_f32_16x16x32_bf16 v[44:47], a[140:143], v[32:35], v[44:47]
    v_mfma_f32_16x16x32_bf16 v[48:51], a[136:139], v[36:39], v[48:51]
    v_mfma_f32_16x16x32_bf16 v[52:55], a[140:143], v[36:39], v[52:55]
    s_waitcnt lgkmcnt(2)
    v_mfma_f32_16x16x32_bf16 v[40:43], a[144:147], v[16:19], v[40:43]
    v_mfma_f32_16x16x32_bf16 v[44:47], a[148:151], v[16:19], v[44:47]
    v_mfma_f32_16x16x32_bf16 v[48:51], a[144:147], v[20:23], v[48:51]
    v_mfma_f32_16x16x32_bf16 v[52:55], a[148:151], v[20:23], v[52:55]
    s_waitcnt lgkmcnt(0)
    v_mfma_f32_16x16x32_bf16 v[40:43], a[152:155], v[24:27], v[40:43]
    v_mfma_f32_16x16x32_bf16 v[44:47], a[156:159], v[24:27], v[44:47]
    v_mfma_f32_16x16x32_bf16 v[48:51], a[152:155], v[28:31], v[48:51]
    v_mfma_f32_16x16x32_bf16 v[52:55], a[156:159], v[28:31], v[52:55]
L_nd2_56:
    v_pk_mul_f32 v[40:41], v[40:41], s[34:35]
    v_pk_mul_f32 v[42:43], v[42:43], s[34:35]
    v_pk_mul_f32 v[44:45], v[44:45], s[34:35]
    v_pk_mul_f32 v[46:47], v[46:47], s[34:35]
    s_nop 0
    v_pk_mul_f32 v[48:49], v[48:49], s[34:35]
    v_pk_mul_f32 v[50:51], v[50:51], s[34:35]
    s_nop 0
    v_pk_mul_f32 v[52:53], v[52:53], s[34:35]
    v_pk_mul_f32 v[54:55], v[54:55], s[34:35]
    v_cvt_pk_bf16_f32 v56, v40, v44
    v_cvt_pk_bf16_f32 v57, v41, v45
    v_cvt_pk_bf16_f32 v58, v42, v46
    v_cvt_pk_bf16_f32 v59, v43, v47
    global_store_dwordx4 v1, v[56:59], s[20:21] offset:0 sc1
    v_cvt_pk_bf16_f32 v60, v48, v52
    v_cvt_pk_bf16_f32 v61, v49, v53
    v_cvt_pk_bf16_f32 v62, v50, v54
    v_cvt_pk_bf16_f32 v63, v51, v55
    s_add_u32 s14, s20, 4096
    s_addc_u32 s15, s21, 0
    global_store_dwordx4 v1, v[60:63], s[14:15] sc1
    s_add_u32 s20, s20, 262144
    s_addc_u32 s21, s21, 0
    s_xor_b32 s26, s26, 40960
    v_add_u32 v12, s26, v14
    v_add_u32 v13, s26, v15
    s_add_u32 s18, s18, 1
    s_cmp_lt_u32 s18, 64
    s_cbranch_scc1 L_qp_loop
    s_waitcnt vmcnt(0)
    s_barrier
    s_mov_b32 s30, 64
    s_cmp_eq_u32 s5, 0
    s_cbranch_scc0 L_fl_57
    v_mov_b32 v5, s29
    v_mov_b32 v6, s30
    s_mov_b64 exec, 1
    global_store_dword v5, v6, s[22:23] sc1
    s_mov_b64 exec, -1
L_fl_57:
    s_waitcnt vmcnt(0)
    s_endpgm
L_s1:
    s_add_u32 s22, s8, 5767168
    s_addc_u32 s23, s9, 0
    s_lshl_b32 s58, s4, 7
    s_add_u32 s58, s58, 16384
    s_mov_b32 s30, 0
    s_cmp_eq_u32 s5, 0
    s_cbranch_scc0 L_fl_58
    v_mov_b32 v5, s58
    v_mov_b32 v6, s30
    s_mov_b64 exec, 1
    global_store_dword v5, v6, s[22:23] sc1
    s_mov_b64 exec, -1
L_fl_58:
    s_waitcnt vmcnt(0)
    s_barrier
    s_cmp_eq_u32 s5, 0
    s_cbranch_scc0 L_si_59
    s_lshl_b32 s10, s3, 5
    s_add_u32 s10, s10, 4
    v_mov_b32 v5, s10
    v_mov_b32 v6, 1
    s_mov_b64 exec, 1
    global_atomic_add v5, v6, s[6:7]
    s_mov_b64 exec, -1
L_si_59:
    v_lshlrev_b32 v1, 4, v0
    s_and_b32 s11, s5, 1
    s_lshr_b32 s12, s5, 1
    s_lshl_b32 s13, s11, 12
    s_add_u32 s13, s13, 0
    v_add_u32 v7, s13, v1
    v_add_u32 v8, 16384, v1
    s_lshl_b32 s13, s12, 12
    s_add_u32 s13, s13, 24576
    v_add_u32 v9, s13, v1
    v_lshrrev_b32 v5, 4, v0
    v_lshlrev_b32 v5, 2, v5
    v_bfe_u32 v6, v0, 3, 1
    v_add_u32 v5, v5, v6
    v_lshlrev_b32 v10, 3, v5
    v_and_b32 v6, 1, v0
    v_lshl_add_u32 v10, v6, 7, v10
    v_bfe_u32 v6, v0, 2, 1
    v_lshl_add_u32 v10, v6, 8, v10
    v_add_u32 v10, 49152, v10
    v_and_b32 v5, 31, v0
    v_lshlrev_b32 v11, 3, v5
    s_lshl_b32 s13, s12, 10
    s_add_u32 s13, s13, 51200
    v_add_u32 v11, s13, v11
    s_lshl_b32 s13, s11, 17
    s_lshl_b32 s14, s4, 12
    s_add_u32 s13, s13, s14
    s_lshl_b32 s14, s12, 11
    s_add_u32 s13, s13, s14
    v_add_u32 v12, s13, v1
    s_lshl_b32 s13, s5, 12
    v_add_u32 v13, s13, v1
    s_lshl_b32 s13, s5, 11
    v_add_u32 v16, s13, v1
    v_mov_b32 v15, 0xff7fffff
    s_mov_b32 s48, -1
    s_mov_b32 s49, 0
    v_and_b32 v5, 3, v0
    v_lshlrev_b32 v6, 12, v5
    v_mov_b32 v20, 28672
    v_cmp_eq_u32 vcc, 2, v5
    s_nop 1
    v_cndmask_b32 v6, v6, v20, vcc
    s_lshl_b32 s10, s4, 7
    v_add_u32 v17, s10, v6
    v_and_b32 v5, 1, v0
    v_lshlrev_b32 v6, 7, v5
    s_lshl_b32 s10, s4, 8
    s_add_u32 s10, s10, 8192
    v_add_u32 v18, s10, v6
    v_and_b32 v5, 15, v0
    v_lshrrev_b32 v6, 4, v0
    v_lshlrev_b32 v6, 2, v6
    v_add_u32 v20, 0, v6
    v_cmp_le_u32 vcc, v20, v5
    s_nop 3
    s_cmp_eq_u32 s11, 0
    s_cselect_b64 s[32:33], vcc, -1
    s_cselect_b64 s[40:41], 0, vcc
    v_add_u32 v20, 1, v6
    v_cmp_le_u32 vcc, v20, v5
    s_nop 3
    s_cmp_eq_u32 s11, 0
    s_cselect_b64 s[34:35], vcc, -1
    s_cselect_b64 s[42:43], 0, vcc
    v_add_u32 v20, 2, v6
    v_cmp_le_u32 vcc, v20, v5
    s_nop 3
    s_cmp_eq_u32 s11, 0
    s_cselect_b64 s[36:37], vcc, -1
    s_cselect_b64 s[44:45], 0, vcc
    v_add_u32 v20, 3, v6
    v_cmp_le_u32 vcc, v20, v5
    s_nop 3
    s_cmp_eq_u32 s11, 0
    s_cselect_b64 s[38:39], vcc, -1
    s_cselect_b64 s[46:47], 0, vcc
    s_lshl_b32 s10, s4, 14
    s_add_u32 s10, s10, 16777216
    s_add_u32 s50, s8, s10
    s_addc_u32 s51, s9, 0
    s_lshl_b32 s10, s4, 13
    s_add_u32 s10, s10, 92274688
    s_add_u32 s56, s8, s10
    s_addc_u32 s57, s9, 0
    s_lshl_b32 s10, s4, 12
    s_add_u32 s10, s10, 8388608
    s_add_u32 s52, s8, s10
    s_addc_u32 s53, s9, 0
    s_add_u32 s54, s8, 50331648
    s_addc_u32 s55, s9, 0
    v_lshlrev_b32 v5, 5, v0
    v_add_u32 v5, 4, v5
    s_mov_b32 s27, 0
L_wi_60:
    s_mov_b64 exec, 0xff
    global_load_dword v6, v5, s[6:7] sc1
    s_waitcnt vmcnt(0)
    s_mov_b64 exec, -1
    v_readlane_b32 s10, v6, 0
    v_readlane_b32 s11, v6, 1
    s_add_u32 s10, s10, s11
    v_readlane_b32 s11, v6, 2
    s_add_u32 s10, s10, s11
    v_readlane_b32 s11, v6, 3
    s_add_u32 s10, s10, s11
    v_readlane_b32 s11, v6, 4
    s_add_u32 s10, s10, s11
    v_readlane_b32 s11, v6, 5
    s_add_u32 s10, s10, s11
    v_readlane_b32 s11, v6, 6
    s_add_u32 s10, s10, s11
    v_readlane_b32 s11, v6, 7
    s_add_u32 s10, s10, s11
    s_cmp_ge_u32 s10, 256
    s_cbranch_scc1 L_wiok_61
    s_sleep 4
    s_add_u32 s27, s27, 1
    s_cmp_lt_u32 s27, 262144
    s_cbranch_scc1 L_wi_60
    s_branch L_timeout
L_wiok_61:
    s_mov_b32 s18, 0
    s_mov_b32 s59, 0
    s_mov_b32 s30, 1
    s_mov_b32 s27, 0
L_pfq0_62:
    s_mov_b64 exec, 7
    global_load_dword v5, v17, s[22:23] sc1
    s_waitcnt vmcnt(0)
    v_cmp_gt_u32 vcc, s30, v5
    s_mov_b64 exec, -1
    s_cbranch_vccz L_pfoq0_63
    s_sleep 1
    s_add_u32 s27, s27, 1
    s_cmp_lt_u32 s27, 262144
    s_cbranch_scc1 L_pfq0_62
    s_branch L_timeout
L_pfoq0_63:
    s_lshl_b32 s10, s5, 12
    s_lshl_b32 s11, s59, 14
    s_add_u32 s10, s10, s11
    s_add_u32 m0, s10, 16384
    s_nop 0
    global_load_lds_dwordx4 v13, s[50:51] offset:0 sc1
    global_load_lds_dwordx4 v13, s[50:51] offset:1024 sc1
    global_load_lds_dwordx4 v13, s[50:51] offset:2048 sc1
    global_load_lds_dwordx4 v13, s[50:51] offset:3072 sc1
    s_lshl_b32 s10, s5, 11
    s_lshl_b32 s11, s59, 13
    s_add_u32 s10, s10, s11
    s_add_u32 m0, s10, 0
    s_nop 0
    global_load_lds_dwordx4 v16, s[56:57] offset:0 sc1
    global_load_lds_dwordx4 v16, s[56:57] offset:1024 sc1
    s_add_u32 s50, s50, 524288
    s_addc_u32 s51, s51, 0
    s_add_u32 s56, s56, 262144
    s_addc_u32 s57, s57, 0
L_s1_loop:
    s_add_u32 s30, s18, 1
    s_mov_b32 s27, 0
L_pfkm_64:
    s_mov_b64 exec, 3
    global_load_dword v5, v18, s[22:23] sc1
    s_waitcnt vmcnt(0)
    v_cmp_gt_u32 vcc, s30, v5
    s_mov_b64 exec, -1
    s_cbranch_vccz L_pfokm_65
    s_sleep 1
    s_add_u32 s27, s27, 1
    s_cmp_lt_u32 s27, 262144
    s_cbranch_scc1 L_pfkm_64
    s_branch L_timeout
L_pfokm_65:
    s_lshl_b32 s10, s5, 10
    s_add_u32 m0, s10, 49152
    v_add_u32 v5, s10, v1
    global_load_lds_dwordx4 v5, s[52:53] sc1
    s_mov_b64 exec, 7
    global_load_dword v19, v17, s[22:23] sc1
    s_mov_b64 exec, -1
    s_waitcnt vmcnt(0)
    s_barrier
    ds_read_b128 v[64:67], v7 offset:0
    ds_read_b128 v[68:71], v7 offset:1024
    ds_read_b128 v[72:75], v7 offset:2048
    ds_read_b128 v[76:79], v7 offset:3072
    ds_read_b128 v[96:99], v8 offset:0
    ds_read_b128 v[100:103], v8 offset:1024
    ds_read_b128 v[104:107], v8 offset:2048
    ds_read_b128 v[108:111], v8 offset:3072
    ds_read_b128 v[112:115], v8 offset:4096
    ds_read_b128 v[116:119], v8 offset:5120
    ds_read_b128 v[120:123], v8 offset:6144
    ds_read_b128 v[124:127], v8 offset:7168
    s_waitcnt lgkmcnt(4)
    v_mfma_f32_16x16x32_bf16 v[84:87], v[96:99], v[64:67], 0
    ds_read_b64_tr_b16 v[128:129], v10 offset:0
    ds_read_b64_tr_b16 v[130:131], v10 offset:16
    v_mfma_f32_16x16x32_bf16 v[84:87], v[100:103], v[68:71], v[84:87]
    ds_read_b64_tr_b16 v[132:133], v10 offset:512
    ds_read_b64_tr_b16 v[134:135], v10 offset:528
    v_mfma_f32_16x16x32_bf16 v[84:87], v[104:107], v[72:75], v[84:87]
    ds_read_b64_tr_b16 v[136:137], v10 offset:1024
    ds_read_b64_tr_b16 v[138:139], v10 offset:1040
    v_mfma_f32_16x16x32_bf16 v[84:87], v[108:111], v[76:79], v[84:87]
    ds_read_b64_tr_b16 v[140:141], v10 offset:1536
    ds_read_b64_tr_b16 v[142:143], v10 offset:1552
    s_waitcnt lgkmcnt(8)
    v_mfma_f32_16x16x32_bf16 v[88:91], v[112:115], v[64:67], 0
    v_mfma_f32_16x16x32_bf16 v[88:91], v[116:119], v[68:71], v[88:91]
    v_mfma_f32_16x16x32_bf16 v[88:91], v[120:123], v[72:75], v[88:91]
    v_mfma_f32_16x16x32_bf16 v[88:91], v[124:127], v[76:79], v[88:91]
    s_waitcnt lgkmcnt(0)
    v_mfma_f32_16x16x32_bf16 v[80:83], v[128:131], v[64:67], 0
    v_mfma_f32_16x16x32_bf16 v[80:83], v[132:135], v[68:71], v[80:83]
    v_mfma_f32_16x16x32_bf16 v[80:83], v[136:139], v[72:75], v[80:83]
    v_mfma_f32_16x16x32_bf16 v[80:83], v[140:143], v[76:79], v[80:83]
    ds_read_b128 v[144:147], v9 offset:0
    ds_read_b64 v[160:161], v11 offset:0
    ds_read_b128 v[148:151], v9 offset:1024
    ds_read_b64 v[162:163], v11 offset:256
    ds_read_b128 v[152:155], v9 offset:2048
    ds_read_b64 v[164:165], v11 offset:512
    ds_read_b128 v[156:159], v9 offset:3072
    ds_read_b64 v[166:167], v11 offset:768
    v_cndmask_b32 v84, v15, v84, s[32:33]
    v_cndmask_b32 v88, v15, v88, s[40:41]
    v_cndmask_b32 v85, v15, v85, s[34:35]
    v_cndmask_b32 v89, v15, v89, s[42:43]
    v_cndmask_b32 v86, v15, v86, s[36:37]
    v_cndmask_b32 v90, v15, v90, s[44:45]
    v_cndmask_b32 v87, v15, v87, s[38:39]
    v_cndmask_b32 v91, v15, v91, s[46:47]
    v_cndmask_b32 v80, v15, v80, s[48:49]
    v_cndmask_b32 v81, v15, v81, s[48:49]
    v_cndmask_b32 v82, v15, v82, s[48:49]
    v_cndmask_b32 v83, v15, v83, s[48:49]
    v_max3_f32 v5, v80, v81, v82
    v_max3_f32 v5, v5, v83, v84
    v_max3_f32 v5, v5, v85, v86
    v_max3_f32 v5, v5, v87, v88
    v_max3_f32 v5, v5, v89, v90
    v_max_f32 v5, v5, v91
    v_mov_b32 v6, v5
    s_nop 1
    v_permlane32_swap_b32 v5, v6
    v_max_f32 v5, v5, v6
    v_mov_b32 v6, v5
    s_nop 1
    v_permlane16_swap_b32 v5, v6
    v_max_f32 v5, v5, v6
    v_sub_f32 v80, v80, v5
    v_sub_f32 v81, v81, v5
    v_sub_f32 v82, v82, v5
    v_sub_f32 v83, v83, v5
    v_sub_f32 v84, v84, v5
    v_sub_f32 v85, v85, v5
    v_sub_f32 v86, v86, v5
    v_sub_f32 v87, v87, v5
    v_sub_f32 v88, v88, v5
    v_sub_f32 v89, v89, v5
    v_sub_f32 v90, v90, v5
    v_sub_f32 v91, v91, v5
    v_exp_f32 v80, v80
    v_exp_f32 v81, v81
    v_exp_f32 v82, v82
    v_exp_f32 v83, v83
    v_exp_f32 v84, v84
    v_exp_f32 v85, v85
    v_exp_f32 v86, v86
    v_exp_f32 v87, v87
    v_exp_f32 v88, v88
    v_exp_f32 v89, v89
    v_exp_f32 v90, v90
    v_exp_f32 v91, v91
    v_cvt_pk_bf16_f32 v184, v80, v81
    v_cvt_pk_bf16_f32 v185, v82, v83
    v_cvt_pk_bf16_f32 v186, v84, v85
    v_cvt_pk_bf16_f32 v187, v86, v87
    v_cvt_pk_bf16_f32 v188, v88, v89
    v_cvt_pk_bf16_f32 v189, v90, v91
    s_waitcnt lgkmcnt(0)
    s_barrier
    v_mfma_f32_16x16x32_bf16 v[168:171], v[144:147], v[186:189], 0
    v_mfma_f32_16x16x32_bf16 v[172:175], v[148:151], v[186:189], 0
    v_mfma_f32_16x16x32_bf16 v[176:179], v[152:155], v[186:189], 0
    v_mfma_f32_16x16x32_bf16 v[180:183], v[156:159], v[186:189], 0
    v_mfma_f32_16x16x16_bf16 v[168:171], v[160:161], v[184:185], v[168:171]
    v_mfma_f32_16x16x16_bf16 v[172:175], v[162:163], v[184:185], v[172:175]
    v_mfma_f32_16x16x16_bf16 v[176:179], v[164:165], v[184:185], v[176:179]
    v_mfma_f32_16x16x16_bf16 v[180:183], v[166:167], v[184:185], v[180:183]
    v_pk_add_f32 v[80:81], v[80:81], v[82:83]
    v_pk_add_f32 v[84:85], v[84:85], v[86:87]
    v_pk_add_f32 v[88:89], v[88:89], v[90:91]
    v_pk_add_f32 v[80:81], v[80:81], v[84:85]
    v_pk_add_f32 v[80:81], v[80:81], v[88:89]
    v_add_f32 v5, v80, v81
    v_mov_b32 v6, v5
    s_nop 1
    v_permlane32_swap_b32 v5, v6
    v_add_f32 v5, v5, v6
    v_mov_b32 v6, v5
    s_nop 1
    v_permlane16_swap_b32 v5, v6
    v_add_f32 v5, v5, v6
    v_rcp_f32 v20, v5
    s_nop 0
    v_pk_mul_f32 v[168:169], v[168:169], v[20:21] op_sel_hi:[1,0]
    v_pk_mul_f32 v[170:171], v[170:171], v[20:21] op_sel_hi:[1,0]
    v_pk_mul_f32 v[172:173], v[172:173], v[20:21] op_sel_hi:[1,0]
    v_pk_mul_f32 v[174:175], v[174:175], v[20:21] op_sel_hi:[1,0]
    v_cvt_pk_bf16_f32 v56, v168, v172
    v_cvt_pk_bf16_f32 v57, v169, v173
    v_cvt_pk_bf16_f32 v58, v170, v174
    v_cvt_pk_bf16_f32 v59, v171, v175
    global_store_dwordx4 v12, v[56:59], s[54:55] offset:0 sc1
    v_pk_mul_f32 v[176:177], v[176:177], v[20:21] op_sel_hi:[1,0]
    v_pk_mul_f32 v[178:179], v[178:179], v[20:21] op_sel_hi:[1,0]
    v_pk_mul_f32 v[180:181], v[180:181], v[20:21] op_sel_hi:[1,0]
    v_pk_mul_f32 v[182:183], v[182:183], v[20:21] op_sel_hi:[1,0]
    v_cvt_pk_bf16_f32 v60, v176, v180
    v_cvt_pk_bf16_f32 v61, v177, v181
    v_cvt_pk_bf16_f32 v62, v178, v182
    v_cvt_pk_bf16_f32 v63, v179, v183
    global_store_dwordx4 v12, v[60:63], s[54:55] offset:1024 sc1
    s_add_u32 s54, s54, 262144
    s_addc_u32 s55, s55, 0
    s_add_u32 s52, s52, 131072
    s_addc_u32 s53, s53, 0
    s_add_u32 s18, s18, 1
    s_cmp_ge_u32 s18, 64
    s_cbranch_scc1 L_s1_done
    s_add_u32 s30, s18, 1
    s_mov_b64 exec, 7
    v_cmp_gt_u32 vcc, s30, v19
    s_mov_b64 exec, -1
    s_cbranch_vccz L_kvok_66
    s_mov_b32 s27, 0
L_pfkv_67:
    s_mov_b64 exec, 7
    global_load_dword v5, v17, s[22:23] sc1
    s_waitcnt vmcnt(0)
    v_cmp_gt_u32 vcc, s30, v5
    s_mov_b64 exec, -1
    s_cbranch_vccz L_pfokv_68
    s_sleep 1
    s_add_u32 s27, s27, 1
    s_cmp_lt_u32 s27, 262144
    s_cbranch_scc1 L_pfkv_67
    s_branch L_timeout
L_pfokv_68:
L_kvok_66:
    s_xor_b32 s59, s59, 1
    s_lshl_b32 s10, s5, 12
    s_lshl_b32 s11, s59, 14
    s_add_u32 s10, s10, s11
    s_add_u32 m0, s10, 16384
    s_nop 0
    global_load_lds_dwordx4 v13, s[50:51] offset:0 sc1
    global_load_lds_dwordx4 v13, s[50:51] offset:1024 sc1
    global_load_lds_dwordx4 v13, s[50:51] offset:2048 sc1
    global_load_lds_dwordx4 v13, s[50:51] offset:3072 sc1
    s_lshl_b32 s10, s5, 11
    s_lshl_b32 s11, s59, 13
    s_add_u32 s10, s10, s11
    s_add_u32 m0, s10, 0
    s_nop 0
    global_load_lds_dwordx4 v16, s[56:57] offset:0 sc1
    global_load_lds_dwordx4 v16, s[56:57] offset:1024 sc1
    s_add_u32 s50, s50, 524288
    s_addc_u32 s51, s51, 0
    s_add_u32 s56, s56, 262144
    s_addc_u32 s57, s57, 0
    v_xor_b32 v7, 8192, v7
    s_lshl_b32 s10, s59, 14
    v_add_u32 v8, 16384, v1
    v_add_u32 v8, s10, v8
    s_lshr_b32 s11, s5, 1
    s_lshl_b32 s11, s11, 12
    s_add_u32 s10, s10, s11
    s_add_u32 s10, s10, 24576
    v_add_u32 v9, s10, v1
    s_waitcnt vmcnt(6)
    s_barrier
    s_mov_b32 s30, s18
    s_cmp_eq_u32 s5, 0
    s_cbranch_scc0 L_fl_69
    v_mov_b32 v5, s58
    v_mov_b32 v6, s30
    s_mov_b64 exec, 1
    global_store_dword v5, v6, s[22:23] sc1
    s_mov_b64 exec, -1
L_fl_69:
    s_branch L_s1_loop
L_s1_done:
    s_waitcnt vmcnt(0)
    s_barrier
    s_mov_b32 s30, 64
    s_cmp_eq_u32 s5, 0
    s_cbranch_scc0 L_fl_70
    v_mov_b32 v5, s58
    v_mov_b32 v6, s30
    s_mov_b64 exec, 1
    global_store_dword v5, v6, s[22:23] sc1
    s_mov_b64 exec, -1
L_fl_70:
    s_waitcnt vmcnt(0)
    s_endpgm
L_s2:
    s_add_u32 s22, s8, 5767168
    s_addc_u32 s23, s9, 0
    s_waitcnt vmcnt(0)
    s_barrier
    s_cmp_eq_u32 s5, 0
    s_cbranch_scc0 L_si_71
    s_lshl_b32 s10, s3, 5
    s_add_u32 s10, s10, 4
    v_mov_b32 v5, s10
    v_mov_b32 v6, 1
    s_mov_b64 exec, 1
    global_atomic_add v5, v6, s[6:7]
    s_mov_b64 exec, -1
L_si_71:
    s_lshl_b32 s30, s39, 6
    s_mul_i32 s31, s5, 1310720
    s_add_u32 s30, s30, s31
    s_load_dwordx2 s[10:11], s[0:1], 40
    v_and_b32 v201, 15, v0
    v_lshrrev_b32 v202, 4, v0
    v_lshlrev_b32 v202, 3, v202
    s_mov_b32 s12, 1280
    v_mul_lo_u32 v200, v202, s12
    v_lshl_add_u32 v200, v201, 2, v200
    v_add_u32 v200, s30, v200
    s_mov_b32 s24, 0x05040100
    s_mov_b32 s25, 0x07060302
    s_waitcnt lgkmcnt(0)
    s_mov_b32 s76, s10
    s_and_b32 s77, s11, 0xffff
    s_mov_b32 s78, 5242880
    s_mov_b32 s79, 0x20000
    s_mov_b32 s10, 0
    buffer_load_dword v64, v200, s[76:79], s10 offen
    s_mov_b32 s11, 1280
    buffer_load_dword v65, v200, s[76:79], s11 offen
    s_mov_b32 s10, 2560
    buffer_load_dword v66, v200, s[76:79], s10 offen
    s_mov_b32 s11, 3840
    buffer_load_dword v67, v200, s[76:79], s11 offen
    s_mov_b32 s10, 5120
    buffer_load_dword v68, v200, s[76:79], s10 offen
    s_mov_b32 s11, 6400
    buffer_load_dword v69, v200, s[76:79], s11 offen
    s_mov_b32 s10, 7680
    buffer_load_dword v70, v200, s[76:79], s10 offen
    s_mov_b32 s11, 8960
    buffer_load_dword v71, v200, s[76:79], s11 offen
    s_mov_b32 s10, 40960
    buffer_load_dword v72, v200, s[76:79], s10 offen
    s_mov_b32 s11, 42240
    buffer_load_dword v73, v200, s[76:79], s11 offen
    s_mov_b32 s10, 43520
    buffer_load_dword v74, v200, s[76:79], s10 offen
    s_mov_b32 s11, 44800
    buffer_load_dword v75, v200, s[76:79], s11 offen
    s_mov_b32 s10, 46080
    buffer_load_dword v76, v200, s[76:79], s10 offen
    s_mov_b32 s11, 47360
    buffer_load_dword v77, v200, s[76:79], s11 offen
    s_mov_b32 s10, 48640
    buffer_load_dword v78, v200, s[76:79], s10 offen
    s_mov_b32 s11, 49920
    buffer_load_dword v79, v200, s[76:79], s11 offen
    s_mov_b32 s10, 81920
    buffer_load_dword v96, v200, s[76:79], s10 offen
    s_mov_b32 s11, 83200
    buffer_load_dword v97, v200, s[76:79], s11 offen
    s_mov_b32 s10, 84480
    buffer_load_dword v98, v200, s[76:79], s10 offen
    s_mov_b32 s11, 85760
    buffer_load_dword v99, v200, s[76:79], s11 offen
    s_mov_b32 s10, 87040
    buffer_load_dword v100, v200, s[76:79], s10 offen
    s_mov_b32 s11, 88320
    buffer_load_dword v101, v200, s[76:79], s11 offen
    s_mov_b32 s10, 89600
    buffer_load_dword v102, v200, s[76:79], s10 offen
    s_mov_b32 s11, 90880
    buffer_load_dword v103, v200, s[76:79], s11 offen
    s_mov_b32 s10, 122880
    buffer_load_dword v104, v200, s[76:79], s10 offen
    s_mov_b32 s11, 124160
    buffer_load_dword v105, v200, s[76:79], s11 offen
    s_mov_b32 s10, 125440
    buffer_load_dword v106, v200, s[76:79], s10 offen
    s_mov_b32 s11, 126720
    buffer_load_dword v107, v200, s[76:79], s11 offen
    s_mov_b32 s10, 128000
    buffer_load_dword v108, v200, s[76:79], s10 offen
    s_mov_b32 s11, 129280
    buffer_load_dword v109, v200, s[76:79], s11 offen
    s_mov_b32 s10, 130560
    buffer_load_dword v110, v200, s[76:79], s10 offen
    s_mov_b32 s11, 131840
    buffer_load_dword v111, v200, s[76:79], s11 offen
    s_mov_b32 s10, 163840
    buffer_load_dword v128, v200, s[76:79], s10 offen
    s_mov_b32 s11, 165120
    buffer_load_dword v129, v200, s[76:79], s11 offen
    s_mov_b32 s10, 166400
    buffer_load_dword v130, v200, s[76:79], s10 offen
    s_mov_b32 s11, 167680
    buffer_load_dword v131, v200, s[76:79], s11 offen
    s_mov_b32 s10, 168960
    buffer_load_dword v132, v200, s[76:79], s10 offen
    s_mov_b32 s11, 170240
    buffer_load_dword v133, v200, s[76:79], s11 offen
    s_mov_b32 s10, 171520
    buffer_load_dword v134, v200, s[76:79], s10 offen
    s_mov_b32 s11, 172800
    buffer_load_dword v135, v200, s[76:79], s11 offen
    s_mov_b32 s10, 204800
    buffer_load_dword v136, v200, s[76:79], s10 offen
    s_mov_b32 s11, 206080
    buffer_load_dword v137, v200, s[76:79], s11 offen
    s_mov_b32 s10, 207360
    buffer_load_dword v138, v200, s[76:79], s10 offen
    s_mov_b32 s11, 208640
    buffer_load_dword v139, v200, s[76:79], s11 offen
    s_mov_b32 s10, 209920
    buffer_load_dword v140, v200, s[76:79], s10 offen
    s_mov_b32 s11, 211200
    buffer_load_dword v141, v200, s[76:79], s11 offen
    s_mov_b32 s10, 212480
    buffer_load_dword v142, v200, s[76:79], s10 offen
    s_mov_b32 s11, 213760
    buffer_load_dword v143, v200, s[76:79], s11 offen
    s_waitcnt vmcnt(32)
    v_perm_b32 v203, v65, v64, s24
    v_accvgpr_write_b32 a0, v203
    v_perm_b32 v204, v67, v66, s24
    v_accvgpr_write_b32 a1, v204
    v_perm_b32 v203, v69, v68, s24
    v_accvgpr_write_b32 a2, v203
    v_perm_b32 v204, v71, v70, s24
    v_accvgpr_write_b32 a3, v204
    v_perm_b32 v203, v65, v64, s25
    v_accvgpr_write_b32 a4, v203
    v_perm_b32 v204, v67, v66, s25
    v_accvgpr_write_b32 a5, v204
    v_perm_b32 v203, v69, v68, s25
    v_accvgpr_write_b32 a6, v203
    v_perm_b32 v204, v71, v70, s25
    v_accvgpr_write_b32 a7, v204
    v_perm_b32 v203, v73, v72, s24
    v_accvgpr_write_b32 a8, v203
    v_perm_b32 v204, v75, v74, s24
    v_accvgpr_write_b32 a9, v204
    v_perm_b32 v203, v77, v76, s24
    v_accvgpr_write_b32 a10, v203
    v_perm_b32 v204, v79, v78, s24
    v_accvgpr_write_b32 a11, v204
    v_perm_b32 v203, v73, v72, s25
    v_accvgpr_write_b32 a12, v203
    v_perm_b32 v204, v75, v74, s25
    v_accvgpr_write_b32 a13, v204
    v_perm_b32 v203, v77, v76, s25
    v_accvgpr_write_b32 a14, v203
    v_perm_b32 v204, v79, v78, s25
    v_accvgpr_write_b32 a15, v204
    s_mov_b32 s10, 245760
    buffer_load_dword v64, v200, s[76:79], s10 offen
    s_mov_b32 s11, 247040
    buffer_load_dword v65, v200, s[76:79], s11 offen
    s_mov_b32 s10, 248320
    buffer_load_dword v66, v200, s[76:79], s10 offen
    s_mov_b32 s11, 249600
    buffer_load_dword v67, v200, s[76:79], s11 offen
    s_mov_b32 s10, 250880
    buffer_load_dword v68, v200, s[76:79], s10 offen
    s_mov_b32 s11, 252160
    buffer_load_dword v69, v200, s[76:79], s11 offen
    s_mov_b32 s10, 253440
    buffer_load_dword v70, v200, s[76:79], s10 offen
    s_mov_b32 s11, 254720
    buffer_load_dword v71, v200, s[76:79], s11 offen
    s_mov_b32 s10, 286720
    buffer_load_dword v72, v200, s[76:79], s10 offen
    s_mov_b32 s11, 288000
    buffer_load_dword v73, v200, s[76:79], s11 offen
    s_mov_b32 s10, 289280
    buffer_load_dword v74, v200, s[76:79], s10 offen
    s_mov_b32 s11, 290560
    buffer_load_dword v75, v200, s[76:79], s11 offen
    s_mov_b32 s10, 291840
    buffer_load_dword v76, v200, s[76:79], s10 offen
    s_mov_b32 s11, 293120
    buffer_load_dword v77, v200, s[76:79], s11 offen
    s_mov_b32 s10, 294400
    buffer_load_dword v78, v200, s[76:79], s10 offen
    s_mov_b32 s11, 295680
    buffer_load_dword v79, v200, s[76:79], s11 offen
    s_waitcnt vmcnt(32)
    v_perm_b32 v203, v97, v96, s24
    v_accvgpr_write_b32 a16, v203
    v_perm_b32 v204, v99, v98, s24
    v_accvgpr_write_b32 a17, v204
    v_perm_b32 v203, v101, v100, s24
    v_accvgpr_write_b32 a18, v203
    v_perm_b32 v204, v103, v102, s24
    v_accvgpr_write_b32 a19, v204
    v_perm_b32 v203, v97, v96, s25
    v_accvgpr_write_b32 a20, v203
    v_perm_b32 v204, v99, v98, s25
    v_accvgpr_write_b32 a21, v204
    v_perm_b32 v203, v101, v100, s25
    v_accvgpr_write_b32 a22, v203
    v_perm_b32 v204, v103, v102, s25
    v_accvgpr_write_b32 a23, v204
    v_perm_b32 v203, v105, v104, s24
    v_accvgpr_write_b32 a24, v203
    v_perm_b32 v204, v107, v106, s24
    v_accvgpr_write_b32 a25, v204
    v_perm_b32 v203, v109, v108, s24
    v_accvgpr_write_b32 a26, v203
    v_perm_b32 v204, v111, v110, s24
    v_accvgpr_write_b32 a27, v204
    v_perm_b32 v203, v105, v104, s25
    v_accvgpr_write_b32 a28, v203
    v_perm_b32 v204, v107, v106, s25
    v_accvgpr_write_b32 a29, v204
    v_perm_b32 v203, v109, v108, s25
    v_accvgpr_write_b32 a30, v203
    v_perm_b32 v204, v111, v110, s25
    v_accvgpr_write_b32 a31, v204
    s_mov_b32 s10, 327680
    buffer_load_dword v96, v200, s[76:79], s10 offen
    s_mov_b32 s11, 328960
    buffer_load_dword v97, v200, s[76:79], s11 offen
    s_mov_b32 s10, 330240
    buffer_load_dword v98, v200, s[76:79], s10 offen
    s_mov_b32 s11, 331520
    buffer_load_dword v99, v200, s[76:79], s11 offen
    s_mov_b32 s10, 332800
    buffer_load_dword v100, v200, s[76:79], s10 offen
    s_mov_b32 s11, 334080
    buffer_load_dword v101, v200, s[76:79], s11 offen
    s_mov_b32 s10, 335360
    buffer_load_dword v102, v200, s[76:79], s10 offen
    s_mov_b32 s11, 336640
    buffer_load_dword v103, v200, s[76:79], s11 offen
    s_mov_b32 s10, 368640
    buffer_load_dword v104, v200, s[76:79], s10 offen
    s_mov_b32 s11, 369920
    buffer_load_dword v105, v200, s[76:79], s11 offen
    s_mov_b32 s10, 371200
    buffer_load_dword v106, v200, s[76:79], s10 offen
    s_mov_b32 s11, 372480
    buffer_load_dword v107, v200, s[76:79], s11 offen
    s_mov_b32 s10, 373760
    buffer_load_dword v108, v200, s[76:79], s10 offen
    s_mov_b32 s11, 375040
    buffer_load_dword v109, v200, s[76:79], s11 offen
    s_mov_b32 s10, 376320
    buffer_load_dword v110, v200, s[76:79], s10 offen
    s_mov_b32 s11, 377600
    buffer_load_dword v111, v200, s[76:79], s11 offen
    s_waitcnt vmcnt(32)
    v_perm_b32 v203, v129, v128, s24
    v_accvgpr_write_b32 a32, v203
    v_perm_b32 v204, v131, v130, s24
    v_accvgpr_write_b32 a33, v204
    v_perm_b32 v203, v133, v132, s24
    v_accvgpr_write_b32 a34, v203
    v_perm_b32 v204, v135, v134, s24
    v_accvgpr_write_b32 a35, v204
    v_perm_b32 v203, v129, v128, s25
    v_accvgpr_write_b32 a36, v203
    v_perm_b32 v204, v131, v130, s25
    v_accvgpr_write_b32 a37, v204
    v_perm_b32 v203, v133, v132, s25
    v_accvgpr_write_b32 a38, v203
    v_perm_b32 v204, v135, v134, s25
    v_accvgpr_write_b32 a39, v204
    v_perm_b32 v203, v137, v136, s24
    v_accvgpr_write_b32 a40, v203
    v_perm_b32 v204, v139, v138, s24
    v_accvgpr_write_b32 a41, v204
    v_perm_b32 v203, v141, v140, s24
    v_accvgpr_write_b32 a42, v203
    v_perm_b32 v204, v143, v142, s24
    v_accvgpr_write_b32 a43, v204
    v_perm_b32 v203, v137, v136, s25
    v_accvgpr_write_b32 a44, v203
    v_perm_b32 v204, v139, v138, s25
    v_accvgpr_write_b32 a45, v204
    v_perm_b32 v203, v141, v140, s25
    v_accvgpr_write_b32 a46, v203
    v_perm_b32 v204, v143, v142, s25
    v_accvgpr_write_b32 a47, v204
    s_mov_b32 s10, 409600
    buffer_load_dword v128, v200, s[76:79], s10 offen
    s_mov_b32 s11, 410880
    buffer_load_dword v129, v200, s[76:79], s11 offen
    s_mov_b32 s10, 412160
    buffer_load_dword v130, v200, s[76:79], s10 offen
    s_mov_b32 s11, 413440
    buffer_load_dword v131, v200, s[76:79], s11 offen
    s_mov_b32 s10, 414720
    buffer_load_dword v132, v200, s[76:79], s10 offen
    s_mov_b32 s11, 416000
    buffer_load_dword v133, v200, s[76:79], s11 offen
    s_mov_b32 s10, 417280
    buffer_load_dword v134, v200, s[76:79], s10 offen
    s_mov_b32 s11, 418560
    buffer_load_dword v135, v200, s[76:79], s11 offen
    s_mov_b32 s10, 450560
    buffer_load_dword v136, v200, s[76:79], s10 offen
    s_mov_b32 s11, 451840
    buffer_load_dword v137, v200, s[76:79], s11 offen
    s_mov_b32 s10, 453120
    buffer_load_dword v138, v200, s[76:79], s10 offen
    s_mov_b32 s11, 454400
    buffer_load_dword v139, v200, s[76:79], s11 offen
    s_mov_b32 s10, 455680
    buffer_load_dword v140, v200, s[76:79], s10 offen
    s_mov_b32 s11, 456960
    buffer_load_dword v141, v200, s[76:79], s11 offen
    s_mov_b32 s10, 458240
    buffer_load_dword v142, v200, s[76:79], s10 offen
    s_mov_b32 s11, 459520
    buffer_load_dword v143, v200, s[76:79], s11 offen
    s_waitcnt vmcnt(32)
    v_perm_b32 v203, v65, v64, s24
    v_accvgpr_write_b32 a48, v203
    v_perm_b32 v204, v67, v66, s24
    v_accvgpr_write_b32 a49, v204
    v_perm_b32 v203, v69, v68, s24
    v_accvgpr_write_b32 a50, v203
    v_perm_b32 v204, v71, v70, s24
    v_accvgpr_write_b32 a51, v204
    v_perm_b32 v203, v65, v64, s25
    v_accvgpr_write_b32 a52, v203
    v_perm_b32 v204, v67, v66, s25
    v_accvgpr_write_b32 a53, v204
    v_perm_b32 v203, v69, v68, s25
    v_accvgpr_write_b32 a54, v203
    v_perm_b32 v204, v71, v70, s25
    v_accvgpr_write_b32 a55, v204
    v_perm_b32 v203, v73, v72, s24
    v_accvgpr_write_b32 a56, v203
    v_perm_b32 v204, v75, v74, s24
    v_accvgpr_write_b32 a57, v204
    v_perm_b32 v203, v77, v76, s24
    v_accvgpr_write_b32 a58, v203
    v_perm_b32 v204, v79, v78, s24
    v_accvgpr_write_b32 a59, v204
    v_perm_b32 v203, v73, v72, s25
    v_accvgpr_write_b32 a60, v203
    v_perm_b32 v204, v75, v74, s25
    v_accvgpr_write_b32 a61, v204
    v_perm_b32 v203, v77, v76, s25
    v_accvgpr_write_b32 a62, v203
    v_perm_b32 v204, v79, v78, s25
    v_accvgpr_write_b32 a63, v204
    s_mov_b32 s10, 491520
    buffer_load_dword v64, v200, s[76:79], s10 offen
    s_mov_b32 s11, 492800
    buffer_load_dword v65, v200, s[76:79], s11 offen
    s_mov_b32 s10, 494080
    buffer_load_dword v66, v200, s[76:79], s10 offen
    s_mov_b32 s11, 495360
    buffer_load_dword v67, v200, s[76:79], s11 offen
    s_mov_b32 s10, 496640
    buffer_load_dword v68, v200, s[76:79], s10 offen
    s_mov_b32 s11, 497920
    buffer_load_dword v69, v200, s[76:79], s11 offen
    s_mov_b32 s10, 499200
    buffer_load_dword v70, v200, s[76:79], s10 offen
    s_mov_b32 s11, 500480
    buffer_load_dword v71, v200, s[76:79], s11 offen
    s_mov_b32 s10, 532480
    buffer_load_dword v72, v200, s[76:79], s10 offen
    s_mov_b32 s11, 533760
    buffer_load_dword v73, v200, s[76:79], s11 offen
    s_mov_b32 s10, 535040
    buffer_load_dword v74, v200, s[76:79], s10 offen
    s_mov_b32 s11, 536320
    buffer_load_dword v75, v200, s[76:79], s11 offen
    s_mov_b32 s10, 537600
    buffer_load_dword v76, v200, s[76:79], s10 offen
    s_mov_b32 s11, 538880
    buffer_load_dword v77, v200, s[76:79], s11 offen
    s_mov_b32 s10, 540160
    buffer_load_dword v78, v200, s[76:79], s10 offen
    s_mov_b32 s11, 541440
    buffer_load_dword v79, v200, s[76:79], s11 offen
    s_waitcnt vmcnt(32)
    v_perm_b32 v203, v97, v96, s24
    v_accvgpr_write_b32 a64, v203
    v_perm_b32 v204, v99, v98, s24
    v_accvgpr_write_b32 a65, v204
    v_perm_b32 v203, v101, v100, s24
    v_accvgpr_write_b32 a66, v203
    v_perm_b32 v204, v103, v102, s24
    v_accvgpr_write_b32 a67, v204
    v_perm_b32 v203, v97, v96, s25
    v_accvgpr_write_b32 a68, v203
    v_perm_b32 v204, v99, v98, s25
    v_accvgpr_write_b32 a69, v204
    v_perm_b32 v203, v101, v100, s25
    v_accvgpr_write_b32 a70, v203
    v_perm_b32 v204, v103, v102, s25
    v_accvgpr_write_b32 a71, v204
    v_perm_b32 v203, v105, v104, s24
    v_accvgpr_write_b32 a72, v203
    v_perm_b32 v204, v107, v106, s24
    v_accvgpr_write_b32 a73, v204
    v_perm_b32 v203, v109, v108, s24
    v_accvgpr_write_b32 a74, v203
    v_perm_b32 v204, v111, v110, s24
    v_accvgpr_write_b32 a75, v204
    v_perm_b32 v203, v105, v104, s25
    v_accvgpr_write_b32 a76, v203
    v_perm_b32 v204, v107, v106, s25
    v_accvgpr_write_b32 a77, v204
    v_perm_b32 v203, v109, v108, s25
    v_accvgpr_write_b32 a78, v203
    v_perm_b32 v204, v111, v110, s25
    v_accvgpr_write_b32 a79, v204
    s_mov_b32 s10, 573440
    buffer_load_dword v96, v200, s[76:79], s10 offen
    s_mov_b32 s11, 574720
    buffer_load_dword v97, v200, s[76:79], s11 offen
    s_mov_b32 s10, 576000
    buffer_load_dword v98, v200, s[76:79], s10 offen
    s_mov_b32 s11, 577280
    buffer_load_dword v99, v200, s[76:79], s11 offen
    s_mov_b32 s10, 578560
    buffer_load_dword v100, v200, s[76:79], s10 offen
    s_mov_b32 s11, 579840
    buffer_load_dword v101, v200, s[76:79], s11 offen
    s_mov_b32 s10, 581120
    buffer_load_dword v102, v200, s[76:79], s10 offen
    s_mov_b32 s11, 582400
    buffer_load_dword v103, v200, s[76:79], s11 offen
    s_mov_b32 s10, 614400
    buffer_load_dword v104, v200, s[76:79], s10 offen
    s_mov_b32 s11, 615680
    buffer_load_dword v105, v200, s[76:79], s11 offen
    s_mov_b32 s10, 616960
    buffer_load_dword v106, v200, s[76:79], s10 offen
    s_mov_b32 s11, 618240
    buffer_load_dword v107, v200, s[76:79], s11 offen
    s_mov_b32 s10, 619520
    buffer_load_dword v108, v200, s[76:79], s10 offen
    s_mov_b32 s11, 620800
    buffer_load_dword v109, v200, s[76:79], s11 offen
    s_mov_b32 s10, 622080
    buffer_load_dword v110, v200, s[76:79], s10 offen
    s_mov_b32 s11, 623360
    buffer_load_dword v111, v200, s[76:79], s11 offen
    s_waitcnt vmcnt(32)
    v_perm_b32 v203, v129, v128, s24
    v_accvgpr_write_b32 a80, v203
    v_perm_b32 v204, v131, v130, s24
    v_accvgpr_write_b32 a81, v204
    v_perm_b32 v203, v133, v132, s24
    v_accvgpr_write_b32 a82, v203
    v_perm_b32 v204, v135, v134, s24
    v_accvgpr_write_b32 a83, v204
    v_perm_b32 v203, v129, v128, s25
    v_accvgpr_write_b32 a84, v203
    v_perm_b32 v204, v131, v130, s25
    v_accvgpr_write_b32 a85, v204
    v_perm_b32 v203, v133, v132, s25
    v_accvgpr_write_b32 a86, v203
    v_perm_b32 v204, v135, v134, s25
    v_accvgpr_write_b32 a87, v204
    v_perm_b32 v203, v137, v136, s24
    v_accvgpr_write_b32 a88, v203
    v_perm_b32 v204, v139, v138, s24
    v_accvgpr_write_b32 a89, v204
    v_perm_b32 v203, v141, v140, s24
    v_accvgpr_write_b32 a90, v203
    v_perm_b32 v204, v143, v142, s24
    v_accvgpr_write_b32 a91, v204
    v_perm_b32 v203, v137, v136, s25
    v_accvgpr_write_b32 a92, v203
    v_perm_b32 v204, v139, v138, s25
    v_accvgpr_write_b32 a93, v204
    v_perm_b32 v203, v141, v140, s25
    v_accvgpr_write_b32 a94, v203
    v_perm_b32 v204, v143, v142, s25
    v_accvgpr_write_b32 a95, v204
    s_mov_b32 s10, 655360
    buffer_load_dword v128, v200, s[76:79], s10 offen
    s_mov_b32 s11, 656640
    buffer_load_dword v129, v200, s[76:79], s11 offen
    s_mov_b32 s10, 657920
    buffer_load_dword v130, v200, s[76:79], s10 offen
    s_mov_b32 s11, 659200
    buffer_load_dword v131, v200, s[76:79], s11 offen
    s_mov_b32 s10, 660480
    buffer_load_dword v132, v200, s[76:79], s10 offen
    s_mov_b32 s11, 661760
    buffer_load_dword v133, v200, s[76:79], s11 offen
    s_mov_b32 s10, 663040
    buffer_load_dword v134, v200, s[76:79], s10 offen
    s_mov_b32 s11, 664320
    buffer_load_dword v135, v200, s[76:79], s11 offen
    s_mov_b32 s10, 696320
    buffer_load_dword v136, v200, s[76:79], s10 offen
    s_mov_b32 s11, 697600
    buffer_load_dword v137, v200, s[76:79], s11 offen
    s_mov_b32 s10, 698880
    buffer_load_dword v138, v200, s[76:79], s10 offen
    s_mov_b32 s11, 700160
    buffer_load_dword v139, v200, s[76:79], s11 offen
    s_mov_b32 s10, 701440
    buffer_load_dword v140, v200, s[76:79], s10 offen
    s_mov_b32 s11, 702720
    buffer_load_dword v141, v200, s[76:79], s11 offen
    s_mov_b32 s10, 704000
    buffer_load_dword v142, v200, s[76:79], s10 offen
    s_mov_b32 s11, 705280
    buffer_load_dword v143, v200, s[76:79], s11 offen
    s_waitcnt vmcnt(32)
    v_perm_b32 v203, v65, v64, s24
    v_accvgpr_write_b32 a96, v203
    v_perm_b32 v204, v67, v66, s24
    v_accvgpr_write_b32 a97, v204
    v_perm_b32 v203, v69, v68, s24
    v_accvgpr_write_b32 a98, v203
    v_perm_b32 v204, v71, v70, s24
    v_accvgpr_write_b32 a99, v204
    v_perm_b32 v203, v65, v64, s25
    v_accvgpr_write_b32 a100, v203
    v_perm_b32 v204, v67, v66, s25
    v_accvgpr_write_b32 a101, v204
    v_perm_b32 v203, v69, v68, s25
    v_accvgpr_write_b32 a102, v203
    v_perm_b32 v204, v71, v70, s25
    v_accvgpr_write_b32 a103, v204
    v_perm_b32 v203, v73, v72, s24
    v_accvgpr_write_b32 a104, v203
    v_perm_b32 v204, v75, v74, s24
    v_accvgpr_write_b32 a105, v204
    v_perm_b32 v203, v77, v76, s24
    v_accvgpr_write_b32 a106, v203
    v_perm_b32 v204, v79, v78, s24
    v_accvgpr_write_b32 a107, v204
    v_perm_b32 v203, v73, v72, s25
    v_accvgpr_write_b32 a108, v203
    v_perm_b32 v204, v75, v74, s25
    v_accvgpr_write_b32 a109, v204
    v_perm_b32 v203, v77, v76, s25
    v_accvgpr_write_b32 a110, v203
    v_perm_b32 v204, v79, v78, s25
    v_accvgpr_write_b32 a111, v204
    s_mov_b32 s10, 737280
    buffer_load_dword v64, v200, s[76:79], s10 offen
    s_mov_b32 s11, 738560
    buffer_load_dword v65, v200, s[76:79], s11 offen
    s_mov_b32 s10, 739840
    buffer_load_dword v66, v200, s[76:79], s10 offen
    s_mov_b32 s11, 741120
    buffer_load_dword v67, v200, s[76:79], s11 offen
    s_mov_b32 s10, 742400
    buffer_load_dword v68, v200, s[76:79], s10 offen
    s_mov_b32 s11, 743680
    buffer_load_dword v69, v200, s[76:79], s11 offen
    s_mov_b32 s10, 744960
    buffer_load_dword v70, v200, s[76:79], s10 offen
    s_mov_b32 s11, 746240
    buffer_load_dword v71, v200, s[76:79], s11 offen
    s_mov_b32 s10, 778240
    buffer_load_dword v72, v200, s[76:79], s10 offen
    s_mov_b32 s11, 779520
    buffer_load_dword v73, v200, s[76:79], s11 offen
    s_mov_b32 s10, 780800
    buffer_load_dword v74, v200, s[76:79], s10 offen
    s_mov_b32 s11, 782080
    buffer_load_dword v75, v200, s[76:79], s11 offen
    s_mov_b32 s10, 783360
    buffer_load_dword v76, v200, s[76:79], s10 offen
    s_mov_b32 s11, 784640
    buffer_load_dword v77, v200, s[76:79], s11 offen
    s_mov_b32 s10, 785920
    buffer_load_dword v78, v200, s[76:79], s10 offen
    s_mov_b32 s11, 787200
    buffer_load_dword v79, v200, s[76:79], s11 offen
    s_waitcnt vmcnt(32)
    v_perm_b32 v203, v97, v96, s24
    v_accvgpr_write_b32 a112, v203
    v_perm_b32 v204, v99, v98, s24
    v_accvgpr_write_b32 a113, v204
    v_perm_b32 v203, v101, v100, s24
    v_accvgpr_write_b32 a114, v203
    v_perm_b32 v204, v103, v102, s24
    v_accvgpr_write_b32 a115, v204
    v_perm_b32 v203, v97, v96, s25
    v_accvgpr_write_b32 a116, v203
    v_perm_b32 v204, v99, v98, s25
    v_accvgpr_write_b32 a117, v204
    v_perm_b32 v203, v101, v100, s25
    v_accvgpr_write_b32 a118, v203
    v_perm_b32 v204, v103, v102, s25
    v_accvgpr_write_b32 a119, v204
    v_perm_b32 v203, v105, v104, s24
    v_accvgpr_write_b32 a120, v203
    v_perm_b32 v204, v107, v106, s24
    v_accvgpr_write_b32 a121, v204
    v_perm_b32 v203, v109, v108, s24
    v_accvgpr_write_b32 a122, v203
    v_perm_b32 v204, v111, v110, s24
    v_accvgpr_write_b32 a123, v204
    v_perm_b32 v203, v105, v104, s25
    v_accvgpr_write_b32 a124, v203
    v_perm_b32 v204, v107, v106, s25
    v_accvgpr_write_b32 a125, v204
    v_perm_b32 v203, v109, v108, s25
    v_accvgpr_write_b32 a126, v203
    v_perm_b32 v204, v111, v110, s25
    v_accvgpr_write_b32 a127, v204
    s_mov_b32 s10, 819200
    buffer_load_dword v96, v200, s[76:79], s10 offen
    s_mov_b32 s11, 820480
    buffer_load_dword v97, v200, s[76:79], s11 offen
    s_mov_b32 s10, 821760
    buffer_load_dword v98, v200, s[76:79], s10 offen
    s_mov_b32 s11, 823040
    buffer_load_dword v99, v200, s[76:79], s11 offen
    s_mov_b32 s10, 824320
    buffer_load_dword v100, v200, s[76:79], s10 offen
    s_mov_b32 s11, 825600
    buffer_load_dword v101, v200, s[76:79], s11 offen
    s_mov_b32 s10, 826880
    buffer_load_dword v102, v200, s[76:79], s10 offen
    s_mov_b32 s11, 828160
    buffer_load_dword v103, v200, s[76:79], s11 offen
    s_mov_b32 s10, 860160
    buffer_load_dword v104, v200, s[76:79], s10 offen
    s_mov_b32 s11, 861440
    buffer_load_dword v105, v200, s[76:79], s11 offen
    s_mov_b32 s10, 862720
    buffer_load_dword v106, v200, s[76:79], s10 offen
    s_mov_b32 s11, 864000
    buffer_load_dword v107, v200, s[76:79], s11 offen
    s_mov_b32 s10, 865280
    buffer_load_dword v108, v200, s[76:79], s10 offen
    s_mov_b32 s11, 866560
    buffer_load_dword v109, v200, s[76:79], s11 offen
    s_mov_b32 s10, 867840
    buffer_load_dword v110, v200, s[76:79], s10 offen
    s_mov_b32 s11, 869120
    buffer_load_dword v111, v200, s[76:79], s11 offen
    s_waitcnt vmcnt(32)
    v_perm_b32 v203, v129, v128, s24
    v_accvgpr_write_b32 a128, v203
    v_perm_b32 v204, v131, v130, s24
    v_accvgpr_write_b32 a129, v204
    v_perm_b32 v203, v133, v132, s24
    v_accvgpr_write_b32 a130, v203
    v_perm_b32 v204, v135, v134, s24
    v_accvgpr_write_b32 a131, v204
    v_perm_b32 v203, v129, v128, s25
    v_accvgpr_write_b32 a132, v203
    v_perm_b32 v204, v131, v130, s25
    v_accvgpr_write_b32 a133, v204
    v_perm_b32 v203, v133, v132, s25
    v_accvgpr_write_b32 a134, v203
    v_perm_b32 v204, v135, v134, s25
    v_accvgpr_write_b32 a135, v204
    v_perm_b32 v203, v137, v136, s24
    v_accvgpr_write_b32 a136, v203
    v_perm_b32 v204, v139, v138, s24
    v_accvgpr_write_b32 a137, v204
    v_perm_b32 v203, v141, v140, s24
    v_accvgpr_write_b32 a138, v203
    v_perm_b32 v204, v143, v142, s24
    v_accvgpr_write_b32 a139, v204
    v_perm_b32 v203, v137, v136, s25
    v_accvgpr_write_b32 a140, v203
    v_perm_b32 v204, v139, v138, s25
    v_accvgpr_write_b32 a141, v204
    v_perm_b32 v203, v141, v140, s25
    v_accvgpr_write_b32 a142, v203
    v_perm_b32 v204, v143, v142, s25
    v_accvgpr_write_b32 a143, v204
    s_mov_b32 s10, 901120
    buffer_load_dword v128, v200, s[76:79], s10 offen
    s_mov_b32 s11, 902400
    buffer_load_dword v129, v200, s[76:79], s11 offen
    s_mov_b32 s10, 903680
    buffer_load_dword v130, v200, s[76:79], s10 offen
    s_mov_b32 s11, 904960
    buffer_load_dword v131, v200, s[76:79], s11 offen
    s_mov_b32 s10, 906240
    buffer_load_dword v132, v200, s[76:79], s10 offen
    s_mov_b32 s11, 907520
    buffer_load_dword v133, v200, s[76:79], s11 offen
    s_mov_b32 s10, 908800
    buffer_load_dword v134, v200, s[76:79], s10 offen
    s_mov_b32 s11, 910080
    buffer_load_dword v135, v200, s[76:79], s11 offen
    s_mov_b32 s10, 942080
    buffer_load_dword v136, v200, s[76:79], s10 offen
    s_mov_b32 s11, 943360
    buffer_load_dword v137, v200, s[76:79], s11 offen
    s_mov_b32 s10, 944640
    buffer_load_dword v138, v200, s[76:79], s10 offen
    s_mov_b32 s11, 945920
    buffer_load_dword v139, v200, s[76:79], s11 offen
    s_mov_b32 s10, 947200
    buffer_load_dword v140, v200, s[76:79], s10 offen
    s_mov_b32 s11, 948480
    buffer_load_dword v141, v200, s[76:79], s11 offen
    s_mov_b32 s10, 949760
    buffer_load_dword v142, v200, s[76:79], s10 offen
    s_mov_b32 s11, 951040
    buffer_load_dword v143, v200, s[76:79], s11 offen
    s_waitcnt vmcnt(32)
    v_perm_b32 v203, v65, v64, s24
    v_accvgpr_write_b32 a144, v203
    v_perm_b32 v204, v67, v66, s24
    v_accvgpr_write_b32 a145, v204
    v_perm_b32 v203, v69, v68, s24
    v_accvgpr_write_b32 a146, v203
    v_perm_b32 v204, v71, v70, s24
    v_accvgpr_write_b32 a147, v204
    v_perm_b32 v203, v65, v64, s25
    v_accvgpr_write_b32 a148, v203
    v_perm_b32 v204, v67, v66, s25
    v_accvgpr_write_b32 a149, v204
    v_perm_b32 v203, v69, v68, s25
    v_accvgpr_write_b32 a150, v203
    v_perm_b32 v204, v71, v70, s25
    v_accvgpr_write_b32 a151, v204
    v_perm_b32 v203, v73, v72, s24
    v_accvgpr_write_b32 a152, v203
    v_perm_b32 v204, v75, v74, s24
    v_accvgpr_write_b32 a153, v204
    v_perm_b32 v203, v77, v76, s24
    v_accvgpr_write_b32 a154, v203
    v_perm_b32 v204, v79, v78, s24
    v_accvgpr_write_b32 a155, v204
    v_perm_b32 v203, v73, v72, s25
    v_accvgpr_write_b32 a156, v203
    v_perm_b32 v204, v75, v74, s25
    v_accvgpr_write_b32 a157, v204
    v_perm_b32 v203, v77, v76, s25
    v_accvgpr_write_b32 a158, v203
    v_perm_b32 v204, v79, v78, s25
    v_accvgpr_write_b32 a159, v204
    s_mov_b32 s10, 983040
    buffer_load_dword v64, v200, s[76:79], s10 offen
    s_mov_b32 s11, 984320
    buffer_load_dword v65, v200, s[76:79], s11 offen
    s_mov_b32 s10, 985600
    buffer_load_dword v66, v200, s[76:79], s10 offen
    s_mov_b32 s11, 986880
    buffer_load_dword v67, v200, s[76:79], s11 offen
    s_mov_b32 s10, 988160
    buffer_load_dword v68, v200, s[76:79], s10 offen
    s_mov_b32 s11, 989440
    buffer_load_dword v69, v200, s[76:79], s11 offen
    s_mov_b32 s10, 990720
    buffer_load_dword v70, v200, s[76:79], s10 offen
    s_mov_b32 s11, 992000
    buffer_load_dword v71, v200, s[76:79], s11 offen
    s_mov_b32 s10, 1024000
    buffer_load_dword v72, v200, s[76:79], s10 offen
    s_mov_b32 s11, 1025280
    buffer_load_dword v73, v200, s[76:79], s11 offen
    s_mov_b32 s10, 1026560
    buffer_load_dword v74, v200, s[76:79], s10 offen
    s_mov_b32 s11, 1027840
    buffer_load_dword v75, v200, s[76:79], s11 offen
    s_mov_b32 s10, 1029120
    buffer_load_dword v76, v200, s[76:79], s10 offen
    s_mov_b32 s11, 1030400
    buffer_load_dword v77, v200, s[76:79], s11 offen
    s_mov_b32 s10, 1031680
    buffer_load_dword v78, v200, s[76:79], s10 offen
    s_mov_b32 s11, 1032960
    buffer_load_dword v79, v200, s[76:79], s11 offen
    s_waitcnt vmcnt(32)
    v_perm_b32 v203, v97, v96, s24
    v_accvgpr_write_b32 a160, v203
    v_perm_b32 v204, v99, v98, s24
    v_accvgpr_write_b32 a161, v204
    v_perm_b32 v203, v101, v100, s24
    v_accvgpr_write_b32 a162, v203
    v_perm_b32 v204, v103, v102, s24
    v_accvgpr_write_b32 a163, v204
    v_perm_b32 v203, v97, v96, s25
    v_accvgpr_write_b32 a164, v203
    v_perm_b32 v204, v99, v98, s25
    v_accvgpr_write_b32 a165, v204
    v_perm_b32 v203, v101, v100, s25
    v_accvgpr_write_b32 a166, v203
    v_perm_b32 v204, v103, v102, s25
    v_accvgpr_write_b32 a167, v204
    v_perm_b32 v203, v105, v104, s24
    v_accvgpr_write_b32 a168, v203
    v_perm_b32 v204, v107, v106, s24
    v_accvgpr_write_b32 a169, v204
    v_perm_b32 v203, v109, v108, s24
    v_accvgpr_write_b32 a170, v203
    v_perm_b32 v204, v111, v110, s24
    v_accvgpr_write_b32 a171, v204
    v_perm_b32 v203, v105, v104, s25
    v_accvgpr_write_b32 a172, v203
    v_perm_b32 v204, v107, v106, s25
    v_accvgpr_write_b32 a173, v204
    v_perm_b32 v203, v109, v108, s25
    v_accvgpr_write_b32 a174, v203
    v_perm_b32 v204, v111, v110, s25
    v_accvgpr_write_b32 a175, v204
    s_mov_b32 s10, 1064960
    buffer_load_dword v96, v200, s[76:79], s10 offen
    s_mov_b32 s11, 1066240
    buffer_load_dword v97, v200, s[76:79], s11 offen
    s_mov_b32 s10, 1067520
    buffer_load_dword v98, v200, s[76:79], s10 offen
    s_mov_b32 s11, 1068800
    buffer_load_dword v99, v200, s[76:79], s11 offen
    s_mov_b32 s10, 1070080
    buffer_load_dword v100, v200, s[76:79], s10 offen
    s_mov_b32 s11, 1071360
    buffer_load_dword v101, v200, s[76:79], s11 offen
    s_mov_b32 s10, 1072640
    buffer_load_dword v102, v200, s[76:79], s10 offen
    s_mov_b32 s11, 1073920
    buffer_load_dword v103, v200, s[76:79], s11 offen
    s_mov_b32 s10, 1105920
    buffer_load_dword v104, v200, s[76:79], s10 offen
    s_mov_b32 s11, 1107200
    buffer_load_dword v105, v200, s[76:79], s11 offen
    s_mov_b32 s10, 1108480
    buffer_load_dword v106, v200, s[76:79], s10 offen
    s_mov_b32 s11, 1109760
    buffer_load_dword v107, v200, s[76:79], s11 offen
    s_mov_b32 s10, 1111040
    buffer_load_dword v108, v200, s[76:79], s10 offen
    s_mov_b32 s11, 1112320
    buffer_load_dword v109, v200, s[76:79], s11 offen
    s_mov_b32 s10, 1113600
    buffer_load_dword v110, v200, s[76:79], s10 offen
    s_mov_b32 s11, 1114880
    buffer_load_dword v111, v200, s[76:79], s11 offen
    s_waitcnt vmcnt(32)
    v_perm_b32 v203, v129, v128, s24
    v_accvgpr_write_b32 a176, v203
    v_perm_b32 v204, v131, v130, s24
    v_accvgpr_write_b32 a177, v204
    v_perm_b32 v203, v133, v132, s24
    v_accvgpr_write_b32 a178, v203
    v_perm_b32 v204, v135, v134, s24
    v_accvgpr_write_b32 a179, v204
    v_perm_b32 v203, v129, v128, s25
    v_accvgpr_write_b32 a180, v203
    v_perm_b32 v204, v131, v130, s25
    v_accvgpr_write_b32 a181, v204
    v_perm_b32 v203, v133, v132, s25
    v_accvgpr_write_b32 a182, v203
    v_perm_b32 v204, v135, v134, s25
    v_accvgpr_write_b32 a183, v204
    v_perm_b32 v203, v137, v136, s24
    v_accvgpr_write_b32 a184, v203
    v_perm_b32 v204, v139, v138, s24
    v_accvgpr_write_b32 a185, v204
    v_perm_b32 v203, v141, v140, s24
    v_accvgpr_write_b32 a186, v203
    v_perm_b32 v204, v143, v142, s24
    v_accvgpr_write_b32 a187, v204
    v_perm_b32 v203, v137, v136, s25
    v_accvgpr_write_b32 a188, v203
    v_perm_b32 v204, v139, v138, s25
    v_accvgpr_write_b32 a189, v204
    v_perm_b32 v203, v141, v140, s25
    v_accvgpr_write_b32 a190, v203
    v_perm_b32 v204, v143, v142, s25
    v_accvgpr_write_b32 a191, v204
    s_mov_b32 s10, 1146880
    buffer_load_dword v128, v200, s[76:79], s10 offen
    s_mov_b32 s11, 1148160
    buffer_load_dword v129, v200, s[76:79], s11 offen
    s_mov_b32 s10, 1149440
    buffer_load_dword v130, v200, s[76:79], s10 offen
    s_mov_b32 s11, 1150720
    buffer_load_dword v131, v200, s[76:79], s11 offen
    s_mov_b32 s10, 1152000
    buffer_load_dword v132, v200, s[76:79], s10 offen
    s_mov_b32 s11, 1153280
    buffer_load_dword v133, v200, s[76:79], s11 offen
    s_mov_b32 s10, 1154560
    buffer_load_dword v134, v200, s[76:79], s10 offen
    s_mov_b32 s11, 1155840
    buffer_load_dword v135, v200, s[76:79], s11 offen
    s_mov_b32 s10, 1187840
    buffer_load_dword v136, v200, s[76:79], s10 offen
    s_mov_b32 s11, 1189120
    buffer_load_dword v137, v200, s[76:79], s11 offen
    s_mov_b32 s10, 1190400
    buffer_load_dword v138, v200, s[76:79], s10 offen
    s_mov_b32 s11, 1191680
    buffer_load_dword v139, v200, s[76:79], s11 offen
    s_mov_b32 s10, 1192960
    buffer_load_dword v140, v200, s[76:79], s10 offen
    s_mov_b32 s11, 1194240
    buffer_load_dword v141, v200, s[76:79], s11 offen
    s_mov_b32 s10, 1195520
    buffer_load_dword v142, v200, s[76:79], s10 offen
    s_mov_b32 s11, 1196800
    buffer_load_dword v143, v200, s[76:79], s11 offen
    s_waitcnt vmcnt(32)
    v_perm_b32 v203, v65, v64, s24
    v_accvgpr_write_b32 a192, v203
    v_perm_b32 v204, v67, v66, s24
    v_accvgpr_write_b32 a193, v204
    v_perm_b32 v203, v69, v68, s24
    v_accvgpr_write_b32 a194, v203
    v_perm_b32 v204, v71, v70, s24
    v_accvgpr_write_b32 a195, v204
    v_perm_b32 v203, v65, v64, s25
    v_accvgpr_write_b32 a196, v203
    v_perm_b32 v204, v67, v66, s25
    v_accvgpr_write_b32 a197, v204
    v_perm_b32 v203, v69, v68, s25
    v_accvgpr_write_b32 a198, v203
    v_perm_b32 v204, v71, v70, s25
    v_accvgpr_write_b32 a199, v204
    v_perm_b32 v203, v73, v72, s24
    v_accvgpr_write_b32 a200, v203
    v_perm_b32 v204, v75, v74, s24
    v_accvgpr_write_b32 a201, v204
    v_perm_b32 v203, v77, v76, s24
    v_accvgpr_write_b32 a202, v203
    v_perm_b32 v204, v79, v78, s24
    v_accvgpr_write_b32 a203, v204
    v_perm_b32 v203, v73, v72, s25
    v_accvgpr_write_b32 a204, v203
    v_perm_b32 v204, v75, v74, s25
    v_accvgpr_write_b32 a205, v204
    v_perm_b32 v203, v77, v76, s25
    v_accvgpr_write_b32 a206, v203
    v_perm_b32 v204, v79, v78, s25
    v_accvgpr_write_b32 a207, v204
    s_mov_b32 s10, 1228800
    buffer_load_dword v64, v200, s[76:79], s10 offen
    s_mov_b32 s11, 1230080
    buffer_load_dword v65, v200, s[76:79], s11 offen
    s_mov_b32 s10, 1231360
    buffer_load_dword v66, v200, s[76:79], s10 offen
    s_mov_b32 s11, 1232640
    buffer_load_dword v67, v200, s[76:79], s11 offen
    s_mov_b32 s10, 1233920
    buffer_load_dword v68, v200, s[76:79], s10 offen
    s_mov_b32 s11, 1235200
    buffer_load_dword v69, v200, s[76:79], s11 offen
    s_mov_b32 s10, 1236480
    buffer_load_dword v70, v200, s[76:79], s10 offen
    s_mov_b32 s11, 1237760
    buffer_load_dword v71, v200, s[76:79], s11 offen
    s_mov_b32 s10, 1269760
    buffer_load_dword v72, v200, s[76:79], s10 offen
    s_mov_b32 s11, 1271040
    buffer_load_dword v73, v200, s[76:79], s11 offen
    s_mov_b32 s10, 1272320
    buffer_load_dword v74, v200, s[76:79], s10 offen
    s_mov_b32 s11, 1273600
    buffer_load_dword v75, v200, s[76:79], s11 offen
    s_mov_b32 s10, 1274880
    buffer_load_dword v76, v200, s[76:79], s10 offen
    s_mov_b32 s11, 1276160
    buffer_load_dword v77, v200, s[76:79], s11 offen
    s_mov_b32 s10, 1277440
    buffer_load_dword v78, v200, s[76:79], s10 offen
    s_mov_b32 s11, 1278720
    buffer_load_dword v79, v200, s[76:79], s11 offen
    s_waitcnt vmcnt(32)
    v_perm_b32 v203, v97, v96, s24
    v_accvgpr_write_b32 a208, v203
    v_perm_b32 v204, v99, v98, s24
    v_accvgpr_write_b32 a209, v204
    v_perm_b32 v203, v101, v100, s24
    v_accvgpr_write_b32 a210, v203
    v_perm_b32 v204, v103, v102, s24
    v_accvgpr_write_b32 a211, v204
    v_perm_b32 v203, v97, v96, s25
    v_accvgpr_write_b32 a212, v203
    v_perm_b32 v204, v99, v98, s25
    v_accvgpr_write_b32 a213, v204
    v_perm_b32 v203, v101, v100, s25
    v_accvgpr_write_b32 a214, v203
    v_perm_b32 v204, v103, v102, s25
    v_accvgpr_write_b32 a215, v204
    v_perm_b32 v203, v105, v104, s24
    v_accvgpr_write_b32 a216, v203
    v_perm_b32 v204, v107, v106, s24
    v_accvgpr_write_b32 a217, v204
    v_perm_b32 v203, v109, v108, s24
    v_accvgpr_write_b32 a218, v203
    v_perm_b32 v204, v111, v110, s24
    v_accvgpr_write_b32 a219, v204
    v_perm_b32 v203, v105, v104, s25
    v_accvgpr_write_b32 a220, v203
    v_perm_b32 v204, v107, v106, s25
    v_accvgpr_write_b32 a221, v204
    v_perm_b32 v203, v109, v108, s25
    v_accvgpr_write_b32 a222, v203
    v_perm_b32 v204, v111, v110, s25
    v_accvgpr_write_b32 a223, v204
    s_waitcnt vmcnt(16)
    v_perm_b32 v203, v129, v128, s24
    v_accvgpr_write_b32 a224, v203
    v_perm_b32 v204, v131, v130, s24
    v_accvgpr_write_b32 a225, v204
    v_perm_b32 v203, v133, v132, s24
    v_accvgpr_write_b32 a226, v203
    v_perm_b32 v204, v135, v134, s24
    v_accvgpr_write_b32 a227, v204
    v_perm_b32 v203, v129, v128, s25
    v_accvgpr_write_b32 a228, v203
    v_perm_b32 v204, v131, v130, s25
    v_accvgpr_write_b32 a229, v204
    v_perm_b32 v203, v133, v132, s25
    v_accvgpr_write_b32 a230, v203
    v_perm_b32 v204, v135, v134, s25
    v_accvgpr_write_b32 a231, v204
    v_perm_b32 v203, v137, v136, s24
    v_accvgpr_write_b32 a232, v203
    v_perm_b32 v204, v139, v138, s24
    v_accvgpr_write_b32 a233, v204
    v_perm_b32 v203, v141, v140, s24
    v_accvgpr_write_b32 a234, v203
    v_perm_b32 v204, v143, v142, s24
    v_accvgpr_write_b32 a235, v204
    v_perm_b32 v203, v137, v136, s25
    v_accvgpr_write_b32 a236, v203
    v_perm_b32 v204, v139, v138, s25
    v_accvgpr_write_b32 a237, v204
    v_perm_b32 v203, v141, v140, s25
    v_accvgpr_write_b32 a238, v203
    v_perm_b32 v204, v143, v142, s25
    v_accvgpr_write_b32 a239, v204
    s_waitcnt vmcnt(0)
    v_perm_b32 v203, v65, v64, s24
    v_accvgpr_write_b32 a240, v203
    v_perm_b32 v204, v67, v66, s24
    v_accvgpr_write_b32 a241, v204
    v_perm_b32 v203, v69, v68, s24
    v_accvgpr_write_b32 a242, v203
    v_perm_b32 v204, v71, v70, s24
    v_accvgpr_write_b32 a243, v204
    v_perm_b32 v203, v65, v64, s25
    v_accvgpr_write_b32 a244, v203
    v_perm_b32 v204, v67, v66, s25
    v_accvgpr_write_b32 a245, v204
    v_perm_b32 v203, v69, v68, s25
    v_accvgpr_write_b32 a246, v203
    v_perm_b32 v204, v71, v70, s25
    v_accvgpr_write_b32 a247, v204
    v_perm_b32 v203, v73, v72, s24
    v_accvgpr_write_b32 a248, v203
    v_perm_b32 v204, v75, v74, s24
    v_accvgpr_write_b32 a249, v204
    v_perm_b32 v203, v77, v76, s24
    v_accvgpr_write_b32 a250, v203
    v_perm_b32 v204, v79, v78, s24
    v_accvgpr_write_b32 a251, v204
    v_perm_b32 v203, v73, v72, s25
    v_accvgpr_write_b32 a252, v203
    v_perm_b32 v204, v75, v74, s25
    v_accvgpr_write_b32 a253, v204
    v_perm_b32 v203, v77, v76, s25
    v_accvgpr_write_b32 a254, v203
    v_perm_b32 v204, v79, v78, s25
    v_accvgpr_write_b32 a255, v204
    v_lshlrev_b32 v1, 4, v0
    s_lshl_b32 s10, s5, 15
    s_lshl_b32 s11, s38, 17
    s_add_u32 s10, s10, s11
    v_add_u32 v16, s10, v1
    s_add_u32 s10, s10, 4096
    v_add_u32 v17, s10, v1
    s_add_u32 s10, s10, 4096
    v_add_u32 v18, s10, v1
    s_add_u32 s10, s10, 4096
    v_add_u32 v19, s10, v1
    s_add_u32 s10, s10, 4096
    v_add_u32 v20, s10, v1
    s_add_u32 s10, s10, 4096
    v_add_u32 v21, s10, v1
    s_add_u32 s10, s10, 4096
    v_add_u32 v22, s10, v1
    s_add_u32 s10, s10, 4096
    v_add_u32 v23, s10, v1
    s_add_u32 s10, s10, 4096
    s_lshl_b32 s10, s5, 11
    v_add_u32 v7, s10, v1
    v_and_b32 v5, 15, v0
    s_lshl_b32 s10, s38, 4
    v_add_u32 v5, s10, v5
    v_mul_u32_u24 v8, 5120, v5
    v_lshrrev_b32 v5, 4, v0
    v_lshl_add_u32 v8, v5, 5, v8
    s_lshl_b32 s10, s39, 7
    v_add_u32 v8, s10, v8
    v_and_b32 v5, 7, v0
    s_lshl_b32 s10, s5, 3
    v_add_u32 v5, s10, v5
    v_lshlrev_b32 v9, 7, v5
    v_add_u32 v9, 16384, v9
    s_load_dwordx2 s[34:35], s[0:1], 128
    s_waitcnt lgkmcnt(0)
    s_add_u32 s32, s8, 50331648
    s_addc_u32 s33, s9, 0
    v_lshlrev_b32 v5, 5, v0
    v_add_u32 v5, 4, v5
    s_mov_b32 s27, 0
L_wi_72:
    s_mov_b64 exec, 0xff
    global_load_dword v6, v5, s[6:7] sc1
    s_waitcnt vmcnt(0)
    s_mov_b64 exec, -1
    v_readlane_b32 s10, v6, 0
    v_readlane_b32 s11, v6, 1
    s_add_u32 s10, s10, s11
    v_readlane_b32 s11, v6, 2
    s_add_u32 s10, s10, s11
    v_readlane_b32 s11, v6, 3
    s_add_u32 s10, s10, s11
    v_readlane_b32 s11, v6, 4
    s_add_u32 s10, s10, s11
    v_readlane_b32 s11, v6, 5
    s_add_u32 s10, s10, s11
    v_readlane_b32 s11, v6, 6
    s_add_u32 s10, s10, s11
    v_readlane_b32 s11, v6, 7
    s_add_u32 s10, s10, s11
    s_cmp_ge_u32 s10, 256
    s_cbranch_scc1 L_wiok_73
    s_sleep 4
    s_add_u32 s27, s27, 1
    s_cmp_lt_u32 s27, 262144
    s_cbranch_scc1 L_wi_72
    s_branch L_timeout
L_wiok_73:
    s_mov_b32 s18, 0
    s_mov_b32 s37, 0
L_s2_loop:
    s_add_u32 s30, s18, 1
    s_mov_b32 s27, 0
L_pfs2_74:
    s_mov_b64 exec, 255
    global_load_dword v5, v9, s[22:23] sc1
    s_waitcnt vmcnt(0)
    v_cmp_gt_u32 vcc, s30, v5
    s_mov_b64 exec, -1
    s_cbranch_vccz L_pfos2_75
    s_sleep 1
    s_add_u32 s27, s27, 1
    s_cmp_lt_u32 s27, 262144
    s_cbranch_scc1 L_pfs2_74
    s_branch L_timeout
L_pfos2_75:
    global_load_dwordx4 v[64:67], v16, s[32:33] offset:0 sc1
    global_load_dwordx4 v[68:71], v16, s[32:33] offset:1024 sc1
    global_load_dwordx4 v[72:75], v16, s[32:33] offset:2048 sc1
    global_load_dwordx4 v[76:79], v16, s[32:33] offset:3072 sc1
    global_load_dwordx4 v[80:83], v17, s[32:33] offset:0 sc1
    global_load_dwordx4 v[84:87], v17, s[32:33] offset:1024 sc1
    global_load_dwordx4 v[88:91], v17, s[32:33] offset:2048 sc1
    global_load_dwordx4 v[92:95], v17, s[32:33] offset:3072 sc1
    global_load_dwordx4 v[96:99], v18, s[32:33] offset:0 sc1
    global_load_dwordx4 v[100:103], v18, s[32:33] offset:1024 sc1
    global_load_dwordx4 v[104:107], v18, s[32:33] offset:2048 sc1
    global_load_dwordx4 v[108:111], v18, s[32:33] offset:3072 sc1
    global_load_dwordx4 v[112:115], v19, s[32:33] offset:0 sc1
    global_load_dwordx4 v[116:119], v19, s[32:33] offset:1024 sc1
    global_load_dwordx4 v[120:123], v19, s[32:33] offset:2048 sc1
    global_load_dwordx4 v[124:127], v19, s[32:33] offset:3072 sc1
    global_load_dwordx4 v[128:131], v20, s[32:33] offset:0 sc1
    global_load_dwordx4 v[132:135], v20, s[32:33] offset:1024 sc1
    global_load_dwordx4 v[136:139], v20, s[32:33] offset:2048 sc1
    global_load_dwordx4 v[140:143], v20, s[32:33] offset:3072 sc1
    global_load_dwordx4 v[144:147], v21, s[32:33] offset:0 sc1
    global_load_dwordx4 v[148:151], v21, s[32:33] offset:1024 sc1
    global_load_dwordx4 v[152:155], v21, s[32:33] offset:2048 sc1
    global_load_dwordx4 v[156:159], v21, s[32:33] offset:3072 sc1
    global_load_dwordx4 v[160:163], v22, s[32:33] offset:0 sc1
    global_load_dwordx4 v[164:167], v22, s[32:33] offset:1024 sc1
    global_load_dwordx4 v[168:171], v22, s[32:33] offset:2048 sc1
    global_load_dwordx4 v[172:175], v22, s[32:33] offset:3072 sc1
    global_load_dwordx4 v[176:179], v23, s[32:33] offset:0 sc1
    global_load_dwordx4 v[180:183], v23, s[32:33] offset:1024 sc1
    global_load_dwordx4 v[184:187], v23, s[32:33] offset:2048 sc1
    global_load_dwordx4 v[188:191], v23, s[32:33] offset:3072 sc1
    s_waitcnt vmcnt(30)
    v_mfma_f32_16x16x32_bf16 v[40:43], a[0:3], v[64:67], 0
    v_mfma_f32_16x16x32_bf16 v[44:47], a[4:7], v[64:67], 0
    v_mfma_f32_16x16x32_bf16 v[40:43], a[8:11], v[68:71], v[40:43]
    v_mfma_f32_16x16x32_bf16 v[44:47], a[12:15], v[68:71], v[44:47]
    s_waitcnt vmcnt(28)
    v_mfma_f32_16x16x32_bf16 v[40:43], a[16:19], v[72:75], v[40:43]
    v_mfma_f32_16x16x32_bf16 v[44:47], a[20:23], v[72:75], v[44:47]
    v_mfma_f32_16x16x32_bf16 v[40:43], a[24:27], v[76:79], v[40:43]
    v_mfma_f32_16x16x32_bf16 v[44:47], a[28:31], v[76:79], v[44:47]
    s_waitcnt vmcnt(26)
    v_mfma_f32_16x16x32_bf16 v[40:43], a[32:35], v[80:83], v[40:43]
    v_mfma_f32_16x16x32_bf16 v[44:47], a[36:39], v[80:83], v[44:47]
    v_mfma_f32_16x16x32_bf16 v[40:43], a[40:43], v[84:87], v[40:43]
    v_mfma_f32_16x16x32_bf16 v[44:47], a[44:47], v[84:87], v[44:47]
    s_waitcnt vmcnt(24)
    v_mfma_f32_16x16x32_bf16 v[40:43], a[48:51], v[88:91], v[40:43]
    v_mfma_f32_16x16x32_bf16 v[44:47], a[52:55], v[88:91], v[44:47]
    v_mfma_f32_16x16x32_bf16 v[40:43], a[56:59], v[92:95], v[40:43]
    v_mfma_f32_16x16x32_bf16 v[44:47], a[60:63], v[92:95], v[44:47]
    s_waitcnt vmcnt(22)
    v_mfma_f32_16x16x32_bf16 v[40:43], a[64:67], v[96:99], v[40:43]
    v_mfma_f32_16x16x32_bf16 v[44:47], a[68:71], v[96:99], v[44:47]
    v_mfma_f32_16x16x32_bf16 v[40:43], a[72:75], v[100:103], v[40:43]
    v_mfma_f32_16x16x32_bf16 v[44:47], a[76:79], v[100:103], v[44:47]
    s_waitcnt vmcnt(20)
    v_mfma_f32_16x16x32_bf16 v[40:43], a[80:83], v[104:107], v[40:43]
    v_mfma_f32_16x16x32_bf16 v[44:47], a[84:87], v[104:107], v[44:47]
    v_mfma_f32_16x16x32_bf16 v[40:43], a[88:91], v[108:111], v[40:43]
    v_mfma_f32_16x16x32_bf16 v[44:47], a[92:95], v[108:111], v[44:47]
    s_waitcnt vmcnt(18)
    v_mfma_f32_16x16x32_bf16 v[40:43], a[96:99], v[112:115], v[40:43]
    v_mfma_f32_16x16x32_bf16 v[44:47], a[100:103], v[112:115], v[44:47]
    v_mfma_f32_16x16x32_bf16 v[40:43], a[104:107], v[116:119], v[40:43]
    v_mfma_f32_16x16x32_bf16 v[44:47], a[108:111], v[116:119], v[44:47]
    s_waitcnt vmcnt(16)
    v_mfma_f32_16x16x32_bf16 v[40:43], a[112:115], v[120:123], v[40:43]
    v_mfma_f32_16x16x32_bf16 v[44:47], a[116:119], v[120:123], v[44:47]
    v_mfma_f32_16x16x32_bf16 v[40:43], a[120:123], v[124:127], v[40:43]
    v_mfma_f32_16x16x32_bf16 v[44:47], a[124:127], v[124:127], v[44:47]
    s_waitcnt vmcnt(14)
    v_mfma_f32_16x16x32_bf16 v[40:43], a[128:131], v[128:131], v[40:43]
    v_mfma_f32_16x16x32_bf16 v[44:47], a[132:135], v[128:131], v[44:47]
    v_mfma_f32_16x16x32_bf16 v[40:43], a[136:139], v[132:135], v[40:43]
    v_mfma_f32_16x16x32_bf16 v[44:47], a[140:143], v[132:135], v[44:47]
    s_waitcnt vmcnt(12)
    v_mfma_f32_16x16x32_bf16 v[40:43], a[144:147], v[136:139], v[40:43]
    v_mfma_f32_16x16x32_bf16 v[44:47], a[148:151], v[136:139], v[44:47]
    v_mfma_f32_16x16x32_bf16 v[40:43], a[152:155], v[140:143], v[40:43]
    v_mfma_f32_16x16x32_bf16 v[44:47], a[156:159], v[140:143], v[44:47]
    s_waitcnt vmcnt(10)
    v_mfma_f32_16x16x32_bf16 v[40:43], a[160:163], v[144:147], v[40:43]
    v_mfma_f32_16x16x32_bf16 v[44:47], a[164:167], v[144:147], v[44:47]
    v_mfma_f32_16x16x32_bf16 v[40:43], a[168:171], v[148:151], v[40:43]
    v_mfma_f32_16x16x32_bf16 v[44:47], a[172:175], v[148:151], v[44:47]
    s_waitcnt vmcnt(8)
    v_mfma_f32_16x16x32_bf16 v[40:43], a[176:179], v[152:155], v[40:43]
    v_mfma_f32_16x16x32_bf16 v[44:47], a[180:183], v[152:155], v[44:47]
    v_mfma_f32_16x16x32_bf16 v[40:43], a[184:187], v[156:159], v[40:43]
    v_mfma_f32_16x16x32_bf16 v[44:47], a[188:191], v[156:159], v[44:47]
    s_waitcnt vmcnt(6)
    v_mfma_f32_16x16x32_bf16 v[40:43], a[192:195], v[160:163], v[40:43]
    v_mfma_f32_16x16x32_bf16 v[44:47], a[196:199], v[160:163], v[44:47]
    v_mfma_f32_16x16x32_bf16 v[40:43], a[200:203], v[164:167], v[40:43]
    v_mfma_f32_16x16x32_bf16 v[44:47], a[204:207], v[164:167], v[44:47]
    s_waitcnt vmcnt(4)
    v_mfma_f32_16x16x32_bf16 v[40:43], a[208:211], v[168:171], v[40:43]
    v_mfma_f32_16x16x32_bf16 v[44:47], a[212:215], v[168:171], v[44:47]
    v_mfma_f32_16x16x32_bf16 v[40:43], a[216:219], v[172:175], v[40:43]
    v_mfma_f32_16x16x32_bf16 v[44:47], a[220:223], v[172:175], v[44:47]
    s_waitcnt vmcnt(2)
    v_mfma_f32_16x16x32_bf16 v[40:43], a[224:227], v[176:179], v[40:43]
    v_mfma_f32_16x16x32_bf16 v[44:47], a[228:231], v[176:179], v[44:47]
    v_mfma_f32_16x16x32_bf16 v[40:43], a[232:235], v[180:183], v[40:43]
    v_mfma_f32_16x16x32_bf16 v[44:47], a[236:239], v[180:183], v[44:47]
    s_waitcnt vmcnt(0)
    v_mfma_f32_16x16x32_bf16 v[40:43], a[240:243], v[184:187], v[40:43]
    v_mfma_f32_16x16x32_bf16 v[44:47], a[244:247], v[184:187], v[44:47]
    v_mfma_f32_16x16x32_bf16 v[40:43], a[248:251], v[188:191], v[40:43]
    v_mfma_f32_16x16x32_bf16 v[44:47], a[252:255], v[188:191], v[44:47]
    s_lshl_b32 s10, s37, 13
    v_add_u32 v5, s10, v7
    s_nop 2
    ds_write_b128 v5, v[40:43]
    s_nop 1
    ds_write_b128 v5, v[44:47] offset:1024
    s_waitcnt lgkmcnt(0)
    s_barrier
    s_cmp_eq_u32 s5, 0
    s_cbranch_scc0 L_s2sk_76
    ds_read_b128 v[72:75], v5 offset:2048
    ds_read_b128 v[76:79], v5 offset:3072
    ds_read_b128 v[80:83], v5 offset:4096
    ds_read_b128 v[84:87], v5 offset:5120
    ds_read_b128 v[88:91], v5 offset:6144
    ds_read_b128 v[92:95], v5 offset:7168
    s_waitcnt lgkmcnt(0)
    v_pk_add_f32 v[40:41], v[40:41], v[72:73]
    v_pk_add_f32 v[42:43], v[42:43], v[74:75]
    v_pk_add_f32 v[80:81], v[80:81], v[88:89]
    v_pk_add_f32 v[82:83], v[82:83], v[90:91]
    v_pk_add_f32 v[44:45], v[44:45], v[76:77]
    v_pk_add_f32 v[46:47], v[46:47], v[78:79]
    v_pk_add_f32 v[84:85], v[84:85], v[92:93]
    v_pk_add_f32 v[86:87], v[86:87], v[94:95]
    v_add_f32 v48, v40, v80
    v_add_f32 v49, v44, v84
    v_add_f32 v50, v41, v81
    v_add_f32 v51, v45, v85
    v_add_f32 v52, v42, v82
    v_add_f32 v53, v46, v86
    v_add_f32 v54, v43, v83
    v_add_f32 v55, v47, v87
    global_store_dwordx4 v8, v[48:51], s[34:35]
    global_store_dwordx4 v8, v[52:55], s[34:35] offset:16
L_s2sk_76:
    s_add_u32 s32, s32, 262144
    s_addc_u32 s33, s33, 0
    s_add_u32 s34, s34, 163840
    s_addc_u32 s35, s35, 0
    s_xor_b32 s37, s37, 1
    s_add_u32 s18, s18, 1
    s_cmp_lt_u32 s18, 64
    s_cbranch_scc1 L_s2_loop
    s_waitcnt vmcnt(0)
    s_endpgm
L_b1:
    s_add_u32 s22, s8, 5767168
    s_addc_u32 s23, s9, 0
    s_lshl_b32 s36, s38, 7
    s_add_u32 s36, s36, 20480
    s_mov_b32 s30, 0
    s_cmp_eq_u32 s5, 0
    s_cbranch_scc0 L_fl_77
    v_mov_b32 v5, s36
    v_mov_b32 v6, s30
    s_mov_b64 exec, 1
    global_store_dword v5, v6, s[22:23] sc1
    s_mov_b64 exec, -1
L_fl_77:
    s_waitcnt vmcnt(0)
    s_barrier
    s_cmp_eq_u32 s5, 0
    s_cbranch_scc0 L_si_78
    s_lshl_b32 s10, s3, 5
    s_add_u32 s10, s10, 4
    v_mov_b32 v5, s10
    v_mov_b32 v6, 1
    s_mov_b64 exec, 1
    global_atomic_add v5, v6, s[6:7]
    s_mov_b64 exec, -1
L_si_78:
    s_load_dwordx2 s[16:17], s[0:1], 56
    v_lshlrev_b32 v1, 4, v0
    v_lshrrev_b32 v5, 3, v0
    v_and_b32 v6, 7, v0
    v_xor_b32 v6, v6, v5
    s_lshl_b32 s10, s5, 3
    v_add_u32 v5, s10, v5
    v_mul_u32_u24 v2, 1280, v5
    v_lshl_add_u32 v2, v6, 4, v2
    v_and_b32 v5, 7, v0
    v_bfe_u32 v6, v0, 3, 1
    v_mul_u32_u24 v3, 10240, v6
    v_lshl_add_u32 v3, v5, 7, v3
    v_lshrrev_b32 v6, 4, v0
    v_xor_b32 v14, v6, v5
    v_xor_b32 v6, 4, v14
    v_lshl_add_u32 v15, v6, 4, v3
    v_lshl_add_u32 v14, v14, 4, v3
    s_waitcnt lgkmcnt(0)
    s_mov_b32 s31, 0
    s_mul_i32 s13, s5, 10240
    s_add_u32 s13, s13, s31
    s_add_u32 m0, s13, 0
    s_nop 0
    global_load_lds_dwordx4 v2, s[16:17] offset:0
    s_add_u32 m0, s13, 896
    s_nop 0
    global_load_lds_dwordx4 v2, s[16:17] offset:128
    s_add_u32 m0, s13, 1792
    s_nop 0
    global_load_lds_dwordx4 v2, s[16:17] offset:256
    s_add_u32 m0, s13, 2688
    s_nop 0
    global_load_lds_dwordx4 v2, s[16:17] offset:384
    s_add_u32 m0, s13, 3584
    s_nop 0
    global_load_lds_dwordx4 v2, s[16:17] offset:512
    s_add_u32 m0, s13, 4480
    s_nop 0
    global_load_lds_dwordx4 v2, s[16:17] offset:640
    s_add_u32 m0, s13, 5376
    s_nop 0
    global_load_lds_dwordx4 v2, s[16:17] offset:768
    s_add_u32 m0, s13, 6272
    s_nop 0
    global_load_lds_dwordx4 v2, s[16:17] offset:896
    s_add_u32 m0, s13, 7168
    s_nop 0
    global_load_lds_dwordx4 v2, s[16:17] offset:1024
    s_add_u32 m0, s13, 8064
    s_nop 0
    global_load_lds_dwordx4 v2, s[16:17] offset:1152
    s_load_dwordx2 s[10:11], s[0:1], 80
    s_load_dwordx2 s[12:13], s[0:1], 88
    v_and_b32 v16, 7, v0
    s_lshl_b32 s14, s38, 5
    s_lshl_b32 s15, s5, 3
    s_add_u32 s14, s14, s15
    v_add_u32 v16, s14, v16
    v_mul_u32_u24 v16, 1280, v16
    v_lshrrev_b32 v17, 4, v0
    v_lshl_add_u32 v16, v17, 4, v16
    v_bfe_u32 v17, v0, 3, 1
    v_cmp_eq_u32 vcc, 0, v17
    s_waitcnt lgkmcnt(0)
    v_mov_b32 v18, s10
    v_mov_b32 v19, s11
    v_mov_b32 v20, s12
    v_mov_b32 v21, s13
    v_cndmask_b32 v18, v20, v18, vcc
    v_cndmask_b32 v19, v21, v19, vcc
    v_add_co_u32 v18, vcc, v18, v16
    s_nop 1
    v_addc_co_u32 v19, vcc, 0, v19, vcc
    global_load_dwordx4 a[0:3], v[18:19], off offset:0
    global_load_dwordx4 a[4:7], v[18:19], off offset:64
    global_load_dwordx4 a[8:11], v[18:19], off offset:128
    global_load_dwordx4 a[12:15], v[18:19], off offset:192
    global_load_dwordx4 a[16:19], v[18:19], off offset:256
    global_load_dwordx4 a[20:23], v[18:19], off offset:320
    global_load_dwordx4 a[24:27], v[18:19], off offset:384
    global_load_dwordx4 a[28:31], v[18:19], off offset:448
    global_load_dwordx4 a[32:35], v[18:19], off offset:512
    global_load_dwordx4 a[36:39], v[18:19], off offset:576
    global_load_dwordx4 a[40:43], v[18:19], off offset:640
    global_load_dwordx4 a[44:47], v[18:19], off offset:704
    global_load_dwordx4 a[48:51], v[18:19], off offset:768
    global_load_dwordx4 a[52:55], v[18:19], off offset:832
    global_load_dwordx4 a[56:59], v[18:19], off offset:896
    global_load_dwordx4 a[60:63], v[18:19], off offset:960
    global_load_dwordx4 a[64:67], v[18:19], off offset:1024
    global_load_dwordx4 a[68:71], v[18:19], off offset:1088
    global_load_dwordx4 a[72:75], v[18:19], off offset:1152
    global_load_dwordx4 a[76:79], v[18:19], off offset:1216
    v_bfe_u32 v16, v0, 3, 1
    v_lshlrev_b32 v16, 4, v16
    v_lshrrev_b32 v17, 4, v0
    v_lshl_add_u32 v16, v17, 2, v16
    v_lshlrev_b32 v4, 7, v16
    v_and_b32 v17, 7, v0
    s_lshl_b32 s10, s5, 3
    v_add_u32 v17, s10, v17
    v_lshl_add_u32 v4, v17, 2, v4
    s_mul_i32 s10, s38, 262144
    s_add_u32 s10, s10, 67108864
    s_add_u32 s32, s8, s10
    s_addc_u32 s33, s9, 0
    s_mov_b32 s40, 0x00ff00ff
    s_mov_b32 s41, 0x00ff00ff
    v_lshlrev_b32 v5, 5, v0
    v_add_u32 v5, 4, v5
    s_mov_b32 s27, 0
L_wi_79:
    s_mov_b64 exec, 0xff
    global_load_dword v6, v5, s[6:7] sc1
    s_waitcnt vmcnt(0)
    s_mov_b64 exec, -1
    v_readlane_b32 s10, v6, 0
    v_readlane_b32 s11, v6, 1
    s_add_u32 s10, s10, s11
    v_readlane_b32 s11, v6, 2
    s_add_u32 s10, s10, s11
    v_readlane_b32 s11, v6, 3
    s_add_u32 s10, s10, s11
    v_readlane_b32 s11, v6, 4
    s_add_u32 s10, s10, s11
    v_readlane_b32 s11, v6, 5
    s_add_u32 s10, s10, s11
    v_readlane_b32 s11, v6, 6
    s_add_u32 s10, s10, s11
    v_readlane_b32 s11, v6, 7
    s_add_u32 s10, s10, s11
    s_cmp_ge_u32 s10, 256
    s_cbranch_scc1 L_wiok_80
    s_sleep 4
    s_add_u32 s27, s27, 1
    s_cmp_lt_u32 s27, 262144
    s_cbranch_scc1 L_wi_79
    s_branch L_timeout
L_wiok_80:
    s_mov_b32 s18, 0
    s_mov_b32 s26, 0
    v_add_u32 v12, 0, v14
    v_add_u32 v13, 0, v15
    s_waitcnt vmcnt(0)
L_b1_loop:
    s_waitcnt vmcnt(4)
    s_barrier
    s_add_u32 s30, s18, 1
    s_cmp_ge_u32 s30, 64
    s_cbranch_scc1 L_b1nd_81
    s_add_u32 s16, s16, 40960
    s_addc_u32 s17, s17, 0
    s_xor_b32 s31, s26, 40960
    s_mul_i32 s13, s5, 10240
    s_add_u32 s13, s13, s31
    ds_read_b128 v[16:19], v12 offset:0
    ds_read_b128 v[20:23], v12 offset:20480
    ds_read_b128 v[24:27], v13 offset:0
    ds_read_b128 v[28:31], v13 offset:20480
    ds_read_b128 v[32:35], v12 offset:1024
    ds_read_b128 v[36:39], v12 offset:21504
    s_waitcnt lgkmcnt(4)
    v_mfma_f32_16x16x32_bf16 v[40:43], v[16:19], a[0:3], 0
    v_mfma_f32_16x16x32_bf16 v[44:47], v[20:23], a[0:3], 0
    s_add_u32 m0, s13, 0
    s_nop 0
    global_load_lds_dwordx4 v2, s[16:17] offset:0
    ds_read_b128 v[16:19], v13 offset:1024
    ds_read_b128 v[20:23], v13 offset:21504
    s_waitcnt lgkmcnt(4)
    v_mfma_f32_16x16x32_bf16 v[40:43], v[24:27], a[4:7], v[40:43]
    v_mfma_f32_16x16x32_bf16 v[44:47], v[28:31], a[4:7], v[44:47]
    ds_read_b128 v[24:27], v12 offset:2048
    ds_read_b128 v[28:31], v12 offset:22528
    s_waitcnt lgkmcnt(4)
    v_mfma_f32_16x16x32_bf16 v[40:43], v[32:35], a[8:11], v[40:43]
    v_mfma_f32_16x16x32_bf16 v[44:47], v[36:39], a[8:11], v[44:47]
    s_add_u32 m0, s13, 896
    s_nop 0
    global_load_lds_dwordx4 v2, s[16:17] offset:128
    ds_read_b128 v[32:35], v13 offset:2048
    ds_read_b128 v[36:39], v13 offset:22528
    s_waitcnt lgkmcnt(4)
    v_mfma_f32_16x16x32_bf16 v[40:43], v[16:19], a[12:15], v[40:43]
    v_mfma_f32_16x16x32_bf16 v[44:47], v[20:23], a[12:15], v[44:47]
    ds_read_b128 v[16:19], v12 offset:3072
    ds_read_b128 v[20:23], v12 offset:23552
    s_waitcnt lgkmcnt(4)
    v_mfma_f32_16x16x32_bf16 v[40:43], v[24:27], a[16:19], v[40:43]
    v_mfma_f32_16x16x32_bf16 v[44:47], v[28:31], a[16:19], v[44:47]
    s_add_u32 m0, s13, 1792
    s_nop 0
    global_load_lds_dwordx4 v2, s[16:17] offset:256
    ds_read_b128 v[24:27], v13 offset:3072
    ds_read_b128 v[28:31], v13 offset:23552
    s_waitcnt lgkmcnt(4)
    v_mfma_f32_16x16x32_bf16 v[40:43], v[32:35], a[20:23], v[40:43]
    v_mfma_f32_16x16x32_bf16 v[44:47], v[36:39], a[20:23], v[44:47]
    ds_read_b128 v[32:35], v12 offset:4096
    ds_read_b128 v[36:39], v12 offset:24576
    s_waitcnt lgkmcnt(4)
    v_mfma_f32_16x16x32_bf16 v[40:43], v[16:19], a[24:27], v[40:43]
    v_mfma_f32_16x16x32_bf16 v[44:47], v[20:23], a[24:27], v[44:47]
    s_add_u32 m0, s13, 2688
    s_nop 0
    global_load_lds_dwordx4 v2, s[16:17] offset:384
    ds_read_b128 v[16:19], v13 offset:4096
    ds_read_b128 v[20:23], v13 offset:24576
    s_waitcnt lgkmcnt(4)
    v_mfma_f32_16x16x32_bf16 v[40:43], v[24:27], a[28:31], v[40:43]
    v_mfma_f32_16x16x32_bf16 v[44:47], v[28:31], a[28:31], v[44:47]
    ds_read_b128 v[24:27], v12 offset:5120
    ds_read_b128 v[28:31], v12 offset:25600
    s_waitcnt lgkmcnt(4)
    v_mfma_f32_16x16x32_bf16 v[40:43], v[32:35], a[32:35], v[40:43]
    v_mfma_f32_16x16x32_bf16 v[44:47], v[36:39], a[32:35], v[44:47]
    s_add_u32 m0, s13, 3584
    s_nop 0
    global_load_lds_dwordx4 v2, s[16:17] offset:512
    ds_read_b128 v[32:35], v13 offset:5120
    ds_read_b128 v[36:39], v13 offset:25600
    s_waitcnt lgkmcnt(4)
    v_mfma_f32_16x16x32_bf16 v[40:43], v[16:19], a[36:39], v[40:43]
    v_mfma_f32_16x16x32_bf16 v[44:47], v[20:23], a[36:39], v[44:47]
    ds_read_b128 v[16:19], v12 offset:6144
    ds_read_b128 v[20:23], v12 offset:26624
    s_waitcnt lgkmcnt(4)
    v_mfma_f32_16x16x32_bf16 v[40:43], v[24:27], a[40:43], v[40:43]
    v_mfma_f32_16x16x32_bf16 v[44:47], v[28:31], a[40:43], v[44:47]
    s_add_u32 m0, s13, 4480
    s_nop 0
    global_load_lds_dwordx4 v2, s[16:17] offset:640
    ds_read_b128 v[24:27], v13 offset:6144
    ds_read_b128 v[28:31], v13 offset:26624
    s_waitcnt lgkmcnt(4)
    v_mfma_f32_16x16x32_bf16 v[40:43], v[32:35], a[44:47], v[40:43]
    v_mfma_f32_16x16x32_bf16 v[44:47], v[36:39], a[44:47], v[44:47]
    ds_read_b128 v[32:35], v12 offset:7168
    ds_read_b128 v[36:39], v12 offset:27648
    s_waitcnt lgkmcnt(4)
    v_mfma_f32_16x16x32_bf16 v[40:43], v[16:19], a[48:51], v[40:43]
    v_mfma_f32_16x16x32_bf16 v[44:47], v[20:23], a[48:51], v[44:47]
    s_add_u32 m0, s13, 5376
    s_nop 0
    global_load_lds_dwordx4 v2, s[16:17] offset:768
    ds_read_b128 v[16:19], v13 offset:7168
    ds_read_b128 v[20:23], v13 offset:27648
    s_waitcnt lgkmcnt(4)
    v_mfma_f32_16x16x32_bf16 v[40:43], v[24:27], a[52:55], v[40:43]
    v_mfma_f32_16x16x32_bf16 v[44:47], v[28:31], a[52:55], v[44:47]
    ds_read_b128 v[24:27], v12 offset:8192
    ds_read_b128 v[28:31], v12 offset:28672
    s_waitcnt lgkmcnt(4)
    v_mfma_f32_16x16x32_bf16 v[40:43], v[32:35], a[56:59], v[40:43]
    v_mfma_f32_16x16x32_bf16 v[44:47], v[36:39], a[56:59], v[44:47]
    s_add_u32 m0, s13, 6272
    s_nop 0
    global_load_lds_dwordx4 v2, s[16:17] offset:896
    ds_read_b128 v[32:35], v13 offset:8192
    ds_read_b128 v[36:39], v13 offset:28672
    s_waitcnt lgkmcnt(4)
    v_mfma_f32_16x16x32_bf16 v[40:43], v[16:19], a[60:63], v[40:43]
    v_mfma_f32_16x16x32_bf16 v[44:47], v[20:23], a[60:63], v[44:47]
    ds_read_b128 v[16:19], v12 offset:9216
    ds_read_b128 v[20:23], v12 offset:29696
    s_waitcnt lgkmcnt(4)
    v_mfma_f32_16x16x32_bf16 v[40:43], v[24:27], a[64:67], v[40:43]
    v_mfma_f32_16x16x32_bf16 v[44:47], v[28:31], a[64:67], v[44:47]
    s_add_u32 m0, s13, 7168
    s_nop 0
    global_load_lds_dwordx4 v2, s[16:17] offset:1024
    ds_read_b128 v[24:27], v13 offset:9216
    ds_read_b128 v[28:31], v13 offset:29696
    s_waitcnt lgkmcnt(4)
    v_mfma_f32_16x16x32_bf16 v[40:43], v[32:35], a[68:71], v[40:43]
    v_mfma_f32_16x16x32_bf16 v[44:47], v[36:39], a[68:71], v[44:47]
    s_waitcnt lgkmcnt(2)
    v_mfma_f32_16x16x32_bf16 v[40:43], v[16:19], a[72:75], v[40:43]
    v_mfma_f32_16x16x32_bf16 v[44:47], v[20:23], a[72:75], v[44:47]
    s_add_u32 m0, s13, 8064
    s_nop 0
    global_load_lds_dwordx4 v2, s[16:17] offset:1152
    s_waitcnt lgkmcnt(0)
    v_mfma_f32_16x16x32_bf16 v[40:43], v[24:27], a[76:79], v[40:43]
    v_mfma_f32_16x16x32_bf16 v[44:47], v[28:31], a[76:79], v[44:47]
    s_branch L_b1j_82
L_b1nd_81:
    ds_read_b128 v[16:19], v12 offset:0
    ds_read_b128 v[20:23], v12 offset:20480
    ds_read_b128 v[24:27], v13 offset:0
    ds_read_b128 v[28:31], v13 offset:20480
    ds_read_b128 v[32:35], v12 offset:1024
    ds_read_b128 v[36:39], v12 offset:21504
    s_waitcnt lgkmcnt(4)
    v_mfma_f32_16x16x32_bf16 v[40:43], v[16:19], a[0:3], 0
    v_mfma_f32_16x16x32_bf16 v[44:47], v[20:23], a[0:3], 0
    ds_read_b128 v[16:19], v13 offset:1024
    ds_read_b128 v[20:23], v13 offset:21504
    s_waitcnt lgkmcnt(4)
    v_mfma_f32_16x16x32_bf16 v[40:43], v[24:27], a[4:7], v[40:43]
    v_mfma_f32_16x16x32_bf16 v[44:47], v[28:31], a[4:7], v[44:47]
    ds_read_b128 v[24:27], v12 offset:2048
    ds_read_b128 v[28:31], v12 offset:22528
    s_waitcnt lgkmcnt(4)
    v_mfma_f32_16x16x32_bf16 v[40:43], v[32:35], a[8:11], v[40:43]
    v_mfma_f32_16x16x32_bf16 v[44:47], v[36:39], a[8:11], v[44:47]
    ds_read_b128 v[32:35], v13 offset:2048
    ds_read_b128 v[36:39], v13 offset:22528
    s_waitcnt lgkmcnt(4)
    v_mfma_f32_16x16x32_bf16 v[40:43], v[16:19], a[12:15], v[40:43]
    v_mfma_f32_16x16x32_bf16 v[44:47], v[20:23], a[12:15], v[44:47]
    ds_read_b128 v[16:19], v12 offset:3072
    ds_read_b128 v[20:23], v12 offset:23552
    s_waitcnt lgkmcnt(4)
    v_mfma_f32_16x16x32_bf16 v[40:43], v[24:27], a[16:19], v[40:43]
    v_mfma_f32_16x16x32_bf16 v[44:47], v[28:31], a[16:19], v[44:47]
    ds_read_b128 v[24:27], v13 offset:3072
    ds_read_b128 v[28:31], v13 offset:23552
    s_waitcnt lgkmcnt(4)
    v_mfma_f32_16x16x32_bf16 v[40:43], v[32:35], a[20:23], v[40:43]
    v_mfma_f32_16x16x32_bf16 v[44:47], v[36:39], a[20:23], v[44:47]
    ds_read_b128 v[32:35], v12 offset:4096
    ds_read_b128 v[36:39], v12 offset:24576
    s_waitcnt lgkmcnt(4)
    v_mfma_f32_16x16x32_bf16 v[40:43], v[16:19], a[24:27], v[40:43]
    v_mfma_f32_16x16x32_bf16 v[44:47], v[20:23], a[24:27], v[44:47]
    ds_read_b128 v[16:19], v13 offset:4096
    ds_read_b128 v[20:23], v13 offset:24576
    s_waitcnt lgkmcnt(4)
    v_mfma_f32_16x16x32_bf16 v[40:43], v[24:27], a[28:31], v[40:43]
    v_mfma_f32_16x16x32_bf16 v[44:47], v[28:31], a[28:31], v[44:47]
    ds_read_b128 v[24:27], v12 offset:5120
    ds_read_b128 v[28:31], v12 offset:25600
    s_waitcnt lgkmcnt(4)
    v_mfma_f32_16x16x32_bf16 v[40:43], v[32:35], a[32:35], v[40:43]
    v_mfma_f32_16x16x32_bf16 v[44:47], v[36:39], a[32:35], v[44:47]
    ds_read_b128 v[32:35], v13 offset:5120
    ds_read_b128 v[36:39], v13 offset:25600
    s_waitcnt lgkmcnt(4)
    v_mfma_f32_16x16x32_bf16 v[40:43], v[16:19], a[36:39], v[40:43]
    v_mfma_f32_16x16x32_bf16 v[44:47], v[20:23], a[36:39], v[44:47]
    ds_read_b128 v[16:19], v12 offset:6144
    ds_read_b128 v[20:23], v12 offset:26624
    s_waitcnt lgkmcnt(4)
    v_mfma_f32_16x16x32_bf16 v[40:43], v[24:27], a[40:43], v[40:43]
    v_mfma_f32_16x16x32_bf16 v[44:47], v[28:31], a[40:43], v[44:47]
    ds_read_b128 v[24:27], v13 offset:6144
    ds_read_b128 v[28:31], v13 offset:26624
    s_waitcnt lgkmcnt(4)
    v_mfma_f32_16x16x32_bf16 v[40:43], v[32:35], a[44:47], v[40:43]
    v_mfma_f32_16x16x32_bf16 v[44:47], v[36:39], a[44:47], v[44:47]
    ds_read_b128 v[32:35], v12 offset:7168
    ds_read_b128 v[36:39], v12 offset:27648
    s_waitcnt lgkmcnt(4)
    v_mfma_f32_16x16x32_bf16 v[40:43], v[16:19], a[48:51], v[40:43]
    v_mfma_f32_16x16x32_bf16 v[44:47], v[20:23], a[48:51], v[44:47]
    ds_read_b128 v[16:19], v13 offset:7168
    ds_read_b128 v[20:23], v13 offset:27648
    s_waitcnt lgkmcnt(4)
    v_mfma_f32_16x16x32_bf16 v[40:43], v[24:27], a[52:55], v[40:43]
    v_mfma_f32_16x16x32_bf16 v[44:47], v[28:31], a[52:55], v[44:47]
    ds_read_b128 v[24:27], v12 offset:8192
    ds_read_b128 v[28:31], v12 offset:28672
    s_waitcnt lgkmcnt(4)
    v_mfma_f32_16x16x32_bf16 v[40:43], v[32:35], a[56:59], v[40:43]
    v_mfma_f32_16x16x32_bf16 v[44:47], v[36:39], a[56:59], v[44:47]
    ds_read_b128 v[32:35], v13 offset:8192
    ds_read_b128 v[36:39], v13 offset:28672
    s_waitcnt lgkmcnt(4)
    v_mfma_f32_16x16x32_bf16 v[40:43], v[16:19], a[60:63], v[40:43]
    v_mfma_f32_16x16x32_bf16 v[44:47], v[20:23], a[60:63], v[44:47]
    ds_read_b128 v[16:19], v12 offset:9216
    ds_read_b128 v[20:23], v12 offset:29696
    s_waitcnt lgkmcnt(4)
    v_mfma_f32_16x16x32_bf16 v[40:43], v[24:27], a[64:67], v[40:43]
    v_mfma_f32_16x16x32_bf16 v[44:47], v[28:31], a[64:67], v[44:47]
    ds_read_b128 v[24:27], v13 offset:9216
    ds_read_b128 v[28:31], v13 offset:29696
    s_waitcnt lgkmcnt(4)
    v_mfma_f32_16x16x32_bf16 v[40:43], v[32:35], a[68:71], v[40:43]
    v_mfma_f32_16x16x32_bf16 v[44:47], v[36:39], a[68:71], v[44:47]
    s_waitcnt lgkmcnt(2)
    v_mfma_f32_16x16x32_bf16 v[40:43], v[16:19], a[72:75], v[40:43]
    v_mfma_f32_16x16x32_bf16 v[44:47], v[20:23], a[72:75], v[44:47]
    s_waitcnt lgkmcnt(0)
    v_mfma_f32_16x16x32_bf16 v[40:43], v[24:27], a[76:79], v[40:43]
    v_mfma_f32_16x16x32_bf16 v[44:47], v[28:31], a[76:79], v[44:47]
L_b1j_82:
    s_nop 7
    v_cndmask_b32 v56, v40, v44, s[40:41]
    v_cndmask_b32 v57, v44, v40, s[40:41]
    s_nop 0
    v_mov_b32_dpp v58, v56 row_ror:8 row_mask:0xf bank_mask:0xf
    v_cndmask_b32 v59, v58, v57, s[40:41]
    v_cndmask_b32 v58, v57, v58, s[40:41]
    v_cvt_pk_bf16_f32 v60, v59, v58
    v_cndmask_b32 v56, v41, v45, s[40:41]
    v_cndmask_b32 v57, v45, v41, s[40:41]
    s_nop 0
    v_mov_b32_dpp v58, v56 row_ror:8 row_mask:0xf bank_mask:0xf
    v_cndmask_b32 v59, v58, v57, s[40:41]
    v_cndmask_b32 v58, v57, v58, s[40:41]
    v_cvt_pk_bf16_f32 v61, v59, v58
    v_cndmask_b32 v56, v42, v46, s[40:41]
    v_cndmask_b32 v57, v46, v42, s[40:41]
    s_nop 0
    v_mov_b32_dpp v58, v56 row_ror:8 row_mask:0xf bank_mask:0xf
    v_cndmask_b32 v59, v58, v57, s[40:41]
    v_cndmask_b32 v58, v57, v58, s[40:41]
    v_cvt_pk_bf16_f32 v62, v59, v58
    v_cndmask_b32 v56, v43, v47, s[40:41]
    v_cndmask_b32 v57, v47, v43, s[40:41]
    s_nop 0
    v_mov_b32_dpp v58, v56 row_ror:8 row_mask:0xf bank_mask:0xf
    v_cndmask_b32 v59, v58, v57, s[40:41]
    v_cndmask_b32 v58, v57, v58, s[40:41]
    v_cvt_pk_bf16_f32 v63, v59, v58
    global_store_dword v4, v60, s[32:33] offset:0
    global_store_dword v4, v61, s[32:33] offset:128
    global_store_dword v4, v62, s[32:33] offset:256
    global_store_dword v4, v63, s[32:33] offset:384
    s_add_u32 s32, s32, 4096
    s_addc_u32 s33, s33, 0
    s_xor_b32 s26, s26, 40960
    v_add_u32 v12, s26, v14
    v_add_u32 v13, s26, v15
    s_add_u32 s18, s18, 1
    s_cmp_lt_u32 s18, 64
    s_cbranch_scc1 L_b1_loop
    s_load_dwordx2 s[10:11], s[0:1], 64
    s_load_dwordx2 s[12:13], s[0:1], 72
    s_load_dwordx2 s[14:15], s[0:1], 112
    v_and_b32 v22, 31, v0
    s_lshl_b32 s30, s38, 5
    v_add_u32 v23, s30, v22
    v_lshlrev_b32 v23, 1, v23
    s_waitcnt lgkmcnt(0)
    global_load_ushort v24, v23, s[10:11]
    global_load_ushort v25, v23, s[12:13]
    global_load_ushort v26, v23, s[14:15]
    s_waitcnt vmcnt(0)
    s_barrier
    v_lshlrev_b32 v24, 16, v24
    v_lshlrev_b32 v25, 16, v25
    v_lshlrev_b32 v26, 16, v26
    v_mul_f32 v26, 1069066811, v26
    v_exp_f32 v26, v26
    s_nop 0
    v_cvt_pk_bf16_f32 v26, v26, v26
    v_lshlrev_b32 v26, 16, v26
    v_mul_f32 v27, v26, v24
    v_mul_f32 v28, v26, v25
    v_mul_f32 v27, 1069066811, v27
    v_exp_f32 v27, v27
    v_mul_f32 v28, 1042479491, v28
    v_fract_f32 v28, v28
    v_sin_f32 v29, v28
    v_cos_f32 v30, v28
    s_nop 0
    v_mul_f32 v16, v27, v30
    v_mul_f32 v17, v27, v29
    v_add_f32 v27, -1.0, v16
    v_mul_f32 v28, v24, v24
    v_fmac_f32 v28, v25, v25
    v_rcp_f32 v28, v28
    v_mul_f32 v29, v27, v24
    v_fmac_f32 v29, v17, v25
    v_mul_f32 v30, v17, v24
    v_fma_f32 v30, -v27, v25, v30
    v_mul_f32 v18, v29, v28
    v_mul_f32 v19, v30, v28
    v_add_f32 v18, v18, v18
    v_add_f32 v19, v19, v19
    v_lshrrev_b32 v23, 5, v0
    s_lshl_b32 s10, s5, 1
    v_add_u32 v23, s10, v23
    v_lshlrev_b32 v31, 15, v23
    v_lshl_add_u32 v31, v22, 2, v31
    s_mul_i32 s10, s38, 262144
    s_add_u32 s10, s10, 67108864
    s_add_u32 s32, s8, s10
    s_addc_u32 s33, s9, 0
    s_add_u32 s34, s8, 75497472
    s_addc_u32 s35, s9, 0
    v_mov_b32 v20, 0
    v_mov_b32 v21, 0
    v_mov_b32 v32, v31
    s_mov_b32 s30, 0
    global_load_dword v64, v32, s[32:33] offset:0 sc1
    global_load_dword v65, v32, s[32:33] offset:128 sc1
    global_load_dword v66, v32, s[32:33] offset:256 sc1
    global_load_dword v67, v32, s[32:33] offset:384 sc1
    global_load_dword v68, v32, s[32:33] offset:512 sc1
    global_load_dword v69, v32, s[32:33] offset:640 sc1
    global_load_dword v70, v32, s[32:33] offset:768 sc1
    global_load_dword v71, v32, s[32:33] offset:896 sc1
    global_load_dword v72, v32, s[32:33] offset:1024 sc1
    global_load_dword v73, v32, s[32:33] offset:1152 sc1
    global_load_dword v74, v32, s[32:33] offset:1280 sc1
    global_load_dword v75, v32, s[32:33] offset:1408 sc1
    global_load_dword v76, v32, s[32:33] offset:1536 sc1
    global_load_dword v77, v32, s[32:33] offset:1664 sc1
    global_load_dword v78, v32, s[32:33] offset:1792 sc1
    global_load_dword v79, v32, s[32:33] offset:1920 sc1
    v_add_u32 v32, 2048, v32
L_scan_83:
    global_load_dword v80, v32, s[32:33] offset:0 sc1
    global_load_dword v81, v32, s[32:33] offset:128 sc1
    global_load_dword v82, v32, s[32:33] offset:256 sc1
    global_load_dword v83, v32, s[32:33] offset:384 sc1
    global_load_dword v84, v32, s[32:33] offset:512 sc1
    global_load_dword v85, v32, s[32:33] offset:640 sc1
    global_load_dword v86, v32, s[32:33] offset:768 sc1
    global_load_dword v87, v32, s[32:33] offset:896 sc1
    global_load_dword v88, v32, s[32:33] offset:1024 sc1
    global_load_dword v89, v32, s[32:33] offset:1152 sc1
    global_load_dword v90, v32, s[32:33] offset:1280 sc1
    global_load_dword v91, v32, s[32:33] offset:1408 sc1
    global_load_dword v92, v32, s[32:33] offset:1536 sc1
    global_load_dword v93, v32, s[32:33] offset:1664 sc1
    global_load_dword v94, v32, s[32:33] offset:1792 sc1
    global_load_dword v95, v32, s[32:33] offset:1920 sc1
    v_add_u32 v32, 2048, v32
    s_waitcnt vmcnt(16)
    v_lshlrev_b32 v34, 16, v64
    v_and_b32 v35, 0xffff0000, v64
    v_fma_f32 v34, -v17, v21, v34
    v_fma_f32 v35, v17, v20, v35
    v_fma_f32 v21, v16, v21, v35
    v_fma_f32 v20, v16, v20, v34
    v_lshlrev_b32 v34, 16, v65
    v_and_b32 v35, 0xffff0000, v65
    v_fma_f32 v34, -v17, v21, v34
    v_fma_f32 v35, v17, v20, v35
    v_fma_f32 v21, v16, v21, v35
    v_fma_f32 v20, v16, v20, v34
    v_lshlrev_b32 v34, 16, v66
    v_and_b32 v35, 0xffff0000, v66
    v_fma_f32 v34, -v17, v21, v34
    v_fma_f32 v35, v17, v20, v35
    v_fma_f32 v21, v16, v21, v35
    v_fma_f32 v20, v16, v20, v34
    v_lshlrev_b32 v34, 16, v67
    v_and_b32 v35, 0xffff0000, v67
    v_fma_f32 v34, -v17, v21, v34
    v_fma_f32 v35, v17, v20, v35
    v_fma_f32 v21, v16, v21, v35
    v_fma_f32 v20, v16, v20, v34
    v_lshlrev_b32 v34, 16, v68
    v_and_b32 v35, 0xffff0000, v68
    v_fma_f32 v34, -v17, v21, v34
    v_fma_f32 v35, v17, v20, v35
    v_fma_f32 v21, v16, v21, v35
    v_fma_f32 v20, v16, v20, v34
    v_lshlrev_b32 v34, 16, v69
    v_and_b32 v35, 0xffff0000, v69
    v_fma_f32 v34, -v17, v21, v34
    v_fma_f32 v35, v17, v20, v35
    v_fma_f32 v21, v16, v21, v35
    v_fma_f32 v20, v16, v20, v34
    v_lshlrev_b32 v34, 16, v70
    v_and_b32 v35, 0xffff0000, v70
    v_fma_f32 v34, -v17, v21, v34
    v_fma_f32 v35, v17, v20, v35
    v_fma_f32 v21, v16, v21, v35
    v_fma_f32 v20, v16, v20, v34
    v_lshlrev_b32 v34, 16, v71
    v_and_b32 v35, 0xffff0000, v71
    v_fma_f32 v34, -v17, v21, v34
    v_fma_f32 v35, v17, v20, v35
    v_fma_f32 v21, v16, v21, v35
    v_fma_f32 v20, v16, v20, v34
    v_lshlrev_b32 v34, 16, v72
    v_and_b32 v35, 0xffff0000, v72
    v_fma_f32 v34, -v17, v21, v34
    v_fma_f32 v35, v17, v20, v35
    v_fma_f32 v21, v16, v21, v35
    v_fma_f32 v20, v16, v20, v34
    v_lshlrev_b32 v34, 16, v73
    v_and_b32 v35, 0xffff0000, v73
    v_fma_f32 v34, -v17, v21, v34
    v_fma_f32 v35, v17, v20, v35
    v_fma_f32 v21, v16, v21, v35
    v_fma_f32 v20, v16, v20, v34
    v_lshlrev_b32 v34, 16, v74
    v_and_b32 v35, 0xffff0000, v74
    v_fma_f32 v34, -v17, v21, v34
    v_fma_f32 v35, v17, v20, v35
    v_fma_f32 v21, v16, v21, v35
    v_fma_f32 v20, v16, v20, v34
    v_lshlrev_b32 v34, 16, v75
    v_and_b32 v35, 0xffff0000, v75
    v_fma_f32 v34, -v17, v21, v34
    v_fma_f32 v35, v17, v20, v35
    v_fma_f32 v21, v16, v21, v35
    v_fma_f32 v20, v16, v20, v34
    v_lshlrev_b32 v34, 16, v76
    v_and_b32 v35, 0xffff0000, v76
    v_fma_f32 v34, -v17, v21, v34
    v_fma_f32 v35, v17, v20, v35
    v_fma_f32 v21, v16, v21, v35
    v_fma_f32 v20, v16, v20, v34
    v_lshlrev_b32 v34, 16, v77
    v_and_b32 v35, 0xffff0000, v77
    v_fma_f32 v34, -v17, v21, v34
    v_fma_f32 v35, v17, v20, v35
    v_fma_f32 v21, v16, v21, v35
    v_fma_f32 v20, v16, v20, v34
    v_lshlrev_b32 v34, 16, v78
    v_and_b32 v35, 0xffff0000, v78
    v_fma_f32 v34, -v17, v21, v34
    v_fma_f32 v35, v17, v20, v35
    v_fma_f32 v21, v16, v21, v35
    v_fma_f32 v20, v16, v20, v34
    v_lshlrev_b32 v34, 16, v79
    v_and_b32 v35, 0xffff0000, v79
    v_fma_f32 v34, -v17, v21, v34
    v_fma_f32 v35, v17, v20, v35
    v_fma_f32 v21, v16, v21, v35
    v_fma_f32 v20, v16, v20, v34
    global_load_dword v64, v32, s[32:33] offset:0 sc1
    global_load_dword v65, v32, s[32:33] offset:128 sc1
    global_load_dword v66, v32, s[32:33] offset:256 sc1
    global_load_dword v67, v32, s[32:33] offset:384 sc1
    global_load_dword v68, v32, s[32:33] offset:512 sc1
    global_load_dword v69, v32, s[32:33] offset:640 sc1
    global_load_dword v70, v32, s[32:33] offset:768 sc1
    global_load_dword v71, v32, s[32:33] offset:896 sc1
    global_load_dword v72, v32, s[32:33] offset:1024 sc1
    global_load_dword v73, v32, s[32:33] offset:1152 sc1
    global_load_dword v74, v32, s[32:33] offset:1280 sc1
    global_load_dword v75, v32, s[32:33] offset:1408 sc1
    global_load_dword v76, v32, s[32:33] offset:1536 sc1
    global_load_dword v77, v32, s[32:33] offset:1664 sc1
    global_load_dword v78, v32, s[32:33] offset:1792 sc1
    global_load_dword v79, v32, s[32:33] offset:1920 sc1
    v_add_u32 v32, 2048, v32
    s_waitcnt vmcnt(16)
    v_lshlrev_b32 v34, 16, v80
    v_and_b32 v35, 0xffff0000, v80
    v_fma_f32 v34, -v17, v21, v34
    v_fma_f32 v35, v17, v20, v35
    v_fma_f32 v21, v16, v21, v35
    v_fma_f32 v20, v16, v20, v34
    v_lshlrev_b32 v34, 16, v81
    v_and_b32 v35, 0xffff0000, v81
    v_fma_f32 v34, -v17, v21, v34
    v_fma_f32 v35, v17, v20, v35
    v_fma_f32 v21, v16, v21, v35
    v_fma_f32 v20, v16, v20, v34
    v_lshlrev_b32 v34, 16, v82
    v_and_b32 v35, 0xffff0000, v82
    v_fma_f32 v34, -v17, v21, v34
    v_fma_f32 v35, v17, v20, v35
    v_fma_f32 v21, v16, v21, v35
    v_fma_f32 v20, v16, v20, v34
    v_lshlrev_b32 v34, 16, v83
    v_and_b32 v35, 0xffff0000, v83
    v_fma_f32 v34, -v17, v21, v34
    v_fma_f32 v35, v17, v20, v35
    v_fma_f32 v21, v16, v21, v35
    v_fma_f32 v20, v16, v20, v34
    v_lshlrev_b32 v34, 16, v84
    v_and_b32 v35, 0xffff0000, v84
    v_fma_f32 v34, -v17, v21, v34
    v_fma_f32 v35, v17, v20, v35
    v_fma_f32 v21, v16, v21, v35
    v_fma_f32 v20, v16, v20, v34
    v_lshlrev_b32 v34, 16, v85
    v_and_b32 v35, 0xffff0000, v85
    v_fma_f32 v34, -v17, v21, v34
    v_fma_f32 v35, v17, v20, v35
    v_fma_f32 v21, v16, v21, v35
    v_fma_f32 v20, v16, v20, v34
    v_lshlrev_b32 v34, 16, v86
    v_and_b32 v35, 0xffff0000, v86
    v_fma_f32 v34, -v17, v21, v34
    v_fma_f32 v35, v17, v20, v35
    v_fma_f32 v21, v16, v21, v35
    v_fma_f32 v20, v16, v20, v34
    v_lshlrev_b32 v34, 16, v87
    v_and_b32 v35, 0xffff0000, v87
    v_fma_f32 v34, -v17, v21, v34
    v_fma_f32 v35, v17, v20, v35
    v_fma_f32 v21, v16, v21, v35
    v_fma_f32 v20, v16, v20, v34
    v_lshlrev_b32 v34, 16, v88
    v_and_b32 v35, 0xffff0000, v88
    v_fma_f32 v34, -v17, v21, v34
    v_fma_f32 v35, v17, v20, v35
    v_fma_f32 v21, v16, v21, v35
    v_fma_f32 v20, v16, v20, v34
    v_lshlrev_b32 v34, 16, v89
    v_and_b32 v35, 0xffff0000, v89
    v_fma_f32 v34, -v17, v21, v34
    v_fma_f32 v35, v17, v20, v35
    v_fma_f32 v21, v16, v21, v35
    v_fma_f32 v20, v16, v20, v34
    v_lshlrev_b32 v34, 16, v90
    v_and_b32 v35, 0xffff0000, v90
    v_fma_f32 v34, -v17, v21, v34
    v_fma_f32 v35, v17, v20, v35
    v_fma_f32 v21, v16, v21, v35
    v_fma_f32 v20, v16, v20, v34
    v_lshlrev_b32 v34, 16, v91
    v_and_b32 v35, 0xffff0000, v91
    v_fma_f32 v34, -v17, v21, v34
    v_fma_f32 v35, v17, v20, v35
    v_fma_f32 v21, v16, v21, v35
    v_fma_f32 v20, v16, v20, v34
    v_lshlrev_b32 v34, 16, v92
    v_and_b32 v35, 0xffff0000, v92
    v_fma_f32 v34, -v17, v21, v34
    v_fma_f32 v35, v17, v20, v35
    v_fma_f32 v21, v16, v21, v35
    v_fma_f32 v20, v16, v20, v34
    v_lshlrev_b32 v34, 16, v93
    v_and_b32 v35, 0xffff0000, v93
    v_fma_f32 v34, -v17, v21, v34
    v_fma_f32 v35, v17, v20, v35
    v_fma_f32 v21, v16, v21, v35
    v_fma_f32 v20, v16, v20, v34
    v_lshlrev_b32 v34, 16, v94
    v_and_b32 v35, 0xffff0000, v94
    v_fma_f32 v34, -v17, v21, v34
    v_fma_f32 v35, v17, v20, v35
    v_fma_f32 v21, v16, v21, v35
    v_fma_f32 v20, v16, v20, v34
    v_lshlrev_b32 v34, 16, v95
    v_and_b32 v35, 0xffff0000, v95
    v_fma_f32 v34, -v17, v21, v34
    v_fma_f32 v35, v17, v20, v35
    v_fma_f32 v21, v16, v21, v35
    v_fma_f32 v20, v16, v20, v34
    s_add_u32 s30, s30, 1
    s_cmp_lt_u32 s30, 8
    s_cbranch_scc1 L_scan_83
    s_waitcnt vmcnt(0)
    v_lshlrev_b32 v34, 5, v23
    v_add_u32 v34, v34, v22
    v_lshlrev_b32 v34, 3, v34
    ds_write_b64 v34, v[20:21]
    v_mov_b32 v36, v16
    v_mov_b32 v37, v17
    v_mul_f32 v38, v36, v36
    v_fma_f32 v38, -v37, v37, v38
    v_mul_f32 v39, v36, v37
    v_add_f32 v37, v39, v39
    v_mov_b32 v36, v38
    v_mul_f32 v38, v36, v36
    v_fma_f32 v38, -v37, v37, v38
    v_mul_f32 v39, v36, v37
    v_add_f32 v37, v39, v39
    v_mov_b32 v36, v38
    v_mul_f32 v38, v36, v36
    v_fma_f32 v38, -v37, v37, v38
    v_mul_f32 v39, v36, v37
    v_add_f32 v37, v39, v39
    v_mov_b32 v36, v38
    v_mul_f32 v38, v36, v36
    v_fma_f32 v38, -v37, v37, v38
    v_mul_f32 v39, v36, v37
    v_add_f32 v37, v39, v39
    v_mov_b32 v36, v38
    v_mul_f32 v38, v36, v36
    v_fma_f32 v38, -v37, v37, v38
    v_mul_f32 v39, v36, v37
    v_add_f32 v37, v39, v39
    v_mov_b32 v36, v38
    v_mul_f32 v38, v36, v36
    v_fma_f32 v38, -v37, v37, v38
    v_mul_f32 v39, v36, v37
    v_add_f32 v37, v39, v39
    v_mov_b32 v36, v38
    v_mul_f32 v38, v36, v36
    v_fma_f32 v38, -v37, v37, v38
    v_mul_f32 v39, v36, v37
    v_add_f32 v37, v39, v39
    v_mov_b32 v36, v38
    v_mul_f32 v38, v36, v36
    v_fma_f32 v38, -v37, v37, v38
    v_mul_f32 v39, v36, v37
    v_add_f32 v37, v39, v39
    v_mov_b32 v36, v38
    s_waitcnt lgkmcnt(0)
    s_barrier
    v_lshlrev_b32 v34, 3, v22
    ds_read_b64 v[40:41], v34 offset:0
    ds_read_b64 v[42:43], v34 offset:256
    ds_read_b64 v[44:45], v34 offset:512
    ds_read_b64 v[46:47], v34 offset:768
    ds_read_b64 v[48:49], v34 offset:1024
    ds_read_b64 v[50:51], v34 offset:1280
    ds_read_b64 v[52:53], v34 offset:1536
    s_waitcnt lgkmcnt(0)
    v_mov_b32 v20, 0
    v_mov_b32 v21, 0
    v_mul_f32 v38, v36, v20
    v_fma_f32 v38, -v37, v21, v38
    v_mul_f32 v39, v37, v20
    v_fma_f32 v39, v36, v21, v39
    v_add_f32 v38, v38, v40
    v_add_f32 v39, v39, v41
    v_cmp_lt_u32 vcc, 0, v23
    s_nop 1
    v_cndmask_b32 v20, v20, v38, vcc
    v_cndmask_b32 v21, v21, v39, vcc
    v_mul_f32 v38, v36, v20
    v_fma_f32 v38, -v37, v21, v38
    v_mul_f32 v39, v37, v20
    v_fma_f32 v39, v36, v21, v39
    v_add_f32 v38, v38, v42
    v_add_f32 v39, v39, v43
    v_cmp_lt_u32 vcc, 1, v23
    s_nop 1
    v_cndmask_b32 v20, v20, v38, vcc
    v_cndmask_b32 v21, v21, v39, vcc
    v_mul_f32 v38, v36, v20
    v_fma_f32 v38, -v37, v21, v38
    v_mul_f32 v39, v37, v20
    v_fma_f32 v39, v36, v21, v39
    v_add_f32 v38, v38, v44
    v_add_f32 v39, v39, v45
    v_cmp_lt_u32 vcc, 2, v23
    s_nop 1
    v_cndmask_b32 v20, v20, v38, vcc
    v_cndmask_b32 v21, v21, v39, vcc
    v_mul_f32 v38, v36, v20
    v_fma_f32 v38, -v37, v21, v38
    v_mul_f32 v39, v37, v20
    v_fma_f32 v39, v36, v21, v39
    v_add_f32 v38, v38, v46
    v_add_f32 v39, v39, v47
    v_cmp_lt_u32 vcc, 3, v23
    s_nop 1
    v_cndmask_b32 v20, v20, v38, vcc
    v_cndmask_b32 v21, v21, v39, vcc
    v_mul_f32 v38, v36, v20
    v_fma_f32 v38, -v37, v21, v38
    v_mul_f32 v39, v37, v20
    v_fma_f32 v39, v36, v21, v39
    v_add_f32 v38, v38, v48
    v_add_f32 v39, v39, v49
    v_cmp_lt_u32 vcc, 4, v23
    s_nop 1
    v_cndmask_b32 v20, v20, v38, vcc
    v_cndmask_b32 v21, v21, v39, vcc
    v_mul_f32 v38, v36, v20
    v_fma_f32 v38, -v37, v21, v38
    v_mul_f32 v39, v37, v20
    v_fma_f32 v39, v36, v21, v39
    v_add_f32 v38, v38, v50
    v_add_f32 v39, v39, v51
    v_cmp_lt_u32 vcc, 5, v23
    s_nop 1
    v_cndmask_b32 v20, v20, v38, vcc
    v_cndmask_b32 v21, v21, v39, vcc
    v_mul_f32 v38, v36, v20
    v_fma_f32 v38, -v37, v21, v38
    v_mul_f32 v39, v37, v20
    v_fma_f32 v39, v36, v21, v39
    v_add_f32 v38, v38, v52
    v_add_f32 v39, v39, v53
    v_cmp_lt_u32 vcc, 6, v23
    s_nop 1
    v_cndmask_b32 v20, v20, v38, vcc
    v_cndmask_b32 v21, v21, v39, vcc
    v_mov_b32 v32, v31
    s_mov_b32 s30, 0
    v_mul_u32_u24 v33, 2560, v23
    v_lshlrev_b32 v33, 8, v33
    s_lshl_b32 s10, s38, 7
    v_lshl_add_u32 v33, v22, 2, v33
    v_add_u32 v33, s10, v33
    global_load_dword v64, v32, s[32:33] offset:0 sc1
    global_load_dword v65, v32, s[32:33] offset:128 sc1
    global_load_dword v66, v32, s[32:33] offset:256 sc1
    global_load_dword v67, v32, s[32:33] offset:384 sc1
    global_load_dword v68, v32, s[32:33] offset:512 sc1
    global_load_dword v69, v32, s[32:33] offset:640 sc1
    global_load_dword v70, v32, s[32:33] offset:768 sc1
    global_load_dword v71, v32, s[32:33] offset:896 sc1
    global_load_dword v72, v32, s[32:33] offset:1024 sc1
    global_load_dword v73, v32, s[32:33] offset:1152 sc1
    global_load_dword v74, v32, s[32:33] offset:1280 sc1
    global_load_dword v75, v32, s[32:33] offset:1408 sc1
    global_load_dword v76, v32, s[32:33] offset:1536 sc1
    global_load_dword v77, v32, s[32:33] offset:1664 sc1
    global_load_dword v78, v32, s[32:33] offset:1792 sc1
    global_load_dword v79, v32, s[32:33] offset:1920 sc1
    v_add_u32 v32, 2048, v32
L_scan_84:
    global_load_dword v80, v32, s[32:33] offset:0 sc1
    global_load_dword v81, v32, s[32:33] offset:128 sc1
    global_load_dword v82, v32, s[32:33] offset:256 sc1
    global_load_dword v83, v32, s[32:33] offset:384 sc1
    global_load_dword v84, v32, s[32:33] offset:512 sc1
    global_load_dword v85, v32, s[32:33] offset:640 sc1
    global_load_dword v86, v32, s[32:33] offset:768 sc1
    global_load_dword v87, v32, s[32:33] offset:896 sc1
    global_load_dword v88, v32, s[32:33] offset:1024 sc1
    global_load_dword v89, v32, s[32:33] offset:1152 sc1
    global_load_dword v90, v32, s[32:33] offset:1280 sc1
    global_load_dword v91, v32, s[32:33] offset:1408 sc1
    global_load_dword v92, v32, s[32:33] offset:1536 sc1
    global_load_dword v93, v32, s[32:33] offset:1664 sc1
    global_load_dword v94, v32, s[32:33] offset:1792 sc1
    global_load_dword v95, v32, s[32:33] offset:1920 sc1
    v_add_u32 v32, 2048, v32
    s_waitcnt vmcnt(16)
    v_lshlrev_b32 v34, 16, v64
    v_and_b32 v35, 0xffff0000, v64
    v_fma_f32 v34, -v17, v21, v34
    v_fma_f32 v35, v17, v20, v35
    v_fma_f32 v21, v16, v21, v35
    v_fma_f32 v20, v16, v20, v34
    v_mul_f32 v36, v18, v20
    v_mul_f32 v37, v19, v20
    v_fma_f32 v36, -v19, v21, v36
    v_fma_f32 v37, v18, v21, v37
    v_cvt_pk_bf16_f32 v64, v36, -v37
    v_lshlrev_b32 v34, 16, v65
    v_and_b32 v35, 0xffff0000, v65
    v_fma_f32 v34, -v17, v21, v34
    v_fma_f32 v35, v17, v20, v35
    v_fma_f32 v21, v16, v21, v35
    v_fma_f32 v20, v16, v20, v34
    v_mul_f32 v36, v18, v20
    v_mul_f32 v37, v19, v20
    v_fma_f32 v36, -v19, v21, v36
    v_fma_f32 v37, v18, v21, v37
    v_cvt_pk_bf16_f32 v65, v36, -v37
    v_lshlrev_b32 v34, 16, v66
    v_and_b32 v35, 0xffff0000, v66
    v_fma_f32 v34, -v17, v21, v34
    v_fma_f32 v35, v17, v20, v35
    v_fma_f32 v21, v16, v21, v35
    v_fma_f32 v20, v16, v20, v34
    v_mul_f32 v36, v18, v20
    v_mul_f32 v37, v19, v20
    v_fma_f32 v36, -v19, v21, v36
    v_fma_f32 v37, v18, v21, v37
    v_cvt_pk_bf16_f32 v66, v36, -v37
    v_lshlrev_b32 v34, 16, v67
    v_and_b32 v35, 0xffff0000, v67
    v_fma_f32 v34, -v17, v21, v34
    v_fma_f32 v35, v17, v20, v35
    v_fma_f32 v21, v16, v21, v35
    v_fma_f32 v20, v16, v20, v34
    v_mul_f32 v36, v18, v20
    v_mul_f32 v37, v19, v20
    v_fma_f32 v36, -v19, v21, v36
    v_fma_f32 v37, v18, v21, v37
    v_cvt_pk_bf16_f32 v67, v36, -v37
    v_lshlrev_b32 v34, 16, v68
    v_and_b32 v35, 0xffff0000, v68
    v_fma_f32 v34, -v17, v21, v34
    v_fma_f32 v35, v17, v20, v35
    v_fma_f32 v21, v16, v21, v35
    v_fma_f32 v20, v16, v20, v34
    v_mul_f32 v36, v18, v20
    v_mul_f32 v37, v19, v20
    v_fma_f32 v36, -v19, v21, v36
    v_fma_f32 v37, v18, v21, v37
    v_cvt_pk_bf16_f32 v68, v36, -v37
    v_lshlrev_b32 v34, 16, v69
    v_and_b32 v35, 0xffff0000, v69
    v_fma_f32 v34, -v17, v21, v34
    v_fma_f32 v35, v17, v20, v35
    v_fma_f32 v21, v16, v21, v35
    v_fma_f32 v20, v16, v20, v34
    v_mul_f32 v36, v18, v20
    v_mul_f32 v37, v19, v20
    v_fma_f32 v36, -v19, v21, v36
    v_fma_f32 v37, v18, v21, v37
    v_cvt_pk_bf16_f32 v69, v36, -v37
    v_lshlrev_b32 v34, 16, v70
    v_and_b32 v35, 0xffff0000, v70
    v_fma_f32 v34, -v17, v21, v34
    v_fma_f32 v35, v17, v20, v35
    v_fma_f32 v21, v16, v21, v35
    v_fma_f32 v20, v16, v20, v34
    v_mul_f32 v36, v18, v20
    v_mul_f32 v37, v19, v20
    v_fma_f32 v36, -v19, v21, v36
    v_fma_f32 v37, v18, v21, v37
    v_cvt_pk_bf16_f32 v70, v36, -v37
    v_lshlrev_b32 v34, 16, v71
    v_and_b32 v35, 0xffff0000, v71
    v_fma_f32 v34, -v17, v21, v34
    v_fma_f32 v35, v17, v20, v35
    v_fma_f32 v21, v16, v21, v35
    v_fma_f32 v20, v16, v20, v34
    v_mul_f32 v36, v18, v20
    v_mul_f32 v37, v19, v20
    v_fma_f32 v36, -v19, v21, v36
    v_fma_f32 v37, v18, v21, v37
    v_cvt_pk_bf16_f32 v71, v36, -v37
    v_lshlrev_b32 v34, 16, v72
    v_and_b32 v35, 0xffff0000, v72
    v_fma_f32 v34, -v17, v21, v34
    v_fma_f32 v35, v17, v20, v35
    v_fma_f32 v21, v16, v21, v35
    v_fma_f32 v20, v16, v20, v34
    v_mul_f32 v36, v18, v20
    v_mul_f32 v37, v19, v20
    v_fma_f32 v36, -v19, v21, v36
    v_fma_f32 v37, v18, v21, v37
    v_cvt_pk_bf16_f32 v72, v36, -v37
    v_lshlrev_b32 v34, 16, v73
    v_and_b32 v35, 0xffff0000, v73
    v_fma_f32 v34, -v17, v21, v34
    v_fma_f32 v35, v17, v20, v35
    v_fma_f32 v21, v16, v21, v35
    v_fma_f32 v20, v16, v20, v34
    v_mul_f32 v36, v18, v20
    v_mul_f32 v37, v19, v20
    v_fma_f32 v36, -v19, v21, v36
    v_fma_f32 v37, v18, v21, v37
    v_cvt_pk_bf16_f32 v73, v36, -v37
    v_lshlrev_b32 v34, 16, v74
    v_and_b32 v35, 0xffff0000, v74
    v_fma_f32 v34, -v17, v21, v34
    v_fma_f32 v35, v17, v20, v35
    v_fma_f32 v21, v16, v21, v35
    v_fma_f32 v20, v16, v20, v34
    v_mul_f32 v36, v18, v20
    v_mul_f32 v37, v19, v20
    v_fma_f32 v36, -v19, v21, v36
    v_fma_f32 v37, v18, v21, v37
    v_cvt_pk_bf16_f32 v74, v36, -v37
    v_lshlrev_b32 v34, 16, v75
    v_and_b32 v35, 0xffff0000, v75
    v_fma_f32 v34, -v17, v21, v34
    v_fma_f32 v35, v17, v20, v35
    v_fma_f32 v21, v16, v21, v35
    v_fma_f32 v20, v16, v20, v34
    v_mul_f32 v36, v18, v20
    v_mul_f32 v37, v19, v20
    v_fma_f32 v36, -v19, v21, v36
    v_fma_f32 v37, v18, v21, v37
    v_cvt_pk_bf16_f32 v75, v36, -v37
    v_lshlrev_b32 v34, 16, v76
    v_and_b32 v35, 0xffff0000, v76
    v_fma_f32 v34, -v17, v21, v34
    v_fma_f32 v35, v17, v20, v35
    v_fma_f32 v21, v16, v21, v35
    v_fma_f32 v20, v16, v20, v34
    v_mul_f32 v36, v18, v20
    v_mul_f32 v37, v19, v20
    v_fma_f32 v36, -v19, v21, v36
    v_fma_f32 v37, v18, v21, v37
    v_cvt_pk_bf16_f32 v76, v36, -v37
    v_lshlrev_b32 v34, 16, v77
    v_and_b32 v35, 0xffff0000, v77
    v_fma_f32 v34, -v17, v21, v34
    v_fma_f32 v35, v17, v20, v35
    v_fma_f32 v21, v16, v21, v35
    v_fma_f32 v20, v16, v20, v34
    v_mul_f32 v36, v18, v20
    v_mul_f32 v37, v19, v20
    v_fma_f32 v36, -v19, v21, v36
    v_fma_f32 v37, v18, v21, v37
    v_cvt_pk_bf16_f32 v77, v36, -v37
    v_lshlrev_b32 v34, 16, v78
    v_and_b32 v35, 0xffff0000, v78
    v_fma_f32 v34, -v17, v21, v34
    v_fma_f32 v35, v17, v20, v35
    v_fma_f32 v21, v16, v21, v35
    v_fma_f32 v20, v16, v20, v34
    v_mul_f32 v36, v18, v20
    v_mul_f32 v37, v19, v20
    v_fma_f32 v36, -v19, v21, v36
    v_fma_f32 v37, v18, v21, v37
    v_cvt_pk_bf16_f32 v78, v36, -v37
    v_lshlrev_b32 v34, 16, v79
    v_and_b32 v35, 0xffff0000, v79
    v_fma_f32 v34, -v17, v21, v34
    v_fma_f32 v35, v17, v20, v35
    v_fma_f32 v21, v16, v21, v35
    v_fma_f32 v20, v16, v20, v34
    v_mul_f32 v36, v18, v20
    v_mul_f32 v37, v19, v20
    v_fma_f32 v36, -v19, v21, v36
    v_fma_f32 v37, v18, v21, v37
    v_cvt_pk_bf16_f32 v79, v36, -v37
    global_store_dword v33, v64, s[34:35]
    global_store_dword v33, v65, s[34:35] offset:2560
    v_add_u32 v33, 5120, v33
    global_store_dword v33, v66, s[34:35]
    global_store_dword v33, v67, s[34:35] offset:2560
    v_add_u32 v33, 5120, v33
    global_store_dword v33, v68, s[34:35]
    global_store_dword v33, v69, s[34:35] offset:2560
    v_add_u32 v33, 5120, v33
    global_store_dword v33, v70, s[34:35]
    global_store_dword v33, v71, s[34:35] offset:2560
    v_add_u32 v33, 5120, v33
    global_store_dword v33, v72, s[34:35]
    global_store_dword v33, v73, s[34:35] offset:2560
    v_add_u32 v33, 5120, v33
    global_store_dword v33, v74, s[34:35]
    global_store_dword v33, v75, s[34:35] offset:2560
    v_add_u32 v33, 5120, v33
    global_store_dword v33, v76, s[34:35]
    global_store_dword v33, v77, s[34:35] offset:2560
    v_add_u32 v33, 5120, v33
    global_store_dword v33, v78, s[34:35]
    global_store_dword v33, v79, s[34:35] offset:2560
    v_add_u32 v33, 5120, v33
    global_load_dword v64, v32, s[32:33] offset:0 sc1
    global_load_dword v65, v32, s[32:33] offset:128 sc1
    global_load_dword v66, v32, s[32:33] offset:256 sc1
    global_load_dword v67, v32, s[32:33] offset:384 sc1
    global_load_dword v68, v32, s[32:33] offset:512 sc1
    global_load_dword v69, v32, s[32:33] offset:640 sc1
    global_load_dword v70, v32, s[32:33] offset:768 sc1
    global_load_dword v71, v32, s[32:33] offset:896 sc1
    global_load_dword v72, v32, s[32:33] offset:1024 sc1
    global_load_dword v73, v32, s[32:33] offset:1152 sc1
    global_load_dword v74, v32, s[32:33] offset:1280 sc1
    global_load_dword v75, v32, s[32:33] offset:1408 sc1
    global_load_dword v76, v32, s[32:33] offset:1536 sc1
    global_load_dword v77, v32, s[32:33] offset:1664 sc1
    global_load_dword v78, v32, s[32:33] offset:1792 sc1
    global_load_dword v79, v32, s[32:33] offset:1920 sc1
    v_add_u32 v32, 2048, v32
    s_waitcnt vmcnt(16)
    v_lshlrev_b32 v34, 16, v80
    v_and_b32 v35, 0xffff0000, v80
    v_fma_f32 v34, -v17, v21, v34
    v_fma_f32 v35, v17, v20, v35
    v_fma_f32 v21, v16, v21, v35
    v_fma_f32 v20, v16, v20, v34
    v_mul_f32 v36, v18, v20
    v_mul_f32 v37, v19, v20
    v_fma_f32 v36, -v19, v21, v36
    v_fma_f32 v37, v18, v21, v37
    v_cvt_pk_bf16_f32 v80, v36, -v37
    v_lshlrev_b32 v34, 16, v81
    v_and_b32 v35, 0xffff0000, v81
    v_fma_f32 v34, -v17, v21, v34
    v_fma_f32 v35, v17, v20, v35
    v_fma_f32 v21, v16, v21, v35
    v_fma_f32 v20, v16, v20, v34
    v_mul_f32 v36, v18, v20
    v_mul_f32 v37, v19, v20
    v_fma_f32 v36, -v19, v21, v36
    v_fma_f32 v37, v18, v21, v37
    v_cvt_pk_bf16_f32 v81, v36, -v37
    v_lshlrev_b32 v34, 16, v82
    v_and_b32 v35, 0xffff0000, v82
    v_fma_f32 v34, -v17, v21, v34
    v_fma_f32 v35, v17, v20, v35
    v_fma_f32 v21, v16, v21, v35
    v_fma_f32 v20, v16, v20, v34
    v_mul_f32 v36, v18, v20
    v_mul_f32 v37, v19, v20
    v_fma_f32 v36, -v19, v21, v36
    v_fma_f32 v37, v18, v21, v37
    v_cvt_pk_bf16_f32 v82, v36, -v37
    v_lshlrev_b32 v34, 16, v83
    v_and_b32 v35, 0xffff0000, v83
    v_fma_f32 v34, -v17, v21, v34
    v_fma_f32 v35, v17, v20, v35
    v_fma_f32 v21, v16, v21, v35
    v_fma_f32 v20, v16, v20, v34
    v_mul_f32 v36, v18, v20
    v_mul_f32 v37, v19, v20
    v_fma_f32 v36, -v19, v21, v36
    v_fma_f32 v37, v18, v21, v37
    v_cvt_pk_bf16_f32 v83, v36, -v37
    v_lshlrev_b32 v34, 16, v84
    v_and_b32 v35, 0xffff0000, v84
    v_fma_f32 v34, -v17, v21, v34
    v_fma_f32 v35, v17, v20, v35
    v_fma_f32 v21, v16, v21, v35
    v_fma_f32 v20, v16, v20, v34
    v_mul_f32 v36, v18, v20
    v_mul_f32 v37, v19, v20
    v_fma_f32 v36, -v19, v21, v36
    v_fma_f32 v37, v18, v21, v37
    v_cvt_pk_bf16_f32 v84, v36, -v37
    v_lshlrev_b32 v34, 16, v85
    v_and_b32 v35, 0xffff0000, v85
    v_fma_f32 v34, -v17, v21, v34
    v_fma_f32 v35, v17, v20, v35
    v_fma_f32 v21, v16, v21, v35
    v_fma_f32 v20, v16, v20, v34
    v_mul_f32 v36, v18, v20
    v_mul_f32 v37, v19, v20
    v_fma_f32 v36, -v19, v21, v36
    v_fma_f32 v37, v18, v21, v37
    v_cvt_pk_bf16_f32 v85, v36, -v37
    v_lshlrev_b32 v34, 16, v86
    v_and_b32 v35, 0xffff0000, v86
    v_fma_f32 v34, -v17, v21, v34
    v_fma_f32 v35, v17, v20, v35
    v_fma_f32 v21, v16, v21, v35
    v_fma_f32 v20, v16, v20, v34
    v_mul_f32 v36, v18, v20
    v_mul_f32 v37, v19, v20
    v_fma_f32 v36, -v19, v21, v36
    v_fma_f32 v37, v18, v21, v37
    v_cvt_pk_bf16_f32 v86, v36, -v37
    v_lshlrev_b32 v34, 16, v87
    v_and_b32 v35, 0xffff0000, v87
    v_fma_f32 v34, -v17, v21, v34
    v_fma_f32 v35, v17, v20, v35
    v_fma_f32 v21, v16, v21, v35
    v_fma_f32 v20, v16, v20, v34
    v_mul_f32 v36, v18, v20
    v_mul_f32 v37, v19, v20
    v_fma_f32 v36, -v19, v21, v36
    v_fma_f32 v37, v18, v21, v37
    v_cvt_pk_bf16_f32 v87, v36, -v37
    v_lshlrev_b32 v34, 16, v88
    v_and_b32 v35, 0xffff0000, v88
    v_fma_f32 v34, -v17, v21, v34
    v_fma_f32 v35, v17, v20, v35
    v_fma_f32 v21, v16, v21, v35
    v_fma_f32 v20, v16, v20, v34
    v_mul_f32 v36, v18, v20
    v_mul_f32 v37, v19, v20
    v_fma_f32 v36, -v19, v21, v36
    v_fma_f32 v37, v18, v21, v37
    v_cvt_pk_bf16_f32 v88, v36, -v37
    v_lshlrev_b32 v34, 16, v89
    v_and_b32 v35, 0xffff0000, v89
    v_fma_f32 v34, -v17, v21, v34
    v_fma_f32 v35, v17, v20, v35
    v_fma_f32 v21, v16, v21, v35
    v_fma_f32 v20, v16, v20, v34
    v_mul_f32 v36, v18, v20
    v_mul_f32 v37, v19, v20
    v_fma_f32 v36, -v19, v21, v36
    v_fma_f32 v37, v18, v21, v37
    v_cvt_pk_bf16_f32 v89, v36, -v37
    v_lshlrev_b32 v34, 16, v90
    v_and_b32 v35, 0xffff0000, v90
    v_fma_f32 v34, -v17, v21, v34
    v_fma_f32 v35, v17, v20, v35
    v_fma_f32 v21, v16, v21, v35
    v_fma_f32 v20, v16, v20, v34
    v_mul_f32 v36, v18, v20
    v_mul_f32 v37, v19, v20
    v_fma_f32 v36, -v19, v21, v36
    v_fma_f32 v37, v18, v21, v37
    v_cvt_pk_bf16_f32 v90, v36, -v37
    v_lshlrev_b32 v34, 16, v91
    v_and_b32 v35, 0xffff0000, v91
    v_fma_f32 v34, -v17, v21, v34
    v_fma_f32 v35, v17, v20, v35
    v_fma_f32 v21, v16, v21, v35
    v_fma_f32 v20, v16, v20, v34
    v_mul_f32 v36, v18, v20
    v_mul_f32 v37, v19, v20
    v_fma_f32 v36, -v19, v21, v36
    v_fma_f32 v37, v18, v21, v37
    v_cvt_pk_bf16_f32 v91, v36, -v37
    v_lshlrev_b32 v34, 16, v92
    v_and_b32 v35, 0xffff0000, v92
    v_fma_f32 v34, -v17, v21, v34
    v_fma_f32 v35, v17, v20, v35
    v_fma_f32 v21, v16, v21, v35
    v_fma_f32 v20, v16, v20, v34
    v_mul_f32 v36, v18, v20
    v_mul_f32 v37, v19, v20
    v_fma_f32 v36, -v19, v21, v36
    v_fma_f32 v37, v18, v21, v37
    v_cvt_pk_bf16_f32 v92, v36, -v37
    v_lshlrev_b32 v34, 16, v93
    v_and_b32 v35, 0xffff0000, v93
    v_fma_f32 v34, -v17, v21, v34
    v_fma_f32 v35, v17, v20, v35
    v_fma_f32 v21, v16, v21, v35
    v_fma_f32 v20, v16, v20, v34
    v_mul_f32 v36, v18, v20
    v_mul_f32 v37, v19, v20
    v_fma_f32 v36, -v19, v21, v36
    v_fma_f32 v37, v18, v21, v37
    v_cvt_pk_bf16_f32 v93, v36, -v37
    v_lshlrev_b32 v34, 16, v94
    v_and_b32 v35, 0xffff0000, v94
    v_fma_f32 v34, -v17, v21, v34
    v_fma_f32 v35, v17, v20, v35
    v_fma_f32 v21, v16, v21, v35
    v_fma_f32 v20, v16, v20, v34
    v_mul_f32 v36, v18, v20
    v_mul_f32 v37, v19, v20
    v_fma_f32 v36, -v19, v21, v36
    v_fma_f32 v37, v18, v21, v37
    v_cvt_pk_bf16_f32 v94, v36, -v37
    v_lshlrev_b32 v34, 16, v95
    v_and_b32 v35, 0xffff0000, v95
    v_fma_f32 v34, -v17, v21, v34
    v_fma_f32 v35, v17, v20, v35
    v_fma_f32 v21, v16, v21, v35
    v_fma_f32 v20, v16, v20, v34
    v_mul_f32 v36, v18, v20
    v_mul_f32 v37, v19, v20
    v_fma_f32 v36, -v19, v21, v36
    v_fma_f32 v37, v18, v21, v37
    v_cvt_pk_bf16_f32 v95, v36, -v37
    global_store_dword v33, v80, s[34:35]
    global_store_dword v33, v81, s[34:35] offset:2560
    v_add_u32 v33, 5120, v33
    global_store_dword v33, v82, s[34:35]
    global_store_dword v33, v83, s[34:35] offset:2560
    v_add_u32 v33, 5120, v33
    global_store_dword v33, v84, s[34:35]
    global_store_dword v33, v85, s[34:35] offset:2560
    v_add_u32 v33, 5120, v33
    global_store_dword v33, v86, s[34:35]
    global_store_dword v33, v87, s[34:35] offset:2560
    v_add_u32 v33, 5120, v33
    global_store_dword v33, v88, s[34:35]
    global_store_dword v33, v89, s[34:35] offset:2560
    v_add_u32 v33, 5120, v33
    global_store_dword v33, v90, s[34:35]
    global_store_dword v33, v91, s[34:35] offset:2560
    v_add_u32 v33, 5120, v33
    global_store_dword v33, v92, s[34:35]
    global_store_dword v33, v93, s[34:35] offset:2560
    v_add_u32 v33, 5120, v33
    global_store_dword v33, v94, s[34:35]
    global_store_dword v33, v95, s[34:35] offset:2560
    v_add_u32 v33, 5120, v33
    s_add_u32 s30, s30, 1
    s_cmp_lt_u32 s30, 8
    s_cbranch_scc1 L_scan_84
    s_waitcnt vmcnt(0)
    s_waitcnt vmcnt(0)
    s_barrier
    s_cmp_eq_u32 s5, 0
    s_cbranch_scc0 L_wb_85
    buffer_wbl2 sc1
    s_waitcnt vmcnt(0)
L_wb_85:
    s_mov_b32 s30, 1
    s_cmp_eq_u32 s5, 0
    s_cbranch_scc0 L_fl_86
    v_mov_b32 v5, s36
    v_mov_b32 v6, s30
    s_mov_b64 exec, 1
    global_store_dword v5, v6, s[22:23] sc1
    s_mov_b64 exec, -1
L_fl_86:
L_b2:
    s_mul_i32 s43, s38, 52
    s_lshr_b32 s43, s43, 8
    s_mul_i32 s10, s43, 5
    s_sub_u32 s42, s38, s10
    s_load_dwordx2 s[44:45], s[0:1], 96
    s_load_dwordx2 s[46:47], s[0:1], 104
    s_load_dwordx2 s[48:49], s[0:1], 120
    s_load_dwordx2 s[50:51], s[0:1], 56
    s_load_dwordx2 s[52:53], s[0:1], 128
    s_lshl_b32 s10, s42, 7
    s_lshl_b32 s11, s5, 5
    s_add_u32 s54, s10, s11
    v_and_b32 v17, 15, v0
    v_lshlrev_b32 v17, 1, v17
    v_add_u32 v17, s54, v17
    v_mul_u32_u24 v16, 1280, v17
    v_lshrrev_b32 v18, 4, v0
    v_lshl_add_u32 v16, v18, 3, v16
    s_mov_b32 s24, 0x05040100
    s_mov_b32 s25, 0x07060302
    s_waitcnt lgkmcnt(0)
    global_load_dwordx2 v[64:65], v16, s[44:45] offset:0
    global_load_dwordx2 v[66:67], v16, s[46:47] offset:0
    global_load_dwordx2 v[68:69], v16, s[44:45] offset:1280
    global_load_dwordx2 v[70:71], v16, s[46:47] offset:1280
    global_load_dwordx2 v[72:73], v16, s[44:45] offset:32
    global_load_dwordx2 v[74:75], v16, s[46:47] offset:32
    global_load_dwordx2 v[76:77], v16, s[44:45] offset:1312
    global_load_dwordx2 v[78:79], v16, s[46:47] offset:1312
    global_load_dwordx2 v[80:81], v16, s[44:45] offset:64
    global_load_dwordx2 v[82:83], v16, s[46:47] offset:64
    global_load_dwordx2 v[84:85], v16, s[44:45] offset:1344
    global_load_dwordx2 v[86:87], v16, s[46:47] offset:1344
    global_load_dwordx2 v[88:89], v16, s[44:45] offset:96
    global_load_dwordx2 v[90:91], v16, s[46:47] offset:96
    global_load_dwordx2 v[92:93], v16, s[44:45] offset:1376
    global_load_dwordx2 v[94:95], v16, s[46:47] offset:1376
    global_load_dwordx2 v[96:97], v16, s[44:45] offset:128
    global_load_dwordx2 v[98:99], v16, s[46:47] offset:128
    global_load_dwordx2 v[100:101], v16, s[44:45] offset:1408
    global_load_dwordx2 v[102:103], v16, s[46:47] offset:1408
    global_load_dwordx2 v[104:105], v16, s[44:45] offset:160
    global_load_dwordx2 v[106:107], v16, s[46:47] offset:160
    global_load_dwordx2 v[108:109], v16, s[44:45] offset:1440
    global_load_dwordx2 v[110:111], v16, s[46:47] offset:1440
    global_load_dwordx2 v[112:113], v16, s[44:45] offset:192
    global_load_dwordx2 v[114:115], v16, s[46:47] offset:192
    global_load_dwordx2 v[116:117], v16, s[44:45] offset:1472
    global_load_dwordx2 v[118:119], v16, s[46:47] offset:1472
    global_load_dwordx2 v[120:121], v16, s[44:45] offset:224
    global_load_dwordx2 v[122:123], v16, s[46:47] offset:224
    global_load_dwordx2 v[124:125], v16, s[44:45] offset:1504
    global_load_dwordx2 v[126:127], v16, s[46:47] offset:1504
    global_load_dwordx2 v[128:129], v16, s[44:45] offset:256
    global_load_dwordx2 v[130:131], v16, s[46:47] offset:256
    global_load_dwordx2 v[132:133], v16, s[44:45] offset:1536
    global_load_dwordx2 v[134:135], v16, s[46:47] offset:1536
    global_load_dwordx2 v[136:137], v16, s[44:45] offset:288
    global_load_dwordx2 v[138:139], v16, s[46:47] offset:288
    global_load_dwordx2 v[140:141], v16, s[44:45] offset:1568
    global_load_dwordx2 v[142:143], v16, s[46:47] offset:1568
    global_load_dwordx2 v[144:145], v16, s[44:45] offset:320
    global_load_dwordx2 v[146:147], v16, s[46:47] offset:320
    global_load_dwordx2 v[148:149], v16, s[44:45] offset:1600
    global_load_dwordx2 v[150:151], v16, s[46:47] offset:1600
    global_load_dwordx2 v[152:153], v16, s[44:45] offset:352
    global_load_dwordx2 v[154:155], v16, s[46:47] offset:352
    global_load_dwordx2 v[156:157], v16, s[44:45] offset:1632
    global_load_dwordx2 v[158:159], v16, s[46:47] offset:1632
    s_waitcnt vmcnt(32)
    v_perm_b32 v20, v66, v64, s24
    v_accvgpr_write_b32 a0, v20
    v_perm_b32 v21, v66, v64, s25
    v_accvgpr_write_b32 a1, v21
    v_perm_b32 v20, v67, v65, s24
    v_accvgpr_write_b32 a2, v20
    v_perm_b32 v21, v67, v65, s25
    v_accvgpr_write_b32 a3, v21
    v_perm_b32 v20, v70, v68, s24
    v_accvgpr_write_b32 a4, v20
    v_perm_b32 v21, v70, v68, s25
    v_accvgpr_write_b32 a5, v21
    v_perm_b32 v20, v71, v69, s24
    v_accvgpr_write_b32 a6, v20
    v_perm_b32 v21, v71, v69, s25
    v_accvgpr_write_b32 a7, v21
    v_perm_b32 v20, v74, v72, s24
    v_accvgpr_write_b32 a8, v20
    v_perm_b32 v21, v74, v72, s25
    v_accvgpr_write_b32 a9, v21
    v_perm_b32 v20, v75, v73, s24
    v_accvgpr_write_b32 a10, v20
    v_perm_b32 v21, v75, v73, s25
    v_accvgpr_write_b32 a11, v21
    v_perm_b32 v20, v78, v76, s24
    v_accvgpr_write_b32 a12, v20
    v_perm_b32 v21, v78, v76, s25
    v_accvgpr_write_b32 a13, v21
    v_perm_b32 v20, v79, v77, s24
    v_accvgpr_write_b32 a14, v20
    v_perm_b32 v21, v79, v77, s25
    v_accvgpr_write_b32 a15, v21
    v_perm_b32 v20, v82, v80, s24
    v_accvgpr_write_b32 a16, v20
    v_perm_b32 v21, v82, v80, s25
    v_accvgpr_write_b32 a17, v21
    v_perm_b32 v20, v83, v81, s24
    v_accvgpr_write_b32 a18, v20
    v_perm_b32 v21, v83, v81, s25
    v_accvgpr_write_b32 a19, v21
    v_perm_b32 v20, v86, v84, s24
    v_accvgpr_write_b32 a20, v20
    v_perm_b32 v21, v86, v84, s25
    v_accvgpr_write_b32 a21, v21
    v_perm_b32 v20, v87, v85, s24
    v_accvgpr_write_b32 a22, v20
    v_perm_b32 v21, v87, v85, s25
    v_accvgpr_write_b32 a23, v21
    v_perm_b32 v20, v90, v88, s24
    v_accvgpr_write_b32 a24, v20
    v_perm_b32 v21, v90, v88, s25
    v_accvgpr_write_b32 a25, v21
    v_perm_b32 v20, v91, v89, s24
    v_accvgpr_write_b32 a26, v20
    v_perm_b32 v21, v91, v89, s25
    v_accvgpr_write_b32 a27, v21
    v_perm_b32 v20, v94, v92, s24
    v_accvgpr_write_b32 a28, v20
    v_perm_b32 v21, v94, v92, s25
    v_accvgpr_write_b32 a29, v21
    v_perm_b32 v20, v95, v93, s24
    v_accvgpr_write_b32 a30, v20
    v_perm_b32 v21, v95, v93, s25
    v_accvgpr_write_b32 a31, v21
    global_load_dwordx2 v[64:65], v16, s[44:45] offset:384
    global_load_dwordx2 v[66:67], v16, s[46:47] offset:384
    global_load_dwordx2 v[68:69], v16, s[44:45] offset:1664
    global_load_dwordx2 v[70:71], v16, s[46:47] offset:1664
    global_load_dwordx2 v[72:73], v16, s[44:45] offset:416
    global_load_dwordx2 v[74:75], v16, s[46:47] offset:416
    global_load_dwordx2 v[76:77], v16, s[44:45] offset:1696
    global_load_dwordx2 v[78:79], v16, s[46:47] offset:1696
    global_load_dwordx2 v[80:81], v16, s[44:45] offset:448
    global_load_dwordx2 v[82:83], v16, s[46:47] offset:448
    global_load_dwordx2 v[84:85], v16, s[44:45] offset:1728
    global_load_dwordx2 v[86:87], v16, s[46:47] offset:1728
    global_load_dwordx2 v[88:89], v16, s[44:45] offset:480
    global_load_dwordx2 v[90:91], v16, s[46:47] offset:480
    global_load_dwordx2 v[92:93], v16, s[44:45] offset:1760
    global_load_dwordx2 v[94:95], v16, s[46:47] offset:1760
    s_waitcnt vmcnt(32)
    v_perm_b32 v20, v98, v96, s24
    v_accvgpr_write_b32 a32, v20
    v_perm_b32 v21, v98, v96, s25
    v_accvgpr_write_b32 a33, v21
    v_perm_b32 v20, v99, v97, s24
    v_accvgpr_write_b32 a34, v20
    v_perm_b32 v21, v99, v97, s25
    v_accvgpr_write_b32 a35, v21
    v_perm_b32 v20, v102, v100, s24
    v_accvgpr_write_b32 a36, v20
    v_perm_b32 v21, v102, v100, s25
    v_accvgpr_write_b32 a37, v21
    v_perm_b32 v20, v103, v101, s24
    v_accvgpr_write_b32 a38, v20
    v_perm_b32 v21, v103, v101, s25
    v_accvgpr_write_b32 a39, v21
    v_perm_b32 v20, v106, v104, s24
    v_accvgpr_write_b32 a40, v20
    v_perm_b32 v21, v106, v104, s25
    v_accvgpr_write_b32 a41, v21
    v_perm_b32 v20, v107, v105, s24
    v_accvgpr_write_b32 a42, v20
    v_perm_b32 v21, v107, v105, s25
    v_accvgpr_write_b32 a43, v21
    v_perm_b32 v20, v110, v108, s24
    v_accvgpr_write_b32 a44, v20
    v_perm_b32 v21, v110, v108, s25
    v_accvgpr_write_b32 a45, v21
    v_perm_b32 v20, v111, v109, s24
    v_accvgpr_write_b32 a46, v20
    v_perm_b32 v21, v111, v109, s25
    v_accvgpr_write_b32 a47, v21
    v_perm_b32 v20, v114, v112, s24
    v_accvgpr_write_b32 a48, v20
    v_perm_b32 v21, v114, v112, s25
    v_accvgpr_write_b32 a49, v21
    v_perm_b32 v20, v115, v113, s24
    v_accvgpr_write_b32 a50, v20
    v_perm_b32 v21, v115, v113, s25
    v_accvgpr_write_b32 a51, v21
    v_perm_b32 v20, v118, v116, s24
    v_accvgpr_write_b32 a52, v20
    v_perm_b32 v21, v118, v116, s25
    v_accvgpr_write_b32 a53, v21
    v_perm_b32 v20, v119, v117, s24
    v_accvgpr_write_b32 a54, v20
    v_perm_b32 v21, v119, v117, s25
    v_accvgpr_write_b32 a55, v21
    v_perm_b32 v20, v122, v120, s24
    v_accvgpr_write_b32 a56, v20
    v_perm_b32 v21, v122, v120, s25
    v_accvgpr_write_b32 a57, v21
    v_perm_b32 v20, v123, v121, s24
    v_accvgpr_write_b32 a58, v20
    v_perm_b32 v21, v123, v121, s25
    v_accvgpr_write_b32 a59, v21
    v_perm_b32 v20, v126, v124, s24
    v_accvgpr_write_b32 a60, v20
    v_perm_b32 v21, v126, v124, s25
    v_accvgpr_write_b32 a61, v21
    v_perm_b32 v20, v127, v125, s24
    v_accvgpr_write_b32 a62, v20
    v_perm_b32 v21, v127, v125, s25
    v_accvgpr_write_b32 a63, v21
    global_load_dwordx2 v[96:97], v16, s[44:45] offset:512
    global_load_dwordx2 v[98:99], v16, s[46:47] offset:512
    global_load_dwordx2 v[100:101], v16, s[44:45] offset:1792
    global_load_dwordx2 v[102:103], v16, s[46:47] offset:1792
    global_load_dwordx2 v[104:105], v16, s[44:45] offset:544
    global_load_dwordx2 v[106:107], v16, s[46:47] offset:544
    global_load_dwordx2 v[108:109], v16, s[44:45] offset:1824
    global_load_dwordx2 v[110:111], v16, s[46:47] offset:1824
    global_load_dwordx2 v[112:113], v16, s[44:45] offset:576
    global_load_dwordx2 v[114:115], v16, s[46:47] offset:576
    global_load_dwordx2 v[116:117], v16, s[44:45] offset:1856
    global_load_dwordx2 v[118:119], v16, s[46:47] offset:1856
    global_load_dwordx2 v[120:121], v16, s[44:45] offset:608
    global_load_dwordx2 v[122:123], v16, s[46:47] offset:608
    global_load_dwordx2 v[124:125], v16, s[44:45] offset:1888
    global_load_dwordx2 v[126:127], v16, s[46:47] offset:1888
    s_waitcnt vmcnt(32)
    v_perm_b32 v20, v130, v128, s24
    v_accvgpr_write_b32 a64, v20
    v_perm_b32 v21, v130, v128, s25
    v_accvgpr_write_b32 a65, v21
    v_perm_b32 v20, v131, v129, s24
    v_accvgpr_write_b32 a66, v20
    v_perm_b32 v21, v131, v129, s25
    v_accvgpr_write_b32 a67, v21
    v_perm_b32 v20, v134, v132, s24
    v_accvgpr_write_b32 a68, v20
    v_perm_b32 v21, v134, v132, s25
    v_accvgpr_write_b32 a69, v21
    v_perm_b32 v20, v135, v133, s24
    v_accvgpr_write_b32 a70, v20
    v_perm_b32 v21, v135, v133, s25
    v_accvgpr_write_b32 a71, v21
    v_perm_b32 v20, v138, v136, s24
    v_accvgpr_write_b32 a72, v20
    v_perm_b32 v21, v138, v136, s25
    v_accvgpr_write_b32 a73, v21
    v_perm_b32 v20, v139, v137, s24
    v_accvgpr_write_b32 a74, v20
    v_perm_b32 v21, v139, v137, s25
    v_accvgpr_write_b32 a75, v21
    v_perm_b32 v20, v142, v140, s24
    v_accvgpr_write_b32 a76, v20
    v_perm_b32 v21, v142, v140, s25
    v_accvgpr_write_b32 a77, v21
    v_perm_b32 v20, v143, v141, s24
    v_accvgpr_write_b32 a78, v20
    v_perm_b32 v21, v143, v141, s25
    v_accvgpr_write_b32 a79, v21
    v_perm_b32 v20, v146, v144, s24
    v_accvgpr_write_b32 a80, v20
    v_perm_b32 v21, v146, v144, s25
    v_accvgpr_write_b32 a81, v21
    v_perm_b32 v20, v147, v145, s24
    v_accvgpr_write_b32 a82, v20
    v_perm_b32 v21, v147, v145, s25
    v_accvgpr_write_b32 a83, v21
    v_perm_b32 v20, v150, v148, s24
    v_accvgpr_write_b32 a84, v20
    v_perm_b32 v21, v150, v148, s25
    v_accvgpr_write_b32 a85, v21
    v_perm_b32 v20, v151, v149, s24
    v_accvgpr_write_b32 a86, v20
    v_perm_b32 v21, v151, v149, s25
    v_accvgpr_write_b32 a87, v21
    v_perm_b32 v20, v154, v152, s24
    v_accvgpr_write_b32 a88, v20
    v_perm_b32 v21, v154, v152, s25
    v_accvgpr_write_b32 a89, v21
    v_perm_b32 v20, v155, v153, s24
    v_accvgpr_write_b32 a90, v20
    v_perm_b32 v21, v155, v153, s25
    v_accvgpr_write_b32 a91, v21
    v_perm_b32 v20, v158, v156, s24
    v_accvgpr_write_b32 a92, v20
    v_perm_b32 v21, v158, v156, s25
    v_accvgpr_write_b32 a93, v21
    v_perm_b32 v20, v159, v157, s24
    v_accvgpr_write_b32 a94, v20
    v_perm_b32 v21, v159, v157, s25
    v_accvgpr_write_b32 a95, v21
    global_load_dwordx2 v[128:129], v16, s[44:45] offset:640
    global_load_dwordx2 v[130:131], v16, s[46:47] offset:640
    global_load_dwordx2 v[132:133], v16, s[44:45] offset:1920
    global_load_dwordx2 v[134:135], v16, s[46:47] offset:1920
    global_load_dwordx2 v[136:137], v16, s[44:45] offset:672
    global_load_dwordx2 v[138:139], v16, s[46:47] offset:672
    global_load_dwordx2 v[140:141], v16, s[44:45] offset:1952
    global_load_dwordx2 v[142:143], v16, s[46:47] offset:1952
    global_load_dwordx2 v[144:145], v16, s[44:45] offset:704
    global_load_dwordx2 v[146:147], v16, s[46:47] offset:704
    global_load_dwordx2 v[148:149], v16, s[44:45] offset:1984
    global_load_dwordx2 v[150:151], v16, s[46:47] offset:1984
    global_load_dwordx2 v[152:153], v16, s[44:45] offset:736
    global_load_dwordx2 v[154:155], v16, s[46:47] offset:736
    global_load_dwordx2 v[156:157], v16, s[44:45] offset:2016
    global_load_dwordx2 v[158:159], v16, s[46:47] offset:2016
    s_waitcnt vmcnt(32)
    v_perm_b32 v20, v66, v64, s24
    v_accvgpr_write_b32 a96, v20
    v_perm_b32 v21, v66, v64, s25
    v_accvgpr_write_b32 a97, v21
    v_perm_b32 v20, v67, v65, s24
    v_accvgpr_write_b32 a98, v20
    v_perm_b32 v21, v67, v65, s25
    v_accvgpr_write_b32 a99, v21
    v_perm_b32 v20, v70, v68, s24
    v_accvgpr_write_b32 a100, v20
    v_perm_b32 v21, v70, v68, s25
    v_accvgpr_write_b32 a101, v21
    v_perm_b32 v20, v71, v69, s24
    v_accvgpr_write_b32 a102, v20
    v_perm_b32 v21, v71, v69, s25
    v_accvgpr_write_b32 a103, v21
    v_perm_b32 v20, v74, v72, s24
    v_accvgpr_write_b32 a104, v20
    v_perm_b32 v21, v74, v72, s25
    v_accvgpr_write_b32 a105, v21
    v_perm_b32 v20, v75, v73, s24
    v_accvgpr_write_b32 a106, v20
    v_perm_b32 v21, v75, v73, s25
    v_accvgpr_write_b32 a107, v21
    v_perm_b32 v20, v78, v76, s24
    v_accvgpr_write_b32 a108, v20
    v_perm_b32 v21, v78, v76, s25
    v_accvgpr_write_b32 a109, v21
    v_perm_b32 v20, v79, v77, s24
    v_accvgpr_write_b32 a110, v20
    v_perm_b32 v21, v79, v77, s25
    v_accvgpr_write_b32 a111, v21
    v_perm_b32 v20, v82, v80, s24
    v_accvgpr_write_b32 a112, v20
    v_perm_b32 v21, v82, v80, s25
    v_accvgpr_write_b32 a113, v21
    v_perm_b32 v20, v83, v81, s24
    v_accvgpr_write_b32 a114, v20
    v_perm_b32 v21, v83, v81, s25
    v_accvgpr_write_b32 a115, v21
    v_perm_b32 v20, v86, v84, s24
    v_accvgpr_write_b32 a116, v20
    v_perm_b32 v21, v86, v84, s25
    v_accvgpr_write_b32 a117, v21
    v_perm_b32 v20, v87, v85, s24
    v_accvgpr_write_b32 a118, v20
    v_perm_b32 v21, v87, v85, s25
    v_accvgpr_write_b32 a119, v21
    v_perm_b32 v20, v90, v88, s24
    v_accvgpr_write_b32 a120, v20
    v_perm_b32 v21, v90, v88, s25
    v_accvgpr_write_b32 a121, v21
    v_perm_b32 v20, v91, v89, s24
    v_accvgpr_write_b32 a122, v20
    v_perm_b32 v21, v91, v89, s25
    v_accvgpr_write_b32 a123, v21
    v_perm_b32 v20, v94, v92, s24
    v_accvgpr_write_b32 a124, v20
    v_perm_b32 v21, v94, v92, s25
    v_accvgpr_write_b32 a125, v21
    v_perm_b32 v20, v95, v93, s24
    v_accvgpr_write_b32 a126, v20
    v_perm_b32 v21, v95, v93, s25
    v_accvgpr_write_b32 a127, v21
    global_load_dwordx2 v[64:65], v16, s[44:45] offset:768
    global_load_dwordx2 v[66:67], v16, s[46:47] offset:768
    global_load_dwordx2 v[68:69], v16, s[44:45] offset:2048
    global_load_dwordx2 v[70:71], v16, s[46:47] offset:2048
    global_load_dwordx2 v[72:73], v16, s[44:45] offset:800
    global_load_dwordx2 v[74:75], v16, s[46:47] offset:800
    global_load_dwordx2 v[76:77], v16, s[44:45] offset:2080
    global_load_dwordx2 v[78:79], v16, s[46:47] offset:2080
    global_load_dwordx2 v[80:81], v16, s[44:45] offset:832
    global_load_dwordx2 v[82:83], v16, s[46:47] offset:832
    global_load_dwordx2 v[84:85], v16, s[44:45] offset:2112
    global_load_dwordx2 v[86:87], v16, s[46:47] offset:2112
    global_load_dwordx2 v[88:89], v16, s[44:45] offset:864
    global_load_dwordx2 v[90:91], v16, s[46:47] offset:864
    global_load_dwordx2 v[92:93], v16, s[44:45] offset:2144
    global_load_dwordx2 v[94:95], v16, s[46:47] offset:2144
    s_waitcnt vmcnt(32)
    v_perm_b32 v20, v98, v96, s24
    v_accvgpr_write_b32 a128, v20
    v_perm_b32 v21, v98, v96, s25
    v_accvgpr_write_b32 a129, v21
    v_perm_b32 v20, v99, v97, s24
    v_accvgpr_write_b32 a130, v20
    v_perm_b32 v21, v99, v97, s25
    v_accvgpr_write_b32 a131, v21
    v_perm_b32 v20, v102, v100, s24
    v_accvgpr_write_b32 a132, v20
    v_perm_b32 v21, v102, v100, s25
    v_accvgpr_write_b32 a133, v21
    v_perm_b32 v20, v103, v101, s24
    v_accvgpr_write_b32 a134, v20
    v_perm_b32 v21, v103, v101, s25
    v_accvgpr_write_b32 a135, v21
    v_perm_b32 v20, v106, v104, s24
    v_accvgpr_write_b32 a136, v20
    v_perm_b32 v21, v106, v104, s25
    v_accvgpr_write_b32 a137, v21
    v_perm_b32 v20, v107, v105, s24
    v_accvgpr_write_b32 a138, v20
    v_perm_b32 v21, v107, v105, s25
    v_accvgpr_write_b32 a139, v21
    v_perm_b32 v20, v110, v108, s24
    v_accvgpr_write_b32 a140, v20
    v_perm_b32 v21, v110, v108, s25
    v_accvgpr_write_b32 a141, v21
    v_perm_b32 v20, v111, v109, s24
    v_accvgpr_write_b32 a142, v20
    v_perm_b32 v21, v111, v109, s25
    v_accvgpr_write_b32 a143, v21
    v_perm_b32 v20, v114, v112, s24
    v_accvgpr_write_b32 a144, v20
    v_perm_b32 v21, v114, v112, s25
    v_accvgpr_write_b32 a145, v21
    v_perm_b32 v20, v115, v113, s24
    v_accvgpr_write_b32 a146, v20
    v_perm_b32 v21, v115, v113, s25
    v_accvgpr_write_b32 a147, v21
    v_perm_b32 v20, v118, v116, s24
    v_accvgpr_write_b32 a148, v20
    v_perm_b32 v21, v118, v116, s25
    v_accvgpr_write_b32 a149, v21
    v_perm_b32 v20, v119, v117, s24
    v_accvgpr_write_b32 a150, v20
    v_perm_b32 v21, v119, v117, s25
    v_accvgpr_write_b32 a151, v21
    v_perm_b32 v20, v122, v120, s24
    v_accvgpr_write_b32 a152, v20
    v_perm_b32 v21, v122, v120, s25
    v_accvgpr_write_b32 a153, v21
    v_perm_b32 v20, v123, v121, s24
    v_accvgpr_write_b32 a154, v20
    v_perm_b32 v21, v123, v121, s25
    v_accvgpr_write_b32 a155, v21
    v_perm_b32 v20, v126, v124, s24
    v_accvgpr_write_b32 a156, v20
    v_perm_b32 v21, v126, v124, s25
    v_accvgpr_write_b32 a157, v21
    v_perm_b32 v20, v127, v125, s24
    v_accvgpr_write_b32 a158, v20
    v_perm_b32 v21, v127, v125, s25
    v_accvgpr_write_b32 a159, v21
    global_load_dwordx2 v[96:97], v16, s[44:45] offset:896
    global_load_dwordx2 v[98:99], v16, s[46:47] offset:896
    global_load_dwordx2 v[100:101], v16, s[44:45] offset:2176
    global_load_dwordx2 v[102:103], v16, s[46:47] offset:2176
    global_load_dwordx2 v[104:105], v16, s[44:45] offset:928
    global_load_dwordx2 v[106:107], v16, s[46:47] offset:928
    global_load_dwordx2 v[108:109], v16, s[44:45] offset:2208
    global_load_dwordx2 v[110:111], v16, s[46:47] offset:2208
    global_load_dwordx2 v[112:113], v16, s[44:45] offset:960
    global_load_dwordx2 v[114:115], v16, s[46:47] offset:960
    global_load_dwordx2 v[116:117], v16, s[44:45] offset:2240
    global_load_dwordx2 v[118:119], v16, s[46:47] offset:2240
    global_load_dwordx2 v[120:121], v16, s[44:45] offset:992
    global_load_dwordx2 v[122:123], v16, s[46:47] offset:992
    global_load_dwordx2 v[124:125], v16, s[44:45] offset:2272
    global_load_dwordx2 v[126:127], v16, s[46:47] offset:2272
    s_waitcnt vmcnt(32)
    v_perm_b32 v20, v130, v128, s24
    v_accvgpr_write_b32 a160, v20
    v_perm_b32 v21, v130, v128, s25
    v_accvgpr_write_b32 a161, v21
    v_perm_b32 v20, v131, v129, s24
    v_accvgpr_write_b32 a162, v20
    v_perm_b32 v21, v131, v129, s25
    v_accvgpr_write_b32 a163, v21
    v_perm_b32 v20, v134, v132, s24
    v_accvgpr_write_b32 a164, v20
    v_perm_b32 v21, v134, v132, s25
    v_accvgpr_write_b32 a165, v21
    v_perm_b32 v20, v135, v133, s24
    v_accvgpr_write_b32 a166, v20
    v_perm_b32 v21, v135, v133, s25
    v_accvgpr_write_b32 a167, v21
    v_perm_b32 v20, v138, v136, s24
    v_accvgpr_write_b32 a168, v20
    v_perm_b32 v21, v138, v136, s25
    v_accvgpr_write_b32 a169, v21
    v_perm_b32 v20, v139, v137, s24
    v_accvgpr_write_b32 a170, v20
    v_perm_b32 v21, v139, v137, s25
    v_accvgpr_write_b32 a171, v21
    v_perm_b32 v20, v142, v140, s24
    v_accvgpr_write_b32 a172, v20
    v_perm_b32 v21, v142, v140, s25
    v_accvgpr_write_b32 a173, v21
    v_perm_b32 v20, v143, v141, s24
    v_accvgpr_write_b32 a174, v20
    v_perm_b32 v21, v143, v141, s25
    v_accvgpr_write_b32 a175, v21
    v_perm_b32 v20, v146, v144, s24
    v_accvgpr_write_b32 a176, v20
    v_perm_b32 v21, v146, v144, s25
    v_accvgpr_write_b32 a177, v21
    v_perm_b32 v20, v147, v145, s24
    v_accvgpr_write_b32 a178, v20
    v_perm_b32 v21, v147, v145, s25
    v_accvgpr_write_b32 a179, v21
    v_perm_b32 v20, v150, v148, s24
    v_accvgpr_write_b32 a180, v20
    v_perm_b32 v21, v150, v148, s25
    v_accvgpr_write_b32 a181, v21
    v_perm_b32 v20, v151, v149, s24
    v_accvgpr_write_b32 a182, v20
    v_perm_b32 v21, v151, v149, s25
    v_accvgpr_write_b32 a183, v21
    v_perm_b32 v20, v154, v152, s24
    v_accvgpr_write_b32 a184, v20
    v_perm_b32 v21, v154, v152, s25
    v_accvgpr_write_b32 a185, v21
    v_perm_b32 v20, v155, v153, s24
    v_accvgpr_write_b32 a186, v20
    v_perm_b32 v21, v155, v153, s25
    v_accvgpr_write_b32 a187, v21
    v_perm_b32 v20, v158, v156, s24
    v_accvgpr_write_b32 a188, v20
    v_perm_b32 v21, v158, v156, s25
    v_accvgpr_write_b32 a189, v21
    v_perm_b32 v20, v159, v157, s24
    v_accvgpr_write_b32 a190, v20
    v_perm_b32 v21, v159, v157, s25
    v_accvgpr_write_b32 a191, v21
    global_load_dwordx2 v[128:129], v16, s[44:45] offset:1024
    global_load_dwordx2 v[130:131], v16, s[46:47] offset:1024
    global_load_dwordx2 v[132:133], v16, s[44:45] offset:2304
    global_load_dwordx2 v[134:135], v16, s[46:47] offset:2304
    global_load_dwordx2 v[136:137], v16, s[44:45] offset:1056
    global_load_dwordx2 v[138:139], v16, s[46:47] offset:1056
    global_load_dwordx2 v[140:141], v16, s[44:45] offset:2336
    global_load_dwordx2 v[142:143], v16, s[46:47] offset:2336
    global_load_dwordx2 v[144:145], v16, s[44:45] offset:1088
    global_load_dwordx2 v[146:147], v16, s[46:47] offset:1088
    global_load_dwordx2 v[148:149], v16, s[44:45] offset:2368
    global_load_dwordx2 v[150:151], v16, s[46:47] offset:2368
    global_load_dwordx2 v[152:153], v16, s[44:45] offset:1120
    global_load_dwordx2 v[154:155], v16, s[46:47] offset:1120
    global_load_dwordx2 v[156:157], v16, s[44:45] offset:2400
    global_load_dwordx2 v[158:159], v16, s[46:47] offset:2400
    s_waitcnt vmcnt(32)
    v_perm_b32 v20, v66, v64, s24
    v_accvgpr_write_b32 a192, v20
    v_perm_b32 v21, v66, v64, s25
    v_accvgpr_write_b32 a193, v21
    v_perm_b32 v20, v67, v65, s24
    v_accvgpr_write_b32 a194, v20
    v_perm_b32 v21, v67, v65, s25
    v_accvgpr_write_b32 a195, v21
    v_perm_b32 v20, v70, v68, s24
    v_accvgpr_write_b32 a196, v20
    v_perm_b32 v21, v70, v68, s25
    v_accvgpr_write_b32 a197, v21
    v_perm_b32 v20, v71, v69, s24
    v_accvgpr_write_b32 a198, v20
    v_perm_b32 v21, v71, v69, s25
    v_accvgpr_write_b32 a199, v21
    v_perm_b32 v20, v74, v72, s24
    v_accvgpr_write_b32 a200, v20
    v_perm_b32 v21, v74, v72, s25
    v_accvgpr_write_b32 a201, v21
    v_perm_b32 v20, v75, v73, s24
    v_accvgpr_write_b32 a202, v20
    v_perm_b32 v21, v75, v73, s25
    v_accvgpr_write_b32 a203, v21
    v_perm_b32 v20, v78, v76, s24
    v_accvgpr_write_b32 a204, v20
    v_perm_b32 v21, v78, v76, s25
    v_accvgpr_write_b32 a205, v21
    v_perm_b32 v20, v79, v77, s24
    v_accvgpr_write_b32 a206, v20
    v_perm_b32 v21, v79, v77, s25
    v_accvgpr_write_b32 a207, v21
    v_perm_b32 v20, v82, v80, s24
    v_accvgpr_write_b32 a208, v20
    v_perm_b32 v21, v82, v80, s25
    v_accvgpr_write_b32 a209, v21
    v_perm_b32 v20, v83, v81, s24
    v_accvgpr_write_b32 a210, v20
    v_perm_b32 v21, v83, v81, s25
    v_accvgpr_write_b32 a211, v21
    v_perm_b32 v20, v86, v84, s24
    v_accvgpr_write_b32 a212, v20
    v_perm_b32 v21, v86, v84, s25
    v_accvgpr_write_b32 a213, v21
    v_perm_b32 v20, v87, v85, s24
    v_accvgpr_write_b32 a214, v20
    v_perm_b32 v21, v87, v85, s25
    v_accvgpr_write_b32 a215, v21
    v_perm_b32 v20, v90, v88, s24
    v_accvgpr_write_b32 a216, v20
    v_perm_b32 v21, v90, v88, s25
    v_accvgpr_write_b32 a217, v21
    v_perm_b32 v20, v91, v89, s24
    v_accvgpr_write_b32 a218, v20
    v_perm_b32 v21, v91, v89, s25
    v_accvgpr_write_b32 a219, v21
    v_perm_b32 v20, v94, v92, s24
    v_accvgpr_write_b32 a220, v20
    v_perm_b32 v21, v94, v92, s25
    v_accvgpr_write_b32 a221, v21
    v_perm_b32 v20, v95, v93, s24
    v_accvgpr_write_b32 a222, v20
    v_perm_b32 v21, v95, v93, s25
    v_accvgpr_write_b32 a223, v21
    global_load_dwordx2 v[64:65], v16, s[44:45] offset:1152
    global_load_dwordx2 v[66:67], v16, s[46:47] offset:1152
    global_load_dwordx2 v[68:69], v16, s[44:45] offset:2432
    global_load_dwordx2 v[70:71], v16, s[46:47] offset:2432
    global_load_dwordx2 v[72:73], v16, s[44:45] offset:1184
    global_load_dwordx2 v[74:75], v16, s[46:47] offset:1184
    global_load_dwordx2 v[76:77], v16, s[44:45] offset:2464
    global_load_dwordx2 v[78:79], v16, s[46:47] offset:2464
    global_load_dwordx2 v[80:81], v16, s[44:45] offset:1216
    global_load_dwordx2 v[82:83], v16, s[46:47] offset:1216
    global_load_dwordx2 v[84:85], v16, s[44:45] offset:2496
    global_load_dwordx2 v[86:87], v16, s[46:47] offset:2496
    global_load_dwordx2 v[88:89], v16, s[44:45] offset:1248
    global_load_dwordx2 v[90:91], v16, s[46:47] offset:1248
    global_load_dwordx2 v[92:93], v16, s[44:45] offset:2528
    global_load_dwordx2 v[94:95], v16, s[46:47] offset:2528
    s_waitcnt vmcnt(32)
    v_perm_b32 v20, v98, v96, s24
    v_accvgpr_write_b32 a224, v20
    v_perm_b32 v21, v98, v96, s25
    v_accvgpr_write_b32 a225, v21
    v_perm_b32 v20, v99, v97, s24
    v_accvgpr_write_b32 a226, v20
    v_perm_b32 v21, v99, v97, s25
    v_accvgpr_write_b32 a227, v21
    v_perm_b32 v20, v102, v100, s24
    v_accvgpr_write_b32 a228, v20
    v_perm_b32 v21, v102, v100, s25
    v_accvgpr_write_b32 a229, v21
    v_perm_b32 v20, v103, v101, s24
    v_accvgpr_write_b32 a230, v20
    v_perm_b32 v21, v103, v101, s25
    v_accvgpr_write_b32 a231, v21
    v_perm_b32 v20, v106, v104, s24
    v_accvgpr_write_b32 a232, v20
    v_perm_b32 v21, v106, v104, s25
    v_accvgpr_write_b32 a233, v21
    v_perm_b32 v20, v107, v105, s24
    v_accvgpr_write_b32 a234, v20
    v_perm_b32 v21, v107, v105, s25
    v_accvgpr_write_b32 a235, v21
    v_perm_b32 v20, v110, v108, s24
    v_accvgpr_write_b32 a236, v20
    v_perm_b32 v21, v110, v108, s25
    v_accvgpr_write_b32 a237, v21
    v_perm_b32 v20, v111, v109, s24
    v_accvgpr_write_b32 a238, v20
    v_perm_b32 v21, v111, v109, s25
    v_accvgpr_write_b32 a239, v21
    v_perm_b32 v20, v114, v112, s24
    v_accvgpr_write_b32 a240, v20
    v_perm_b32 v21, v114, v112, s25
    v_accvgpr_write_b32 a241, v21
    v_perm_b32 v20, v115, v113, s24
    v_accvgpr_write_b32 a242, v20
    v_perm_b32 v21, v115, v113, s25
    v_accvgpr_write_b32 a243, v21
    v_perm_b32 v20, v118, v116, s24
    v_accvgpr_write_b32 a244, v20
    v_perm_b32 v21, v118, v116, s25
    v_accvgpr_write_b32 a245, v21
    v_perm_b32 v20, v119, v117, s24
    v_accvgpr_write_b32 a246, v20
    v_perm_b32 v21, v119, v117, s25
    v_accvgpr_write_b32 a247, v21
    v_perm_b32 v20, v122, v120, s24
    v_accvgpr_write_b32 a248, v20
    v_perm_b32 v21, v122, v120, s25
    v_accvgpr_write_b32 a249, v21
    v_perm_b32 v20, v123, v121, s24
    v_accvgpr_write_b32 a250, v20
    v_perm_b32 v21, v123, v121, s25
    v_accvgpr_write_b32 a251, v21
    v_perm_b32 v20, v126, v124, s24
    v_accvgpr_write_b32 a252, v20
    v_perm_b32 v21, v126, v124, s25
    v_accvgpr_write_b32 a253, v21
    v_perm_b32 v20, v127, v125, s24
    v_accvgpr_write_b32 a254, v20
    v_perm_b32 v21, v127, v125, s25
    v_accvgpr_write_b32 a255, v21
    s_waitcnt vmcnt(16)
    v_perm_b32 v192, v130, v128, s24
    v_perm_b32 v193, v130, v128, s25
    v_perm_b32 v194, v131, v129, s24
    v_perm_b32 v195, v131, v129, s25
    v_perm_b32 v196, v134, v132, s24
    v_perm_b32 v197, v134, v132, s25
    v_perm_b32 v198, v135, v133, s24
    v_perm_b32 v199, v135, v133, s25
    v_perm_b32 v200, v138, v136, s24
    v_perm_b32 v201, v138, v136, s25
    v_perm_b32 v202, v139, v137, s24
    v_perm_b32 v203, v139, v137, s25
    v_perm_b32 v204, v142, v140, s24
    v_perm_b32 v205, v142, v140, s25
    v_perm_b32 v206, v143, v141, s24
    v_perm_b32 v207, v143, v141, s25
    v_perm_b32 v208, v146, v144, s24
    v_perm_b32 v209, v146, v144, s25
    v_perm_b32 v210, v147, v145, s24
    v_perm_b32 v211, v147, v145, s25
    v_perm_b32 v212, v150, v148, s24
    v_perm_b32 v213, v150, v148, s25
    v_perm_b32 v214, v151, v149, s24
    v_perm_b32 v215, v151, v149, s25
    v_perm_b32 v216, v154, v152, s24
    v_perm_b32 v217, v154, v152, s25
    v_perm_b32 v218, v155, v153, s24
    v_perm_b32 v219, v155, v153, s25
    v_perm_b32 v220, v158, v156, s24
    v_perm_b32 v221, v158, v156, s25
    v_perm_b32 v222, v159, v157, s24
    v_perm_b32 v223, v159, v157, s25
    s_waitcnt vmcnt(0)
    v_perm_b32 v224, v66, v64, s24
    v_perm_b32 v225, v66, v64, s25
    v_perm_b32 v226, v67, v65, s24
    v_perm_b32 v227, v67, v65, s25
    v_perm_b32 v228, v70, v68, s24
    v_perm_b32 v229, v70, v68, s25
    v_perm_b32 v230, v71, v69, s24
    v_perm_b32 v231, v71, v69, s25
    v_perm_b32 v232, v74, v72, s24
    v_perm_b32 v233, v74, v72, s25
    v_perm_b32 v234, v75, v73, s24
    v_perm_b32 v235, v75, v73, s25
    v_perm_b32 v236, v78, v76, s24
    v_perm_b32 v237, v78, v76, s25
    v_perm_b32 v238, v79, v77, s24
    v_perm_b32 v239, v79, v77, s25
    v_perm_b32 v240, v82, v80, s24
    v_perm_b32 v241, v82, v80, s25
    v_perm_b32 v242, v83, v81, s24
    v_perm_b32 v243, v83, v81, s25
    v_perm_b32 v244, v86, v84, s24
    v_perm_b32 v245, v86, v84, s25
    v_perm_b32 v246, v87, v85, s24
    v_perm_b32 v247, v87, v85, s25
    v_perm_b32 v248, v90, v88, s24
    v_perm_b32 v249, v90, v88, s25
    v_perm_b32 v250, v91, v89, s24
    v_perm_b32 v251, v91, v89, s25
    v_perm_b32 v252, v94, v92, s24
    v_perm_b32 v253, v94, v92, s25
    v_perm_b32 v254, v95, v93, s24
    v_perm_b32 v255, v95, v93, s25
    v_lshrrev_b32 v18, 4, v0
    v_lshlrev_b32 v18, 3, v18
    v_add_u32 v18, s54, v18
    v_lshlrev_b32 v19, 1, v18
    global_load_dwordx4 v[20:23], v19, s[48:49]
    v_and_b32 v17, 15, v0
    s_lshl_b32 s10, s43, 9
    v_add_u32 v17, s10, v17
    v_mul_u32_u24 v8, 1280, v17
    v_add_u32 v8, v8, v19
    s_mov_b32 s10, 5120
    v_mul_lo_u32 v9, v17, s10
    v_lshl_add_u32 v9, v18, 2, v9
    v_add_u32 v9, 2560, v9
    s_waitcnt vmcnt(0)
    v_lshlrev_b32 v24, 16, v20
    v_and_b32 v25, 0xffff0000, v20
    v_lshlrev_b32 v26, 16, v21
    v_and_b32 v27, 0xffff0000, v21
    v_lshlrev_b32 v28, 16, v22
    v_and_b32 v29, 0xffff0000, v22
    v_lshlrev_b32 v30, 16, v23
    v_and_b32 v31, 0xffff0000, v23
    v_lshrrev_b32 v5, 3, v0
    v_and_b32 v6, 7, v0
    v_xor_b32 v6, v6, v5
    s_and_b32 s10, s5, 1
    s_lshl_b32 s10, s10, 3
    v_add_u32 v5, s10, v5
    v_mul_u32_u24 v2, 2560, v5
    v_lshl_add_u32 v2, v6, 4, v2
    s_lshr_b32 s10, s5, 1
    s_mul_i32 s10, s10, 1280
    v_add_u32 v2, s10, v2
    v_and_b32 v5, 7, v0
    v_bfe_u32 v6, v0, 3, 1
    v_mul_u32_u24 v3, 20480, v6
    v_lshl_add_u32 v3, v5, 7, v3
    v_lshrrev_b32 v6, 4, v0
    v_xor_b32 v14, v6, v5
    v_xor_b32 v6, 4, v14
    v_lshl_add_u32 v15, v6, 4, v3
    v_lshl_add_u32 v14, v14, 4, v3
    v_lshlrev_b32 v10, 7, v0
    v_add_u32 v10, 20480, v10
    s_mov_b32 s30, 1
    s_mov_b32 s27, 0
L_pfb2_87:
    s_mov_b64 exec, 1048575
    global_load_dword v5, v10, s[22:23] sc1
    s_waitcnt vmcnt(0)
    v_cmp_gt_u32 vcc, s30, v5
    s_mov_b64 exec, -1
    s_cbranch_vccz L_pfob2_88
    s_sleep 1
    s_add_u32 s27, s27, 1
    s_cmp_lt_u32 s27, 262144
    s_cbranch_scc1 L_pfb2_87
    s_branch L_timeout
L_pfob2_88:
    s_mul_i32 s10, s43, 1310720
    s_add_u32 s10, s10, 75497472
    s_add_u32 s16, s8, s10
    s_addc_u32 s17, s9, 0
    s_mov_b32 s31, 0
    s_and_b32 s13, s5, 1
    s_mul_i32 s13, s13, 20480
    s_lshr_b32 s12, s5, 1
    s_mul_i32 s12, s12, 10240
    s_add_u32 s13, s13, s12
    s_add_u32 s13, s13, s31
    s_add_u32 m0, s13, 0
    s_nop 0
    global_load_lds_dwordx4 v2, s[16:17] offset:0 sc1
    s_add_u32 m0, s13, 896
    s_nop 0
    global_load_lds_dwordx4 v2, s[16:17] offset:128 sc1
    s_add_u32 m0, s13, 1792
    s_nop 0
    global_load_lds_dwordx4 v2, s[16:17] offset:256 sc1
    s_add_u32 m0, s13, 2688
    s_nop 0
    global_load_lds_dwordx4 v2, s[16:17] offset:384 sc1
    s_add_u32 m0, s13, 3584
    s_nop 0
    global_load_lds_dwordx4 v2, s[16:17] offset:512 sc1
    s_add_u32 m0, s13, 4480
    s_nop 0
    global_load_lds_dwordx4 v2, s[16:17] offset:640 sc1
    s_add_u32 m0, s13, 5376
    s_nop 0
    global_load_lds_dwordx4 v2, s[16:17] offset:768 sc1
    s_add_u32 m0, s13, 6272
    s_nop 0
    global_load_lds_dwordx4 v2, s[16:17] offset:896 sc1
    s_add_u32 m0, s13, 7168
    s_nop 0
    global_load_lds_dwordx4 v2, s[16:17] offset:1024 sc1
    s_add_u32 m0, s13, 8064
    s_nop 0
    global_load_lds_dwordx4 v2, s[16:17] offset:1152 sc1
    s_mov_b32 s18, 0
    s_mov_b32 s26, 0
    v_add_u32 v12, 0, v14
    v_add_u32 v13, 0, v15
    s_waitcnt vmcnt(0)
L_b2_loop:
    s_waitcnt vmcnt(2)
    s_barrier
    global_load_dwordx4 v[40:43], v8, s[50:51]
    s_add_u32 s30, s18, 1
    s_cmp_ge_u32 s30, 32
    s_cbranch_scc1 L_b2nd_89
    s_add_u32 s16, s16, 40960
    s_addc_u32 s17, s17, 0
    s_xor_b32 s31, s26, 40960
    s_and_b32 s13, s5, 1
    s_mul_i32 s13, s13, 20480
    s_lshr_b32 s12, s5, 1
    s_mul_i32 s12, s12, 10240
    s_add_u32 s13, s13, s12
    s_add_u32 s13, s13, s31
    ds_read_b128 v[64:67], v12 offset:0
    ds_read_b128 v[68:71], v13 offset:0
    ds_read_b128 v[72:75], v12 offset:1024
    ds_read_b128 v[76:79], v13 offset:1024
    s_waitcnt lgkmcnt(3)
    v_mfma_f32_16x16x32_bf16 v[32:35], a[0:3], v[64:67], 0
    v_mfma_f32_16x16x32_bf16 v[36:39], a[4:7], v[64:67], 0
    s_add_u32 m0, s13, 0
    s_nop 0
    global_load_lds_dwordx4 v2, s[16:17] offset:0 sc1
    ds_read_b128 v[64:67], v12 offset:2048
    s_waitcnt lgkmcnt(3)
    v_mfma_f32_16x16x32_bf16 v[32:35], a[8:11], v[68:71], v[32:35]
    v_mfma_f32_16x16x32_bf16 v[36:39], a[12:15], v[68:71], v[36:39]
    ds_read_b128 v[68:71], v13 offset:2048
    s_waitcnt lgkmcnt(3)
    v_mfma_f32_16x16x32_bf16 v[32:35], a[16:19], v[72:75], v[32:35]
    v_mfma_f32_16x16x32_bf16 v[36:39], a[20:23], v[72:75], v[36:39]
    ds_read_b128 v[72:75], v12 offset:3072
    s_waitcnt lgkmcnt(3)
    v_mfma_f32_16x16x32_bf16 v[32:35], a[24:27], v[76:79], v[32:35]
    v_mfma_f32_16x16x32_bf16 v[36:39], a[28:31], v[76:79], v[36:39]
    ds_read_b128 v[76:79], v13 offset:3072
    s_waitcnt lgkmcnt(3)
    v_mfma_f32_16x16x32_bf16 v[32:35], a[32:35], v[64:67], v[32:35]
    v_mfma_f32_16x16x32_bf16 v[36:39], a[36:39], v[64:67], v[36:39]
    s_add_u32 m0, s13, 896
    s_nop 0
    global_load_lds_dwordx4 v2, s[16:17] offset:128 sc1
    ds_read_b128 v[64:67], v12 offset:4096
    s_waitcnt lgkmcnt(3)
    v_mfma_f32_16x16x32_bf16 v[32:35], a[40:43], v[68:71], v[32:35]
    v_mfma_f32_16x16x32_bf16 v[36:39], a[44:47], v[68:71], v[36:39]
    ds_read_b128 v[68:71], v13 offset:4096
    s_waitcnt lgkmcnt(3)
    v_mfma_f32_16x16x32_bf16 v[32:35], a[48:51], v[72:75], v[32:35]
    v_mfma_f32_16x16x32_bf16 v[36:39], a[52:55], v[72:75], v[36:39]
    ds_read_b128 v[72:75], v12 offset:5120
    s_waitcnt lgkmcnt(3)
    v_mfma_f32_16x16x32_bf16 v[32:35], a[56:59], v[76:79], v[32:35]
    v_mfma_f32_16x16x32_bf16 v[36:39], a[60:63], v[76:79], v[36:39]
    ds_read_b128 v[76:79], v13 offset:5120
    s_waitcnt lgkmcnt(3)
    v_mfma_f32_16x16x32_bf16 v[32:35], a[64:67], v[64:67], v[32:35]
    v_mfma_f32_16x16x32_bf16 v[36:39], a[68:71], v[64:67], v[36:39]
    s_add_u32 m0, s13, 1792
    s_nop 0
    global_load_lds_dwordx4 v2, s[16:17] offset:256 sc1
    ds_read_b128 v[64:67], v12 offset:6144
    s_waitcnt lgkmcnt(3)
    v_mfma_f32_16x16x32_bf16 v[32:35], a[72:75], v[68:71], v[32:35]
    v_mfma_f32_16x16x32_bf16 v[36:39], a[76:79], v[68:71], v[36:39]
    ds_read_b128 v[68:71], v13 offset:6144
    s_waitcnt lgkmcnt(3)
    v_mfma_f32_16x16x32_bf16 v[32:35], a[80:83], v[72:75], v[32:35]
    v_mfma_f32_16x16x32_bf16 v[36:39], a[84:87], v[72:75], v[36:39]
    ds_read_b128 v[72:75], v12 offset:7168
    s_waitcnt lgkmcnt(3)
    v_mfma_f32_16x16x32_bf16 v[32:35], a[88:91], v[76:79], v[32:35]
    v_mfma_f32_16x16x32_bf16 v[36:39], a[92:95], v[76:79], v[36:39]
    ds_read_b128 v[76:79], v13 offset:7168
    s_waitcnt lgkmcnt(3)
    v_mfma_f32_16x16x32_bf16 v[32:35], a[96:99], v[64:67], v[32:35]
    v_mfma_f32_16x16x32_bf16 v[36:39], a[100:103], v[64:67], v[36:39]
    s_add_u32 m0, s13, 2688
    s_nop 0
    global_load_lds_dwordx4 v2, s[16:17] offset:384 sc1
    ds_read_b128 v[64:67], v12 offset:8192
    s_waitcnt lgkmcnt(3)
    v_mfma_f32_16x16x32_bf16 v[32:35], a[104:107], v[68:71], v[32:35]
    v_mfma_f32_16x16x32_bf16 v[36:39], a[108:111], v[68:71], v[36:39]
    ds_read_b128 v[68:71], v13 offset:8192
    s_waitcnt lgkmcnt(3)
    v_mfma_f32_16x16x32_bf16 v[32:35], a[112:115], v[72:75], v[32:35]
    v_mfma_f32_16x16x32_bf16 v[36:39], a[116:119], v[72:75], v[36:39]
    ds_read_b128 v[72:75], v12 offset:9216
    s_waitcnt lgkmcnt(3)
    v_mfma_f32_16x16x32_bf16 v[32:35], a[120:123], v[76:79], v[32:35]
    v_mfma_f32_16x16x32_bf16 v[36:39], a[124:127], v[76:79], v[36:39]
    ds_read_b128 v[76:79], v13 offset:9216
    s_waitcnt lgkmcnt(3)
    v_mfma_f32_16x16x32_bf16 v[32:35], a[128:131], v[64:67], v[32:35]
    v_mfma_f32_16x16x32_bf16 v[36:39], a[132:135], v[64:67], v[36:39]
    s_add_u32 m0, s13, 3584
    s_nop 0
    global_load_lds_dwordx4 v2, s[16:17] offset:512 sc1
    ds_read_b128 v[64:67], v12 offset:10240
    s_waitcnt lgkmcnt(3)
    v_mfma_f32_16x16x32_bf16 v[32:35], a[136:139], v[68:71], v[32:35]
    v_mfma_f32_16x16x32_bf16 v[36:39], a[140:143], v[68:71], v[36:39]
    ds_read_b128 v[68:71], v13 offset:10240
    s_waitcnt lgkmcnt(3)
    v_mfma_f32_16x16x32_bf16 v[32:35], a[144:147], v[72:75], v[32:35]
    v_mfma_f32_16x16x32_bf16 v[36:39], a[148:151], v[72:75], v[36:39]
    ds_read_b128 v[72:75], v12 offset:11264
    s_waitcnt lgkmcnt(3)
    v_mfma_f32_16x16x32_bf16 v[32:35], a[152:155], v[76:79], v[32:35]
    v_mfma_f32_16x16x32_bf16 v[36:39], a[156:159], v[76:79], v[36:39]
    ds_read_b128 v[76:79], v13 offset:11264
    s_waitcnt lgkmcnt(3)
    v_mfma_f32_16x16x32_bf16 v[32:35], a[160:163], v[64:67], v[32:35]
    v_mfma_f32_16x16x32_bf16 v[36:39], a[164:167], v[64:67], v[36:39]
    s_add_u32 m0, s13, 4480
    s_nop 0
    global_load_lds_dwordx4 v2, s[16:17] offset:640 sc1
    ds_read_b128 v[64:67], v12 offset:12288
    s_waitcnt lgkmcnt(3)
    v_mfma_f32_16x16x32_bf16 v[32:35], a[168:171], v[68:71], v[32:35]
    v_mfma_f32_16x16x32_bf16 v[36:39], a[172:175], v[68:71], v[36:39]
    ds_read_b128 v[68:71], v13 offset:12288
    s_waitcnt lgkmcnt(3)
    v_mfma_f32_16x16x32_bf16 v[32:35], a[176:179], v[72:75], v[32:35]
    v_mfma_f32_16x16x32_bf16 v[36:39], a[180:183], v[72:75], v[36:39]
    ds_read_b128 v[72:75], v12 offset:13312
    s_waitcnt lgkmcnt(3)
    v_mfma_f32_16x16x32_bf16 v[32:35], a[184:187], v[76:79], v[32:35]
    v_mfma_f32_16x16x32_bf16 v[36:39], a[188:191], v[76:79], v[36:39]
    ds_read_b128 v[76:79], v13 offset:13312
    s_waitcnt lgkmcnt(3)
    v_mfma_f32_16x16x32_bf16 v[32:35], a[192:195], v[64:67], v[32:35]
    v_mfma_f32_16x16x32_bf16 v[36:39], a[196:199], v[64:67], v[36:39]
    s_add_u32 m0, s13, 5376
    s_nop 0
    global_load_lds_dwordx4 v2, s[16:17] offset:768 sc1
    ds_read_b128 v[64:67], v12 offset:14336
    s_waitcnt lgkmcnt(3)
    v_mfma_f32_16x16x32_bf16 v[32:35], a[200:203], v[68:71], v[32:35]
    v_mfma_f32_16x16x32_bf16 v[36:39], a[204:207], v[68:71], v[36:39]
    ds_read_b128 v[68:71], v13 offset:14336
    s_waitcnt lgkmcnt(3)
    v_mfma_f32_16x16x32_bf16 v[32:35], a[208:211], v[72:75], v[32:35]
    v_mfma_f32_16x16x32_bf16 v[36:39], a[212:215], v[72:75], v[36:39]
    ds_read_b128 v[72:75], v12 offset:15360
    s_waitcnt lgkmcnt(3)
    v_mfma_f32_16x16x32_bf16 v[32:35], a[216:219], v[76:79], v[32:35]
    v_mfma_f32_16x16x32_bf16 v[36:39], a[220:223], v[76:79], v[36:39]
    ds_read_b128 v[76:79], v13 offset:15360
    s_waitcnt lgkmcnt(3)
    v_mfma_f32_16x16x32_bf16 v[32:35], a[224:227], v[64:67], v[32:35]
    v_mfma_f32_16x16x32_bf16 v[36:39], a[228:231], v[64:67], v[36:39]
    s_add_u32 m0, s13, 6272
    s_nop 0
    global_load_lds_dwordx4 v2, s[16:17] offset:896 sc1
    ds_read_b128 v[64:67], v12 offset:16384
    s_waitcnt lgkmcnt(3)
    v_mfma_f32_16x16x32_bf16 v[32:35], a[232:235], v[68:71], v[32:35]
    v_mfma_f32_16x16x32_bf16 v[36:39], a[236:239], v[68:71], v[36:39]
    ds_read_b128 v[68:71], v13 offset:16384
    s_waitcnt lgkmcnt(3)
    v_mfma_f32_16x16x32_bf16 v[32:35], a[240:243], v[72:75], v[32:35]
    v_mfma_f32_16x16x32_bf16 v[36:39], a[244:247], v[72:75], v[36:39]
    ds_read_b128 v[72:75], v12 offset:17408
    s_waitcnt lgkmcnt(3)
    v_mfma_f32_16x16x32_bf16 v[32:35], a[248:251], v[76:79], v[32:35]
    v_mfma_f32_16x16x32_bf16 v[36:39], a[252:255], v[76:79], v[36:39]
    ds_read_b128 v[76:79], v13 offset:17408
    s_waitcnt lgkmcnt(3)
    v_mfma_f32_16x16x32_bf16 v[32:35], v[192:195], v[64:67], v[32:35]
    v_mfma_f32_16x16x32_bf16 v[36:39], v[196:199], v[64:67], v[36:39]
    s_add_u32 m0, s13, 7168
    s_nop 0
    global_load_lds_dwordx4 v2, s[16:17] offset:1024 sc1
    ds_read_b128 v[64:67], v12 offset:18432
    s_waitcnt lgkmcnt(3)
    v_mfma_f32_16x16x32_bf16 v[32:35], v[200:203], v[68:71], v[32:35]
    v_mfma_f32_16x16x32_bf16 v[36:39], v[204:207], v[68:71], v[36:39]
    ds_read_b128 v[68:71], v13 offset:18432
    s_waitcnt lgkmcnt(3)
    v_mfma_f32_16x16x32_bf16 v[32:35], v[208:211], v[72:75], v[32:35]
    v_mfma_f32_16x16x32_bf16 v[36:39], v[212:215], v[72:75], v[36:39]
    ds_read_b128 v[72:75], v12 offset:19456
    s_waitcnt lgkmcnt(3)
    v_mfma_f32_16x16x32_bf16 v[32:35], v[216:219], v[76:79], v[32:35]
    v_mfma_f32_16x16x32_bf16 v[36:39], v[220:223], v[76:79], v[36:39]
    ds_read_b128 v[76:79], v13 offset:19456
    s_waitcnt lgkmcnt(3)
    v_mfma_f32_16x16x32_bf16 v[32:35], v[224:227], v[64:67], v[32:35]
    v_mfma_f32_16x16x32_bf16 v[36:39], v[228:231], v[64:67], v[36:39]
    s_add_u32 m0, s13, 8064
    s_nop 0
    global_load_lds_dwordx4 v2, s[16:17] offset:1152 sc1
    s_waitcnt lgkmcnt(2)
    v_mfma_f32_16x16x32_bf16 v[32:35], v[232:235], v[68:71], v[32:35]
    v_mfma_f32_16x16x32_bf16 v[36:39], v[236:239], v[68:71], v[36:39]
    s_waitcnt lgkmcnt(1)
    v_mfma_f32_16x16x32_bf16 v[32:35], v[240:243], v[72:75], v[32:35]
    v_mfma_f32_16x16x32_bf16 v[36:39], v[244:247], v[72:75], v[36:39]
    s_waitcnt lgkmcnt(0)
    v_mfma_f32_16x16x32_bf16 v[32:35], v[248:251], v[76:79], v[32:35]
    v_mfma_f32_16x16x32_bf16 v[36:39], v[252:255], v[76:79], v[36:39]
    s_waitcnt vmcnt(10)
    s_branch L_b2j_90
L_b2nd_89:
    ds_read_b128 v[64:67], v12 offset:0
    ds_read_b128 v[68:71], v13 offset:0
    ds_read_b128 v[72:75], v12 offset:1024
    ds_read_b128 v[76:79], v13 offset:1024
    s_waitcnt lgkmcnt(3)
    v_mfma_f32_16x16x32_bf16 v[32:35], a[0:3], v[64:67], 0
    v_mfma_f32_16x16x32_bf16 v[36:39], a[4:7], v[64:67], 0
    ds_read_b128 v[64:67], v12 offset:2048
    s_waitcnt lgkmcnt(3)
    v_mfma_f32_16x16x32_bf16 v[32:35], a[8:11], v[68:71], v[32:35]
    v_mfma_f32_16x16x32_bf16 v[36:39], a[12:15], v[68:71], v[36:39]
    ds_read_b128 v[68:71], v13 offset:2048
    s_waitcnt lgkmcnt(3)
    v_mfma_f32_16x16x32_bf16 v[32:35], a[16:19], v[72:75], v[32:35]
    v_mfma_f32_16x16x32_bf16 v[36:39], a[20:23], v[72:75], v[36:39]
    ds_read_b128 v[72:75], v12 offset:3072
    s_waitcnt lgkmcnt(3)
    v_mfma_f32_16x16x32_bf16 v[32:35], a[24:27], v[76:79], v[32:35]
    v_mfma_f32_16x16x32_bf16 v[36:39], a[28:31], v[76:79], v[36:39]
    ds_read_b128 v[76:79], v13 offset:3072
    s_waitcnt lgkmcnt(3)
    v_mfma_f32_16x16x32_bf16 v[32:35], a[32:35], v[64:67], v[32:35]
    v_mfma_f32_16x16x32_bf16 v[36:39], a[36:39], v[64:67], v[36:39]
    ds_read_b128 v[64:67], v12 offset:4096
    s_waitcnt lgkmcnt(3)
    v_mfma_f32_16x16x32_bf16 v[32:35], a[40:43], v[68:71], v[32:35]
    v_mfma_f32_16x16x32_bf16 v[36:39], a[44:47], v[68:71], v[36:39]
    ds_read_b128 v[68:71], v13 offset:4096
    s_waitcnt lgkmcnt(3)
    v_mfma_f32_16x16x32_bf16 v[32:35], a[48:51], v[72:75], v[32:35]
    v_mfma_f32_16x16x32_bf16 v[36:39], a[52:55], v[72:75], v[36:39]
    ds_read_b128 v[72:75], v12 offset:5120
    s_waitcnt lgkmcnt(3)
    v_mfma_f32_16x16x32_bf16 v[32:35], a[56:59], v[76:79], v[32:35]
    v_mfma_f32_16x16x32_bf16 v[36:39], a[60:63], v[76:79], v[36:39]
    ds_read_b128 v[76:79], v13 offset:5120
    s_waitcnt lgkmcnt(3)
    v_mfma_f32_16x16x32_bf16 v[32:35], a[64:67], v[64:67], v[32:35]
    v_mfma_f32_16x16x32_bf16 v[36:39], a[68:71], v[64:67], v[36:39]
    ds_read_b128 v[64:67], v12 offset:6144
    s_waitcnt lgkmcnt(3)
    v_mfma_f32_16x16x32_bf16 v[32:35], a[72:75], v[68:71], v[32:35]
    v_mfma_f32_16x16x32_bf16 v[36:39], a[76:79], v[68:71], v[36:39]
    ds_read_b128 v[68:71], v13 offset:6144
    s_waitcnt lgkmcnt(3)
    v_mfma_f32_16x16x32_bf16 v[32:35], a[80:83], v[72:75], v[32:35]
    v_mfma_f32_16x16x32_bf16 v[36:39], a[84:87], v[72:75], v[36:39]
    ds_read_b128 v[72:75], v12 offset:7168
    s_waitcnt lgkmcnt(3)
    v_mfma_f32_16x16x32_bf16 v[32:35], a[88:91], v[76:79], v[32:35]
    v_mfma_f32_16x16x32_bf16 v[36:39], a[92:95], v[76:79], v[36:39]
    ds_read_b128 v[76:79], v13 offset:7168
    s_waitcnt lgkmcnt(3)
    v_mfma_f32_16x16x32_bf16 v[32:35], a[96:99], v[64:67], v[32:35]
    v_mfma_f32_16x16x32_bf16 v[36:39], a[100:103], v[64:67], v[36:39]
    ds_read_b128 v[64:67], v12 offset:8192
    s_waitcnt lgkmcnt(3)
    v_mfma_f32_16x16x32_bf16 v[32:35], a[104:107], v[68:71], v[32:35]
    v_mfma_f32_16x16x32_bf16 v[36:39], a[108:111], v[68:71], v[36:39]
    ds_read_b128 v[68:71], v13 offset:8192
    s_waitcnt lgkmcnt(3)
    v_mfma_f32_16x16x32_bf16 v[32:35], a[112:115], v[72:75], v[32:35]
    v_mfma_f32_16x16x32_bf16 v[36:39], a[116:119], v[72:75], v[36:39]
    ds_read_b128 v[72:75], v12 offset:9216
    s_waitcnt lgkmcnt(3)
    v_mfma_f32_16x16x32_bf16 v[32:35], a[120:123], v[76:79], v[32:35]
    v_mfma_f32_16x16x32_bf16 v[36:39], a[124:127], v[76:79], v[36:39]
    ds_read_b128 v[76:79], v13 offset:9216
    s_waitcnt lgkmcnt(3)
    v_mfma_f32_16x16x32_bf16 v[32:35], a[128:131], v[64:67], v[32:35]
    v_mfma_f32_16x16x32_bf16 v[36:39], a[132:135], v[64:67], v[36:39]
    ds_read_b128 v[64:67], v12 offset:10240
    s_waitcnt lgkmcnt(3)
    v_mfma_f32_16x16x32_bf16 v[32:35], a[136:139], v[68:71], v[32:35]
    v_mfma_f32_16x16x32_bf16 v[36:39], a[140:143], v[68:71], v[36:39]
    ds_read_b128 v[68:71], v13 offset:10240
    s_waitcnt lgkmcnt(3)
    v_mfma_f32_16x16x32_bf16 v[32:35], a[144:147], v[72:75], v[32:35]
    v_mfma_f32_16x16x32_bf16 v[36:39], a[148:151], v[72:75], v[36:39]
    ds_read_b128 v[72:75], v12 offset:11264
    s_waitcnt lgkmcnt(3)
    v_mfma_f32_16x16x32_bf16 v[32:35], a[152:155], v[76:79], v[32:35]
    v_mfma_f32_16x16x32_bf16 v[36:39], a[156:159], v[76:79], v[36:39]
    ds_read_b128 v[76:79], v13 offset:11264
    s_waitcnt lgkmcnt(3)
    v_mfma_f32_16x16x32_bf16 v[32:35], a[160:163], v[64:67], v[32:35]
    v_mfma_f32_16x16x32_bf16 v[36:39], a[164:167], v[64:67], v[36:39]
    ds_read_b128 v[64:67], v12 offset:12288
    s_waitcnt lgkmcnt(3)
    v_mfma_f32_16x16x32_bf16 v[32:35], a[168:171], v[68:71], v[32:35]
    v_mfma_f32_16x16x32_bf16 v[36:39], a[172:175], v[68:71], v[36:39]
    ds_read_b128 v[68:71], v13 offset:12288
    s_waitcnt lgkmcnt(3)
    v_mfma_f32_16x16x32_bf16 v[32:35], a[176:179], v[72:75], v[32:35]
    v_mfma_f32_16x16x32_bf16 v[36:39], a[180:183], v[72:75], v[36:39]
    ds_read_b128 v[72:75], v12 offset:13312
    s_waitcnt lgkmcnt(3)
    v_mfma_f32_16x16x32_bf16 v[32:35], a[184:187], v[76:79], v[32:35]
    v_mfma_f32_16x16x32_bf16 v[36:39], a[188:191], v[76:79], v[36:39]
    ds_read_b128 v[76:79], v13 offset:13312
    s_waitcnt lgkmcnt(3)
    v_mfma_f32_16x16x32_bf16 v[32:35], a[192:195], v[64:67], v[32:35]
    v_mfma_f32_16x16x32_bf16 v[36:39], a[196:199], v[64:67], v[36:39]
    ds_read_b128 v[64:67], v12 offset:14336
    s_waitcnt lgkmcnt(3)
    v_mfma_f32_16x16x32_bf16 v[32:35], a[200:203], v[68:71], v[32:35]
    v_mfma_f32_16x16x32_bf16 v[36:39], a[204:207], v[68:71], v[36:39]
    ds_read_b128 v[68:71], v13 offset:14336
    s_waitcnt lgkmcnt(3)
    v_mfma_f32_16x16x32_bf16 v[32:35], a[208:211], v[72:75], v[32:35]
    v_mfma_f32_16x16x32_bf16 v[36:39], a[212:215], v[72:75], v[36:39]
    ds_read_b128 v[72:75], v12 offset:15360
    s_waitcnt lgkmcnt(3)
    v_mfma_f32_16x16x32_bf16 v[32:35], a[216:219], v[76:79], v[32:35]
    v_mfma_f32_16x16x32_bf16 v[36:39], a[220:223], v[76:79], v[36:39]
    ds_read_b128 v[76:79], v13 offset:15360
    s_waitcnt lgkmcnt(3)
    v_mfma_f32_16x16x32_bf16 v[32:35], a[224:227], v[64:67], v[32:35]
    v_mfma_f32_16x16x32_bf16 v[36:39], a[228:231], v[64:67], v[36:39]
    ds_read_b128 v[64:67], v12 offset:16384
    s_waitcnt lgkmcnt(3)
    v_mfma_f32_16x16x32_bf16 v[32:35], a[232:235], v[68:71], v[32:35]
    v_mfma_f32_16x16x32_bf16 v[36:39], a[236:239], v[68:71], v[36:39]
    ds_read_b128 v[68:71], v13 offset:16384
    s_waitcnt lgkmcnt(3)
    v_mfma_f32_16x16x32_bf16 v[32:35], a[240:243], v[72:75], v[32:35]
    v_mfma_f32_16x16x32_bf16 v[36:39], a[244:247], v[72:75], v[36:39]
    ds_read_b128 v[72:75], v12 offset:17408
    s_waitcnt lgkmcnt(3)
    v_mfma_f32_16x16x32_bf16 v[32:35], a[248:251], v[76:79], v[32:35]
    v_mfma_f32_16x16x32_bf16 v[36:39], a[252:255], v[76:79], v[36:39]
    ds_read_b128 v[76:79], v13 offset:17408
    s_waitcnt lgkmcnt(3)
    v_mfma_f32_16x16x32_bf16 v[32:35], v[192:195], v[64:67], v[32:35]
    v_mfma_f32_16x16x32_bf16 v[36:39], v[196:199], v[64:67], v[36:39]
    ds_read_b128 v[64:67], v12 offset:18432
    s_waitcnt lgkmcnt(3)
    v_mfma_f32_16x16x32_bf16 v[32:35], v[200:203], v[68:71], v[32:35]
    v_mfma_f32_16x16x32_bf16 v[36:39], v[204:207], v[68:71], v[36:39]
    ds_read_b128 v[68:71], v13 offset:18432
    s_waitcnt lgkmcnt(3)
    v_mfma_f32_16x16x32_bf16 v[32:35], v[208:211], v[72:75], v[32:35]
    v_mfma_f32_16x16x32_bf16 v[36:39], v[212:215], v[72:75], v[36:39]
    ds_read_b128 v[72:75], v12 offset:19456
    s_waitcnt lgkmcnt(3)
    v_mfma_f32_16x16x32_bf16 v[32:35], v[216:219], v[76:79], v[32:35]
    v_mfma_f32_16x16x32_bf16 v[36:39], v[220:223], v[76:79], v[36:39]
    ds_read_b128 v[76:79], v13 offset:19456
    s_waitcnt lgkmcnt(3)
    v_mfma_f32_16x16x32_bf16 v[32:35], v[224:227], v[64:67], v[32:35]
    v_mfma_f32_16x16x32_bf16 v[36:39], v[228:231], v[64:67], v[36:39]
    s_waitcnt lgkmcnt(2)
    v_mfma_f32_16x16x32_bf16 v[32:35], v[232:235], v[68:71], v[32:35]
    v_mfma_f32_16x16x32_bf16 v[36:39], v[236:239], v[68:71], v[36:39]
    s_waitcnt lgkmcnt(1)
    v_mfma_f32_16x16x32_bf16 v[32:35], v[240:243], v[72:75], v[32:35]
    v_mfma_f32_16x16x32_bf16 v[36:39], v[244:247], v[72:75], v[36:39]
    s_waitcnt lgkmcnt(0)
    v_mfma_f32_16x16x32_bf16 v[32:35], v[248:251], v[76:79], v[32:35]
    v_mfma_f32_16x16x32_bf16 v[36:39], v[252:255], v[76:79], v[36:39]
    s_waitcnt vmcnt(0)
L_b2j_90:
    v_lshlrev_b32 v16, 16, v40
    v_and_b32 v17, 0xffff0000, v40
    v_mul_f32 v16, v16, v24
    v_mul_f32 v17, v17, v25
    v_cvt_pk_bf16_f32 v16, v16, v17
    v_and_b32 v17, 0xffff0000, v16
    v_lshlrev_b32 v16, 16, v16
    v_add_f32 v56, v32, v16
    v_add_f32 v57, v36, v17
    v_lshlrev_b32 v16, 16, v41
    v_and_b32 v17, 0xffff0000, v41
    v_mul_f32 v16, v16, v26
    v_mul_f32 v17, v17, v27
    v_cvt_pk_bf16_f32 v16, v16, v17
    v_and_b32 v17, 0xffff0000, v16
    v_lshlrev_b32 v16, 16, v16
    v_add_f32 v58, v33, v16
    v_add_f32 v59, v37, v17
    v_lshlrev_b32 v16, 16, v42
    v_and_b32 v17, 0xffff0000, v42
    v_mul_f32 v16, v16, v28
    v_mul_f32 v17, v17, v29
    v_cvt_pk_bf16_f32 v16, v16, v17
    v_and_b32 v17, 0xffff0000, v16
    v_lshlrev_b32 v16, 16, v16
    v_add_f32 v60, v34, v16
    v_add_f32 v61, v38, v17
    v_lshlrev_b32 v16, 16, v43
    v_and_b32 v17, 0xffff0000, v43
    v_mul_f32 v16, v16, v30
    v_mul_f32 v17, v17, v31
    v_cvt_pk_bf16_f32 v16, v16, v17
    v_and_b32 v17, 0xffff0000, v16
    v_lshlrev_b32 v16, 16, v16
    v_add_f32 v62, v35, v16
    v_add_f32 v63, v39, v17
    global_store_dwordx4 v9, v[56:59], s[52:53]
    global_store_dwordx4 v9, v[60:63], s[52:53] offset:16
    v_add_u32 v8, 20480, v8
    v_add_u32 v9, 81920, v9
    s_xor_b32 s26, s26, 40960
    v_add_u32 v12, s26, v14
    v_add_u32 v13, s26, v15
    s_add_u32 s18, s18, 1
    s_cmp_lt_u32 s18, 32
    s_cbranch_scc1 L_b2_loop
    s_waitcnt vmcnt(0)
    s_endpgm
L_timeout:
    v_mov_b32 v1, 8
    v_mov_b32 v2, 0xdead
    s_mov_b64 exec, 1
    global_store_dword v1, v2, s[6:7]
    s_waitcnt vmcnt(0)
L_end:
    s_endpgm
.section .rodata,"a"
.p2align 6
.amdhsa_kernel concat_heads__memory_aug_recurrent_mem_tr__ssm_conv_s5__prompt_kernel
  .amdhsa_next_free_vgpr 512
  .amdhsa_next_free_sgpr 102
  .amdhsa_accum_offset 256
  .amdhsa_group_segment_fixed_size 0
  .amdhsa_kernarg_size 152
  .amdhsa_user_sgpr_count 2
  .amdhsa_user_sgpr_kernarg_segment_ptr 1
  .amdhsa_system_sgpr_workgroup_id_x 1
.end_amdhsa_kernel
```
